```python
import torch

def _softmax(x, axis=-1):
    return torch.softmax(x, dim=axis)
def _gelu(x):
    return torch.nn.functional.gelu(x, approximate="tanh")
def _silu(x):
    return torch.nn.functional.silu(x)
def _sigmoid(x):
    return torch.sigmoid(x)
def _layernorm(x, axis=-1, eps=1e-5):
    m = x.mean(dim=axis, keepdim=True)
    v = x.var(dim=axis, keepdim=True, unbiased=False)
    return (x - m) / torch.sqrt(v + eps)
def _scatter_add(tgt, idx, src, axis=0):
    return tgt.clone().index_add_(axis, idx, src)
def _segment_sum(src, seg, n):
    out = torch.zeros((n,) + src.shape[1:], dtype=src.dtype)
    return out.index_add_(0, seg, src)
def _pad(x, pw):
    flat = tuple(v for pair in reversed(pw) for v in pair)
    return torch.nn.functional.pad(x, flat)

kernel_name = 'gated_mix__linear_attn_block__dense_activation_squared_relu__prompt'

def setup_inputs():

    _w = (lambda a: (lambda t: t.to(torch.bfloat16) if t.is_floating_point() else t)(torch.as_tensor(a)))
    def _A_setup():
        B, S, D = 1, 2048, 448
        return {
            "x": _w((lambda *s: torch.randn(*s, dtype=torch.bfloat16) * 0.05)(B, S, D)),
            "wqkv": _w((lambda *s: torch.randn(*s, dtype=torch.bfloat16) * 0.8)(D, 3 * D)),
            "wo": _w((lambda *s: torch.randn(*s, dtype=torch.bfloat16) * 0.2)(D, D)),
        }
    _A_in = _A_setup()

    def _B_setup():
        B, S, D, F = 1, 2048, 448, 1792
        return {
            "x": _w((lambda *s: torch.randn(*s, dtype=torch.bfloat16) * 0.05)(B, S, D)),
            "w1": _w((lambda *s: torch.randn(*s, dtype=torch.bfloat16) * 0.05)(D, F)),
            "b1": _w((lambda *s: torch.randn(*s, dtype=torch.bfloat16) * 0.05)(F)),
            "w2": _w((lambda *s: torch.randn(*s, dtype=torch.bfloat16) * 0.05)(F, D)),
            "b2": _w((lambda *s: torch.randn(*s, dtype=torch.bfloat16) * 0.05)(D)),
        }
    _B_in = _B_setup()

    return {
        "A_x": _A_in["x"],
        "A_wqkv": _A_in["wqkv"],
        "A_wo": _A_in["wo"],
        "B_x": _B_in["x"],
        "B_w1": _B_in["w1"],
        "B_b1": _B_in["b1"],
        "B_w2": _B_in["w2"],
        "B_b2": _B_in["b2"],
        "gate_w": _w((lambda *s: torch.randn(*s, dtype=torch.bfloat16) * 0.05)(448) * 16.0),
    }

def reference(A_x, A_wqkv, A_wo, B_x, B_w1, B_b1, B_w2, B_b2, gate_w):
    def _A_ref(x, wqkv, wo):
        B, S, D = x.shape
        H = 16; Dh = D // H
        qkv = (lambda x, *d: x.permute(*d))((x @ wqkv).reshape(B, S, 3, H, Dh), 2, 0, 3, 1, 4)
        q, k, v = qkv[0], qkv[1], qkv[2]
        phi = lambda t: torch.where(t > 0, t + 1, torch.exp(t)) + 1e-6
        pq, pk = phi(q), phi(k)
        kv = torch.einsum("bhsd,bhse->bhde", pk, v)
        z = torch.einsum("bhsd->bhd", pk)
        num = torch.einsum("bhqd,bhde->bhqe", pq, kv)
        den = torch.einsum("bhqd,bhd->bhq", pq, z)[..., None] + 1e-6
        o = num / den
        return (lambda x, *d: x.permute(*d))(o, 0, 2, 1, 3).reshape(B, S, D) @ wo

    def _B_ref(x, w1, b1, w2, b2):
        h = torch.einsum("bsd,df->bsf", x, w1) + b1
        zero = torch.zeros_like(h)
        r = torch.where(h > zero, h, zero)
        h = r * r
        out = torch.einsum("bsf,fd->bsd", h, w2) + b2
        return out

    x = A_x
    g = _sigmoid((x * gate_w).sum(-1, keepdims=True))
    a = _A_ref(x, A_wqkv, A_wo)
    b = _B_ref(x, B_w1, B_b1, B_w2, B_b2)
    return g * a + (1 - g) * b
```

```asm
; @launch grid=(256,1,1) block=(256,1,1) lds=163840
.amdgcn_target "amdgcn-amd-amdhsa--gfx950"
.text
.globl gated_mix__linear_attn_block__dense_activation_squared_relu__prompt_kernel
.p2align 8
.type gated_mix__linear_attn_block__dense_activation_squared_relu__prompt_kernel,@function
gated_mix__linear_attn_block__dense_activation_squared_relu__prompt_kernel:
    s_load_dwordx16 s[20:35], s[0:1], 0
    s_load_dwordx8 s[36:43], s[0:1], 64
    s_cmp_ge_u32 s2, 256
    s_cbranch_scc1 L_exit
    s_and_b32 s67, s2, 7
    s_lshr_b32 s68, s2, 3
    s_lshr_b32 s66, s67, 1
    s_lshl_b32 s66, s66, 2
    s_and_b32 s69, s68, 3
    s_add_u32 s66, s66, s69
    s_and_b32 s65, s67, 1
    s_lshl_b32 s65, s65, 3
    s_lshr_b32 s69, s68, 2
    s_add_u32 s65, s65, s69
    s_cmp_lt_u32 s68, 28
    s_cselect_b32 s97, 1, 0
    s_mul_i32 s69, s68, 37
    s_lshr_b32 s69, s69, 8
    s_mul_i32 s70, s69, 7
    s_sub_u32 s87, s68, s70
    s_lshl_b32 s86, s67, 2
    s_add_u32 s86, s86, s69
    s_min_u32 s86, s86, 31
    s_and_b32 s3, s68, 3
    s_lshl_b32 s3, s3, 1
    s_lshr_b32 s7, s68, 2
    s_add_u32 s3, s3, s7
    s_cmp_ge_u32 s3, 7
    s_cselect_b32 s7, 7, 0
    s_sub_u32 s3, s3, s7
    s_cmp_ge_u32 s3, 7
    s_cselect_b32 s7, 7, 0
    s_sub_u32 s3, s3, s7
    s_lshl_b32 s19, s69, 1
    s_add_u32 s19, s19, s87
    s_cmp_ge_u32 s19, 7
    s_cselect_b32 s7, 7, 0
    s_sub_u32 s19, s19, s7
    s_cmp_ge_u32 s19, 7
    s_cselect_b32 s7, 7, 0
    s_sub_u32 s19, s19, s7
    v_and_b32 v1, 63, v0
    v_lshrrev_b32 v10, 6, v0
    s_nop 0
    v_readfirstlane_b32 s64, v10
    v_lshlrev_b32 v9, 4, v1
    v_lshrrev_b32 v10, 3, v1
    v_mul_u32_u24 v10, 896, v10
    v_and_b32 v11, 7, v1
    v_lshrrev_b32 v189, 4, v1
    v_xor_b32 v11, v11, v189
    v_lshl_add_u32 v188, v11, 4, v10
    v_xor_b32 v11, 4, v11
    v_lshl_add_u32 v189, v11, 4, v10
    v_add_u32 v189, 6144, v189
    v_add_u32 v190, 12288, v188
    v_add_u32 v191, 12288, v189
    s_lshl_b32 s72, s64, 12
    s_lshl_b32 s67, s65, 2
    s_add_u32 s67, s67, s64
    s_mul_i32 s73, s67, 28672
    v_cmp_le_u32 s[84:85], 32, v1
    v_and_b32 v10, 31, v1
    v_cmp_le_u32 s[82:83], 28, v10
    s_mov_b32 s88, 0x3fb8aa3b
    s_mov_b32 s89, 0x358637bd
    v_bfe_u32 v11, v1, 1, 3
    v_lshrrev_b32 v5, 5, v1
    v_xor_b32 v11, v11, v5
    v_lshlrev_b32 v11, 4, v11
    v_lshl_add_u32 v10, v10, 7, v11
    v_add_u32 v5, s72, v10
    v_xor_b32 v6, 32, v5
    v_xor_b32 v7, 64, v5
    v_xor_b32 v8, 96, v5
    s_waitcnt lgkmcnt(0)
    s_mov_b32 s44, s20
    s_mov_b32 s45, s21
    s_mov_b32 s46, 1835008
    s_mov_b32 s47, 0x00020000
    s_add_u32 m0, s72, 0
    s_add_u32 s100, s3, 0
    s_cmp_ge_u32 s100, 7
    s_cselect_b32 s7, 7, 0
    s_sub_u32 s100, s100, s7
    s_lshl_b32 s100, s100, 7
    s_add_u32 s100, s100, s73
    buffer_load_dwordx4 v188, s[44:47], s100 offen offset:0 lds
    buffer_load_dwordx4 v189, s[44:47], s100 offen offset:1024 lds
    buffer_load_dwordx4 v190, s[44:47], s100 offen offset:2048 lds
    buffer_load_dwordx4 v191, s[44:47], s100 offen offset:3072 lds
    s_cmp_lt_u32 s66, 7
    s_cselect_b32 s48, s28, s22
    s_cselect_b32 s49, s29, s23
    s_movk_i32 s70, 2688
    s_cselect_b32 s70, 3584, s70
    s_mul_i32 s50, s70, 448
    s_mov_b32 s51, 0x00020000
    s_lshl_b32 s95, s70, 6
    s_sub_u32 s77, s66, 7
    s_lshl_b32 s67, s77, 7
    s_add_u32 s74, s67, 896
    s_add_u32 s75, s67, 1792
    s_sub_u32 s68, s66, 13
    s_lshl_b32 s68, s68, 1
    s_lshl_b32 s67, s68, 7
    s_add_u32 s69, s67, 128
    s_cmp_ge_u32 s66, 13
    s_cselect_b32 s77, s68, s77
    s_cselect_b32 s74, s67, s74
    s_cselect_b32 s75, s69, s75
    s_lshl_b32 s67, s66, 9
    s_add_u32 s69, s67, 256
    s_cmp_lt_u32 s66, 7
    s_cselect_b32 s74, s67, s74
    s_cselect_b32 s75, s69, s75
    v_lshrrev_b32 v10, 4, v1
    v_and_b32 v11, 15, v1
    v_lshlrev_b32 v208, 2, v10
    v_xor_b32 v11, v11, v208
    s_lshl_b32 s67, s64, 4
    v_add_u32 v10, s67, v10
    v_mul_u32_u24 v10, s70, v10
    v_lshl_add_u32 v208, v11, 4, v10
    s_lshl_b32 s67, s70, 2
    s_sub_u32 s67, s67, 1024
    v_add_u32 v209, s67, v208
    v_add_u32 v210, s67, v209
    v_add_u32 v211, s67, v210
    s_add_u32 m0, s72, 114688
    s_add_u32 s101, s3, 0
    s_cmp_ge_u32 s101, 7
    s_cselect_b32 s7, 7, 0
    s_sub_u32 s101, s101, s7
    s_mul_i32 s101, s101, s95
    s_add_u32 s101, s101, s74
    buffer_load_dwordx4 v208, s[48:51], s101 offen offset:0 lds
    buffer_load_dwordx4 v209, s[48:51], s101 offen offset:1024 lds
    buffer_load_dwordx4 v210, s[48:51], s101 offen offset:2048 lds
    buffer_load_dwordx4 v211, s[48:51], s101 offen offset:3072 lds
    s_mov_b32 s12, s36
    s_mov_b32 s13, s37
    s_mov_b32 s14, 896
    s_mov_b32 s15, 0x00020000
    s_mov_b32 m0, 147456
    s_nop 0
    buffer_load_dwordx4 v9, s[12:15], 0 offen lds
    s_add_u32 m0, s72, 16384
    s_add_u32 s100, s3, 1
    s_cmp_ge_u32 s100, 7
    s_cselect_b32 s7, 7, 0
    s_sub_u32 s100, s100, s7
    s_lshl_b32 s100, s100, 7
    s_add_u32 s100, s100, s73
    buffer_load_dwordx4 v188, s[44:47], s100 offen offset:0 lds
    buffer_load_dwordx4 v189, s[44:47], s100 offen offset:1024 lds
    buffer_load_dwordx4 v190, s[44:47], s100 offen offset:2048 lds
    buffer_load_dwordx4 v191, s[44:47], s100 offen offset:3072 lds
    s_add_u32 m0, s72, 131072
    s_add_u32 s101, s3, 1
    s_cmp_ge_u32 s101, 7
    s_cselect_b32 s7, 7, 0
    s_sub_u32 s101, s101, s7
    s_mul_i32 s101, s101, s95
    s_add_u32 s101, s101, s74
    buffer_load_dwordx4 v208, s[48:51], s101 offen offset:0 lds
    buffer_load_dwordx4 v209, s[48:51], s101 offen offset:1024 lds
    buffer_load_dwordx4 v210, s[48:51], s101 offen offset:2048 lds
    buffer_load_dwordx4 v211, s[48:51], s101 offen offset:3072 lds
    s_mov_b32 s52, s42
    s_mov_b32 s53, s43
    s_mov_b32 s54, 9519232
    s_mov_b32 s55, 0x00020000
    s_mov_b32 s8, s40
    s_mov_b32 s9, s41
    s_mov_b32 s10, 256
    s_mov_b32 s11, 0x00020000
    s_cmp_lg_u32 s2, 0
    s_cbranch_scc1 nonce_1
    s_cmp_lg_u32 s64, 0
    s_cbranch_scc1 nonce_1
    s_memrealtime s[6:7]
    s_waitcnt lgkmcnt(0)
    s_or_b32 s6, s6, 1
    v_mov_b32 v10, s6
    v_mov_b32 v11, 0
    s_mov_b64 exec, 1
    buffer_store_dword v10, v11, s[8:11], 0 offen sc1
    s_mov_b64 exec, -1
nonce_1:
    s_getpc_b64 s[6:7]
L_pc:
    s_lshr_b32 s67, s2, 3
    s_lshl_b32 s67, s67, 4
    v_and_b32 v10, 15, v1
    v_add_u32 v10, s67, v10
    v_lshlrev_b32 v10, 7, v10
    v_min_u32 v10, L_exit-L_pc, v10
    s_cmp_lg_u32 s64, 3
    s_cbranch_scc1 cpf_2
    global_load_dword v132, v10, s[6:7]
cpf_2:
    s_mov_b32 s56, s32
    s_mov_b32 s57, s33
    s_mov_b32 s58, 1605632
    s_mov_b32 s59, 0x00020000
    s_mov_b32 s60, s24
    s_mov_b32 s61, s25
    s_mov_b32 s62, 401408
    s_mov_b32 s63, 0x00020000
    s_add_u32 s17, s64, 3
    s_lshl_b32 s17, s17, 14
    s_mul_i32 s16, s64, 28672
    s_lshl_b32 s67, s87, 7
    s_add_u32 s16, s16, s67
    s_lshr_b32 s71, s64, 1
    s_lshl_b32 s67, s86, 1
    s_add_u32 s68, s67, s71
    s_mul_i32 s18, s68, 114688
    s_xor_b32 s68, s68, 1
    s_mul_i32 s27, s68, 114688
    s_lshl_b32 s68, s64, 11
    s_add_u32 s18, s18, s68
    s_add_u32 s27, s27, s68
    s_cmp_lt_u32 s66, 7
    s_cbranch_scc0 L_notF
    s_mov_b32 s12, s30
    s_mov_b32 s13, s31
    s_mov_b32 s14, 3584
    s_mov_b32 s15, 0x00020000
    v_and_b32 v10, 31, v1
    v_lshlrev_b32 v10, 1, v10
    s_lshl_b32 s67, s66, 9
    buffer_load_ushort v244, v10, s[12:15], s67 offen offset:0
    buffer_load_ushort v245, v10, s[12:15], s67 offen offset:64
    buffer_load_ushort v246, v10, s[12:15], s67 offen offset:128
    buffer_load_ushort v247, v10, s[12:15], s67 offen offset:192
    buffer_load_ushort v248, v10, s[12:15], s67 offen offset:256
    buffer_load_ushort v249, v10, s[12:15], s67 offen offset:320
    buffer_load_ushort v250, v10, s[12:15], s67 offen offset:384
    buffer_load_ushort v251, v10, s[12:15], s67 offen offset:448
    s_lshl_b32 s67, s65, 2
    s_add_u32 s67, s67, s64
    s_mul_i32 s80, s67, 114688
    s_lshl_b32 s68, s66, 14
    s_add_u32 s80, s80, s68
    v_mov_b32 v253, 0
    v_mov_b32 v254, 0
    v_mov_b32 v255, 0
    v_mov_b32 v11, 0x3f80
    v_cndmask_b32 v11, v11, 0, s[84:85]
    v_accvgpr_write_b32 a248, v11
    v_accvgpr_write_b32 a249, 0
    v_accvgpr_write_b32 a250, 0
    v_accvgpr_write_b32 a251, 0
    v_bfe_u32 v10, v1, 2, 2
    v_and_b32 v11, 3, v1
    v_bfe_u32 v12, v1, 4, 1
    v_lshrrev_b32 v13, 5, v1
    v_lshlrev_b32 v11, 3, v11
    v_lshl_add_u32 v11, v12, 5, v11
    v_lshlrev_b32 v14, 8, v10
    v_lshl_add_u32 v14, v13, 11, v14
    v_lshlrev_b32 v10, 6, v10
    v_add_u32 v15, 0, v11
    v_xor_b32 v15, v15, v10
    v_add_u32 v176, v15, v14
    v_add_u32 v177, 0x10000, v176
    v_add_u32 v178, 0x20000, v176
    v_add_u32 v15, 64, v11
    v_xor_b32 v15, v15, v10
    v_add_u32 v179, v15, v14
    v_add_u32 v180, 0x10000, v179
    v_add_u32 v181, 0x20000, v179
    v_add_u32 v15, 128, v11
    v_xor_b32 v15, v15, v10
    v_add_u32 v182, v15, v14
    v_add_u32 v183, 0x10000, v182
    v_add_u32 v184, 0x20000, v182
    v_add_u32 v15, 192, v11
    v_xor_b32 v15, v15, v10
    v_add_u32 v185, v15, v14
    v_add_u32 v186, 0x10000, v185
    v_add_u32 v187, 0x20000, v185
    s_add_u32 s20, s3, 0
    s_cmp_ge_u32 s20, 7
    s_cselect_b32 s7, 7, 0
    s_sub_u32 s20, s20, s7
    s_mul_i32 s20, s20, 229376
    s_add_u32 s29, s19, 0
    s_cmp_ge_u32 s29, 7
    s_cselect_b32 s7, 7, 0
    s_sub_u32 s29, s29, s7
    s_add_u32 s21, s3, 1
    s_cmp_ge_u32 s21, 7
    s_cselect_b32 s7, 7, 0
    s_sub_u32 s21, s21, s7
    s_mul_i32 s21, s21, 229376
    s_add_u32 s30, s19, 1
    s_cmp_ge_u32 s30, 7
    s_cselect_b32 s7, 7, 0
    s_sub_u32 s30, s30, s7
    s_add_u32 s22, s3, 2
    s_cmp_ge_u32 s22, 7
    s_cselect_b32 s7, 7, 0
    s_sub_u32 s22, s22, s7
    s_mul_i32 s22, s22, 229376
    s_add_u32 s31, s19, 2
    s_cmp_ge_u32 s31, 7
    s_cselect_b32 s7, 7, 0
    s_sub_u32 s31, s31, s7
    s_add_u32 s23, s3, 3
    s_cmp_ge_u32 s23, 7
    s_cselect_b32 s7, 7, 0
    s_sub_u32 s23, s23, s7
    s_mul_i32 s23, s23, 229376
    s_add_u32 s32, s19, 3
    s_cmp_ge_u32 s32, 7
    s_cselect_b32 s7, 7, 0
    s_sub_u32 s32, s32, s7
    s_add_u32 s24, s3, 4
    s_cmp_ge_u32 s24, 7
    s_cselect_b32 s7, 7, 0
    s_sub_u32 s24, s24, s7
    s_mul_i32 s24, s24, 229376
    s_add_u32 s33, s19, 4
    s_cmp_ge_u32 s33, 7
    s_cselect_b32 s7, 7, 0
    s_sub_u32 s33, s33, s7
    s_add_u32 s25, s3, 5
    s_cmp_ge_u32 s25, 7
    s_cselect_b32 s7, 7, 0
    s_sub_u32 s25, s25, s7
    s_mul_i32 s25, s25, 229376
    s_add_u32 s36, s19, 5
    s_cmp_ge_u32 s36, 7
    s_cselect_b32 s7, 7, 0
    s_sub_u32 s36, s36, s7
    s_add_u32 s28, s3, 6
    s_cmp_ge_u32 s28, 7
    s_cselect_b32 s7, 7, 0
    s_sub_u32 s28, s28, s7
    s_mul_i32 s28, s28, 229376
    s_add_u32 s37, s19, 6
    s_cmp_ge_u32 s37, 7
    s_cselect_b32 s7, 7, 0
    s_sub_u32 s37, s37, s7
    v_lshrrev_b32 v10, 3, v1
    v_mul_u32_u24 v10, 896, v10
    v_bfe_u32 v11, v1, 4, 1
    v_lshlrev_b32 v11, 2, v11
    v_and_b32 v12, 7, v1
    v_xor_b32 v12, v12, v11
    v_lshl_add_u32 v232, v12, 4, v10
    v_add_u32 v233, 6144, v232
    v_add_u32 v234, 12288, v232
    v_add_u32 v235, 18432, v232
    v_bfe_u32 v10, v1, 2, 2
    v_lshrrev_b32 v11, 5, v1
    v_lshl_add_u32 v11, v11, 2, v10
    v_lshlrev_b32 v11, 7, v11
    v_and_b32 v12, 3, v1
    v_lshlrev_b32 v12, 3, v12
    v_bfe_u32 v13, v1, 4, 1
    v_lshl_add_u32 v12, v13, 5, v12
    v_add_u32 v11, v11, v12
    v_add_u32 v11, s17, v11
    v_lshrrev_b32 v10, 1, v10
    s_and_b32 s67, s64, 1
    v_xor_b32 v10, s67, v10
    v_lshlrev_b32 v10, 6, v10
    v_add_u32 v236, v11, v10
    v_xor_b32 v10, 64, v10
    v_add_u32 v237, v11, v10
    s_waitcnt vmcnt(21)
    ds_read_b128 a[0:3], v5 offset:0
    ds_read_b128 a[4:7], v6 offset:0
    ds_read_b128 a[8:11], v7 offset:0
    ds_read_b128 a[12:15], v8 offset:0
    s_waitcnt vmcnt(17)
    s_waitcnt lgkmcnt(0)
    s_barrier
    ds_read_b64_tr_b16 v[16:17], v177 offset:49152
    ds_read_b64_tr_b16 v[18:19], v177 offset:50176
    ds_read_b64_tr_b16 v[20:21], v180 offset:49152
    ds_read_b64_tr_b16 v[22:23], v180 offset:50176
    ds_read_b64_tr_b16 v[24:25], v183 offset:49152
    ds_read_b64_tr_b16 v[26:27], v183 offset:50176
    ds_read_b64_tr_b16 v[28:29], v186 offset:49152
    ds_read_b64_tr_b16 v[30:31], v186 offset:50176
    s_waitcnt lgkmcnt(0)
    v_mfma_f32_32x32x16_bf16 v[48:63], v[16:19], a[0:3], 0
    ds_read_b64_tr_b16 v[32:33], v177 offset:53248
    ds_read_b64_tr_b16 v[34:35], v177 offset:54272
    ds_read_b64_tr_b16 v[36:37], v180 offset:53248
    ds_read_b64_tr_b16 v[38:39], v180 offset:54272
    v_mfma_f32_32x32x16_bf16 v[64:79], v[20:23], a[0:3], 0
    ds_read_b64_tr_b16 v[40:41], v183 offset:53248
    ds_read_b64_tr_b16 v[42:43], v183 offset:54272
    ds_read_b64_tr_b16 v[44:45], v186 offset:53248
    ds_read_b64_tr_b16 v[46:47], v186 offset:54272
    v_mfma_f32_32x32x16_bf16 v[80:95], v[24:27], a[0:3], 0
    s_add_u32 m0, s72, 32768
    s_add_u32 s100, s3, 2
    s_cmp_ge_u32 s100, 7
    s_cselect_b32 s7, 7, 0
    s_sub_u32 s100, s100, s7
    s_lshl_b32 s100, s100, 7
    s_add_u32 s100, s100, s73
    buffer_load_dwordx4 v188, s[44:47], s100 offen offset:0 lds
    v_mfma_f32_32x32x16_bf16 v[96:111], v[28:31], a[0:3], 0
    buffer_load_dwordx4 v189, s[44:47], s100 offen offset:1024 lds
    s_waitcnt lgkmcnt(0)
    v_mfma_f32_32x32x16_bf16 v[48:63], v[32:35], a[4:7], v[48:63]
    ds_read_b64_tr_b16 v[16:17], v177 offset:57344
    ds_read_b64_tr_b16 v[18:19], v177 offset:58368
    ds_read_b64_tr_b16 v[20:21], v180 offset:57344
    ds_read_b64_tr_b16 v[22:23], v180 offset:58368
    v_mfma_f32_32x32x16_bf16 v[64:79], v[36:39], a[4:7], v[64:79]
    ds_read_b64_tr_b16 v[24:25], v183 offset:57344
    ds_read_b64_tr_b16 v[26:27], v183 offset:58368
    ds_read_b64_tr_b16 v[28:29], v186 offset:57344
    ds_read_b64_tr_b16 v[30:31], v186 offset:58368
    buffer_load_dwordx4 v190, s[44:47], s100 offen offset:2048 lds
    v_mfma_f32_32x32x16_bf16 v[80:95], v[40:43], a[4:7], v[80:95]
    buffer_load_dwordx4 v191, s[44:47], s100 offen offset:3072 lds
    v_mfma_f32_32x32x16_bf16 v[96:111], v[44:47], a[4:7], v[96:111]
    s_add_u32 m0, s72, 0
    s_add_u32 s101, s22, s74
    buffer_load_dwordx4 v208, s[48:51], s101 offen offset:0 lds
    s_waitcnt lgkmcnt(0)
    v_mfma_f32_32x32x16_bf16 v[48:63], v[16:19], a[8:11], v[48:63]
    ds_read_b64_tr_b16 v[32:33], v177 offset:61440
    ds_read_b64_tr_b16 v[34:35], v177 offset:62464
    ds_read_b64_tr_b16 v[36:37], v180 offset:61440
    ds_read_b64_tr_b16 v[38:39], v180 offset:62464
    buffer_load_dwordx4 v209, s[48:51], s101 offen offset:1024 lds
    s_waitcnt vmcnt(18)
    ds_read_b128 a[16:19], v5 offset:16384
    v_mfma_f32_32x32x16_bf16 v[64:79], v[20:23], a[8:11], v[64:79]
    ds_read_b64_tr_b16 v[40:41], v183 offset:61440
    ds_read_b64_tr_b16 v[42:43], v183 offset:62464
    ds_read_b64_tr_b16 v[44:45], v186 offset:61440
    ds_read_b64_tr_b16 v[46:47], v186 offset:62464
    buffer_load_dwordx4 v210, s[48:51], s101 offen offset:2048 lds
    ds_read_b128 a[20:23], v6 offset:16384
    v_mfma_f32_32x32x16_bf16 v[80:95], v[24:27], a[8:11], v[80:95]
    buffer_load_dwordx4 v211, s[48:51], s101 offen offset:3072 lds
    ds_read_b128 a[24:27], v7 offset:16384
    v_mfma_f32_32x32x16_bf16 v[96:111], v[28:31], a[8:11], v[96:111]
    ds_read_b128 a[28:31], v8 offset:16384
    s_waitcnt lgkmcnt(3)
    v_mfma_f32_32x32x16_bf16 v[48:63], v[32:35], a[12:15], v[48:63]
    s_waitcnt vmcnt(16)
    s_waitcnt lgkmcnt(0)
    s_barrier
    ds_read_b64_tr_b16 v[16:17], v178 offset:0
    ds_read_b64_tr_b16 v[18:19], v178 offset:1024
    ds_read_b64_tr_b16 v[20:21], v181 offset:0
    ds_read_b64_tr_b16 v[22:23], v181 offset:1024
    v_mfma_f32_32x32x16_bf16 v[64:79], v[36:39], a[12:15], v[64:79]
    ds_read_b64_tr_b16 v[24:25], v184 offset:0
    ds_read_b64_tr_b16 v[26:27], v184 offset:1024
    ds_read_b64_tr_b16 v[28:29], v187 offset:0
    ds_read_b64_tr_b16 v[30:31], v187 offset:1024
    v_mfma_f32_32x32x16_bf16 v[80:95], v[40:43], a[12:15], v[80:95]
    s_add_u32 m0, s72, 16384
    s_add_u32 s101, s23, s74
    buffer_load_dwordx4 v208, s[48:51], s101 offen offset:0 lds
    v_mfma_f32_32x32x16_bf16 v[96:111], v[44:47], a[12:15], v[96:111]
    buffer_load_dwordx4 v209, s[48:51], s101 offen offset:1024 lds
    s_waitcnt lgkmcnt(0)
    v_mfma_f32_32x32x16_bf16 v[48:63], v[16:19], a[16:19], v[48:63]
    ds_read_b64_tr_b16 v[32:33], v178 offset:4096
    ds_read_b64_tr_b16 v[34:35], v178 offset:5120
    ds_read_b64_tr_b16 v[36:37], v181 offset:4096
    ds_read_b64_tr_b16 v[38:39], v181 offset:5120
    v_mfma_f32_32x32x16_bf16 v[64:79], v[20:23], a[16:19], v[64:79]
    ds_read_b64_tr_b16 v[40:41], v184 offset:4096
    ds_read_b64_tr_b16 v[42:43], v184 offset:5120
    ds_read_b64_tr_b16 v[44:45], v187 offset:4096
    ds_read_b64_tr_b16 v[46:47], v187 offset:5120
    v_mfma_f32_32x32x16_bf16 v[80:95], v[24:27], a[16:19], v[80:95]
    buffer_load_dwordx4 v210, s[48:51], s101 offen offset:2048 lds
    v_mfma_f32_32x32x16_bf16 v[96:111], v[28:31], a[16:19], v[96:111]
    buffer_load_dwordx4 v211, s[48:51], s101 offen offset:3072 lds
    s_waitcnt lgkmcnt(0)
    v_mfma_f32_32x32x16_bf16 v[48:63], v[32:35], a[20:23], v[48:63]
    ds_read_b64_tr_b16 v[16:17], v178 offset:8192
    ds_read_b64_tr_b16 v[18:19], v178 offset:9216
    ds_read_b64_tr_b16 v[20:21], v181 offset:8192
    ds_read_b64_tr_b16 v[22:23], v181 offset:9216
    v_mfma_f32_32x32x16_bf16 v[64:79], v[36:39], a[20:23], v[64:79]
    ds_read_b64_tr_b16 v[24:25], v184 offset:8192
    ds_read_b64_tr_b16 v[26:27], v184 offset:9216
    ds_read_b64_tr_b16 v[28:29], v187 offset:8192
    ds_read_b64_tr_b16 v[30:31], v187 offset:9216
    v_mfma_f32_32x32x16_bf16 v[80:95], v[40:43], a[20:23], v[80:95]
    s_add_u32 m0, s72, 49152
    s_add_u32 s100, s3, 3
    s_cmp_ge_u32 s100, 7
    s_cselect_b32 s7, 7, 0
    s_sub_u32 s100, s100, s7
    s_lshl_b32 s100, s100, 7
    s_add_u32 s100, s100, s73
    buffer_load_dwordx4 v188, s[44:47], s100 offen offset:0 lds
    v_mfma_f32_32x32x16_bf16 v[96:111], v[44:47], a[20:23], v[96:111]
    buffer_load_dwordx4 v189, s[44:47], s100 offen offset:1024 lds
    s_waitcnt lgkmcnt(0)
    v_mfma_f32_32x32x16_bf16 v[48:63], v[16:19], a[24:27], v[48:63]
    ds_read_b64_tr_b16 v[32:33], v178 offset:12288
    ds_read_b64_tr_b16 v[34:35], v178 offset:13312
    ds_read_b64_tr_b16 v[36:37], v181 offset:12288
    ds_read_b64_tr_b16 v[38:39], v181 offset:13312
    s_waitcnt vmcnt(10)
    ds_read_b128 a[32:35], v5 offset:32768
    v_mfma_f32_32x32x16_bf16 v[64:79], v[20:23], a[24:27], v[64:79]
    ds_read_b64_tr_b16 v[40:41], v184 offset:12288
    ds_read_b64_tr_b16 v[42:43], v184 offset:13312
    ds_read_b64_tr_b16 v[44:45], v187 offset:12288
    ds_read_b64_tr_b16 v[46:47], v187 offset:13312
    buffer_load_dwordx4 v190, s[44:47], s100 offen offset:2048 lds
    ds_read_b128 a[36:39], v6 offset:32768
    v_mfma_f32_32x32x16_bf16 v[80:95], v[24:27], a[24:27], v[80:95]
    buffer_load_dwordx4 v191, s[44:47], s100 offen offset:3072 lds
    ds_read_b128 a[40:43], v7 offset:32768
    v_mfma_f32_32x32x16_bf16 v[96:111], v[28:31], a[24:27], v[96:111]
    ds_read_b128 a[44:47], v8 offset:32768
    s_waitcnt lgkmcnt(3)
    v_mfma_f32_32x32x16_bf16 v[48:63], v[32:35], a[28:31], v[48:63]
    s_waitcnt vmcnt(8)
    s_waitcnt lgkmcnt(0)
    s_barrier
    s_add_u32 m0, s72, 32768
    s_add_u32 s101, s24, s74
    ds_read_b64_tr_b16 v[16:17], v176 offset:0
    ds_read_b64_tr_b16 v[18:19], v176 offset:1024
    ds_read_b64_tr_b16 v[20:21], v179 offset:0
    ds_read_b64_tr_b16 v[22:23], v179 offset:1024
    buffer_load_dwordx4 v208, s[48:51], s101 offen offset:0 lds
    v_mfma_f32_32x32x16_bf16 v[64:79], v[36:39], a[28:31], v[64:79]
    ds_read_b64_tr_b16 v[24:25], v182 offset:0
    ds_read_b64_tr_b16 v[26:27], v182 offset:1024
    ds_read_b64_tr_b16 v[28:29], v185 offset:0
    ds_read_b64_tr_b16 v[30:31], v185 offset:1024
    buffer_load_dwordx4 v209, s[48:51], s101 offen offset:1024 lds
    v_mfma_f32_32x32x16_bf16 v[80:95], v[40:43], a[28:31], v[80:95]
    buffer_load_dwordx4 v210, s[48:51], s101 offen offset:2048 lds
    v_mfma_f32_32x32x16_bf16 v[96:111], v[44:47], a[28:31], v[96:111]
    buffer_load_dwordx4 v211, s[48:51], s101 offen offset:3072 lds
    s_waitcnt lgkmcnt(0)
    v_mfma_f32_32x32x16_bf16 v[48:63], v[16:19], a[32:35], v[48:63]
    s_add_u32 m0, s72, 65536
    s_add_u32 s100, s3, 4
    s_cmp_ge_u32 s100, 7
    s_cselect_b32 s7, 7, 0
    s_sub_u32 s100, s100, s7
    s_lshl_b32 s100, s100, 7
    s_add_u32 s100, s100, s73
    ds_read_b64_tr_b16 v[32:33], v176 offset:4096
    ds_read_b64_tr_b16 v[34:35], v176 offset:5120
    ds_read_b64_tr_b16 v[36:37], v179 offset:4096
    ds_read_b64_tr_b16 v[38:39], v179 offset:5120
    buffer_load_dwordx4 v188, s[44:47], s100 offen offset:0 lds
    v_mfma_f32_32x32x16_bf16 v[64:79], v[20:23], a[32:35], v[64:79]
    ds_read_b64_tr_b16 v[40:41], v182 offset:4096
    ds_read_b64_tr_b16 v[42:43], v182 offset:5120
    ds_read_b64_tr_b16 v[44:45], v185 offset:4096
    ds_read_b64_tr_b16 v[46:47], v185 offset:5120
    buffer_load_dwordx4 v189, s[44:47], s100 offen offset:1024 lds
    v_mfma_f32_32x32x16_bf16 v[80:95], v[24:27], a[32:35], v[80:95]
    buffer_load_dwordx4 v190, s[44:47], s100 offen offset:2048 lds
    v_mfma_f32_32x32x16_bf16 v[96:111], v[28:31], a[32:35], v[96:111]
    buffer_load_dwordx4 v191, s[44:47], s100 offen offset:3072 lds
    s_waitcnt lgkmcnt(0)
    v_mfma_f32_32x32x16_bf16 v[48:63], v[32:35], a[36:39], v[48:63]
    s_add_u32 m0, s72, 114688
    s_add_u32 s101, s25, s74
    ds_read_b64_tr_b16 v[16:17], v176 offset:8192
    ds_read_b64_tr_b16 v[18:19], v176 offset:9216
    ds_read_b64_tr_b16 v[20:21], v179 offset:8192
    ds_read_b64_tr_b16 v[22:23], v179 offset:9216
    buffer_load_dwordx4 v208, s[48:51], s101 offen offset:0 lds
    v_mfma_f32_32x32x16_bf16 v[64:79], v[36:39], a[36:39], v[64:79]
    ds_read_b64_tr_b16 v[24:25], v182 offset:8192
    ds_read_b64_tr_b16 v[26:27], v182 offset:9216
    ds_read_b64_tr_b16 v[28:29], v185 offset:8192
    ds_read_b64_tr_b16 v[30:31], v185 offset:9216
    buffer_load_dwordx4 v209, s[48:51], s101 offen offset:1024 lds
    v_mfma_f32_32x32x16_bf16 v[80:95], v[40:43], a[36:39], v[80:95]
    buffer_load_dwordx4 v210, s[48:51], s101 offen offset:2048 lds
    v_mfma_f32_32x32x16_bf16 v[96:111], v[44:47], a[36:39], v[96:111]
    buffer_load_dwordx4 v211, s[48:51], s101 offen offset:3072 lds
    s_waitcnt lgkmcnt(0)
    v_mfma_f32_32x32x16_bf16 v[48:63], v[16:19], a[40:43], v[48:63]
    s_add_u32 m0, s72, 81920
    s_add_u32 s100, s3, 5
    s_cmp_ge_u32 s100, 7
    s_cselect_b32 s7, 7, 0
    s_sub_u32 s100, s100, s7
    s_lshl_b32 s100, s100, 7
    s_add_u32 s100, s100, s73
    ds_read_b64_tr_b16 v[32:33], v176 offset:12288
    ds_read_b64_tr_b16 v[34:35], v176 offset:13312
    ds_read_b64_tr_b16 v[36:37], v179 offset:12288
    ds_read_b64_tr_b16 v[38:39], v179 offset:13312
    buffer_load_dwordx4 v188, s[44:47], s100 offen offset:0 lds
    s_waitcnt vmcnt(13)
    ds_read_b128 a[48:51], v5 offset:49152
    v_mfma_f32_32x32x16_bf16 v[64:79], v[20:23], a[40:43], v[64:79]
    ds_read_b64_tr_b16 v[40:41], v182 offset:12288
    ds_read_b64_tr_b16 v[42:43], v182 offset:13312
    ds_read_b64_tr_b16 v[44:45], v185 offset:12288
    ds_read_b64_tr_b16 v[46:47], v185 offset:13312
    buffer_load_dwordx4 v189, s[44:47], s100 offen offset:1024 lds
    ds_read_b128 a[52:55], v6 offset:49152
    v_mfma_f32_32x32x16_bf16 v[80:95], v[24:27], a[40:43], v[80:95]
    buffer_load_dwordx4 v190, s[44:47], s100 offen offset:2048 lds
    ds_read_b128 a[56:59], v7 offset:49152
    v_mfma_f32_32x32x16_bf16 v[96:111], v[28:31], a[40:43], v[96:111]
    buffer_load_dwordx4 v191, s[44:47], s100 offen offset:3072 lds
    ds_read_b128 a[60:63], v8 offset:49152
    s_waitcnt lgkmcnt(3)
    v_mfma_f32_32x32x16_bf16 v[48:63], v[32:35], a[44:47], v[48:63]
    s_barrier
    ds_read_b64_tr_b16 v[16:17], v176 offset:16384
    ds_read_b64_tr_b16 v[18:19], v176 offset:17408
    ds_read_b64_tr_b16 v[20:21], v179 offset:16384
    ds_read_b64_tr_b16 v[22:23], v179 offset:17408
    v_mfma_f32_32x32x16_bf16 v[64:79], v[36:39], a[44:47], v[64:79]
    ds_read_b64_tr_b16 v[24:25], v182 offset:16384
    ds_read_b64_tr_b16 v[26:27], v182 offset:17408
    ds_read_b64_tr_b16 v[28:29], v185 offset:16384
    ds_read_b64_tr_b16 v[30:31], v185 offset:17408
    v_mfma_f32_32x32x16_bf16 v[80:95], v[40:43], a[44:47], v[80:95]
    s_add_u32 m0, s72, 131072
    s_add_u32 s101, s28, s74
    buffer_load_dwordx4 v208, s[48:51], s101 offen offset:0 lds
    v_mfma_f32_32x32x16_bf16 v[96:111], v[44:47], a[44:47], v[96:111]
    buffer_load_dwordx4 v209, s[48:51], s101 offen offset:1024 lds
    s_waitcnt lgkmcnt(0)
    v_mfma_f32_32x32x16_bf16 v[48:63], v[16:19], a[48:51], v[48:63]
    ds_read_b64_tr_b16 v[32:33], v176 offset:20480
    ds_read_b64_tr_b16 v[34:35], v176 offset:21504
    ds_read_b64_tr_b16 v[36:37], v179 offset:20480
    ds_read_b64_tr_b16 v[38:39], v179 offset:21504
    v_mfma_f32_32x32x16_bf16 v[64:79], v[20:23], a[48:51], v[64:79]
    ds_read_b64_tr_b16 v[40:41], v182 offset:20480
    ds_read_b64_tr_b16 v[42:43], v182 offset:21504
    ds_read_b64_tr_b16 v[44:45], v185 offset:20480
    ds_read_b64_tr_b16 v[46:47], v185 offset:21504
    v_mfma_f32_32x32x16_bf16 v[80:95], v[24:27], a[48:51], v[80:95]
    buffer_load_dwordx4 v210, s[48:51], s101 offen offset:2048 lds
    v_mfma_f32_32x32x16_bf16 v[96:111], v[28:31], a[48:51], v[96:111]
    buffer_load_dwordx4 v211, s[48:51], s101 offen offset:3072 lds
    s_waitcnt lgkmcnt(0)
    v_mfma_f32_32x32x16_bf16 v[48:63], v[32:35], a[52:55], v[48:63]
    ds_read_b64_tr_b16 v[16:17], v176 offset:24576
    ds_read_b64_tr_b16 v[18:19], v176 offset:25600
    ds_read_b64_tr_b16 v[20:21], v179 offset:24576
    ds_read_b64_tr_b16 v[22:23], v179 offset:25600
    v_mfma_f32_32x32x16_bf16 v[64:79], v[36:39], a[52:55], v[64:79]
    ds_read_b64_tr_b16 v[24:25], v182 offset:24576
    ds_read_b64_tr_b16 v[26:27], v182 offset:25600
    ds_read_b64_tr_b16 v[28:29], v185 offset:24576
    ds_read_b64_tr_b16 v[30:31], v185 offset:25600
    v_mfma_f32_32x32x16_bf16 v[80:95], v[40:43], a[52:55], v[80:95]
    s_add_u32 m0, s72, 98304
    s_add_u32 s100, s3, 6
    s_cmp_ge_u32 s100, 7
    s_cselect_b32 s7, 7, 0
    s_sub_u32 s100, s100, s7
    s_lshl_b32 s100, s100, 7
    s_add_u32 s100, s100, s73
    buffer_load_dwordx4 v188, s[44:47], s100 offen offset:0 lds
    v_mfma_f32_32x32x16_bf16 v[96:111], v[44:47], a[52:55], v[96:111]
    buffer_load_dwordx4 v189, s[44:47], s100 offen offset:1024 lds
    s_waitcnt lgkmcnt(0)
    v_mfma_f32_32x32x16_bf16 v[48:63], v[16:19], a[56:59], v[48:63]
    ds_read_b64_tr_b16 v[32:33], v176 offset:28672
    ds_read_b64_tr_b16 v[34:35], v176 offset:29696
    ds_read_b64_tr_b16 v[36:37], v179 offset:28672
    ds_read_b64_tr_b16 v[38:39], v179 offset:29696
    s_waitcnt vmcnt(14)
    v_add_u32 v5, 0x10000, v5
    v_add_u32 v6, 0x10000, v6
    v_add_u32 v7, 0x10000, v7
    v_add_u32 v8, 0x10000, v8
    ds_read_b128 a[64:67], v5 offset:0
    v_mfma_f32_32x32x16_bf16 v[64:79], v[20:23], a[56:59], v[64:79]
    ds_read_b64_tr_b16 v[40:41], v182 offset:28672
    ds_read_b64_tr_b16 v[42:43], v182 offset:29696
    ds_read_b64_tr_b16 v[44:45], v185 offset:28672
    ds_read_b64_tr_b16 v[46:47], v185 offset:29696
    buffer_load_dwordx4 v190, s[44:47], s100 offen offset:2048 lds
    ds_read_b128 a[68:71], v6 offset:0
    v_mfma_f32_32x32x16_bf16 v[80:95], v[24:27], a[56:59], v[80:95]
    buffer_load_dwordx4 v191, s[44:47], s100 offen offset:3072 lds
    ds_read_b128 a[72:75], v7 offset:0
    v_mfma_f32_32x32x16_bf16 v[96:111], v[28:31], a[56:59], v[96:111]
    ds_read_b128 a[76:79], v8 offset:0
    s_waitcnt lgkmcnt(3)
    v_mfma_f32_32x32x16_bf16 v[48:63], v[32:35], a[60:63], v[48:63]
    s_barrier
    ds_read_b64_tr_b16 v[16:17], v176 offset:32768
    ds_read_b64_tr_b16 v[18:19], v176 offset:33792
    ds_read_b64_tr_b16 v[20:21], v179 offset:32768
    ds_read_b64_tr_b16 v[22:23], v179 offset:33792
    v_mfma_f32_32x32x16_bf16 v[64:79], v[36:39], a[60:63], v[64:79]
    ds_read_b64_tr_b16 v[24:25], v182 offset:32768
    ds_read_b64_tr_b16 v[26:27], v182 offset:33792
    ds_read_b64_tr_b16 v[28:29], v185 offset:32768
    ds_read_b64_tr_b16 v[30:31], v185 offset:33792
    v_mfma_f32_32x32x16_bf16 v[80:95], v[40:43], a[60:63], v[80:95]
    v_mfma_f32_32x32x16_bf16 v[96:111], v[44:47], a[60:63], v[96:111]
    s_waitcnt lgkmcnt(0)
    v_mfma_f32_32x32x16_bf16 v[48:63], v[16:19], a[64:67], v[48:63]
    ds_read_b64_tr_b16 v[32:33], v176 offset:36864
    ds_read_b64_tr_b16 v[34:35], v176 offset:37888
    ds_read_b64_tr_b16 v[36:37], v179 offset:36864
    ds_read_b64_tr_b16 v[38:39], v179 offset:37888
    v_mfma_f32_32x32x16_bf16 v[64:79], v[20:23], a[64:67], v[64:79]
    ds_read_b64_tr_b16 v[40:41], v182 offset:36864
    ds_read_b64_tr_b16 v[42:43], v182 offset:37888
    ds_read_b64_tr_b16 v[44:45], v185 offset:36864
    ds_read_b64_tr_b16 v[46:47], v185 offset:37888
    v_mfma_f32_32x32x16_bf16 v[80:95], v[24:27], a[64:67], v[80:95]
    v_mfma_f32_32x32x16_bf16 v[96:111], v[28:31], a[64:67], v[96:111]
    s_add_u32 m0, s72, 0
    s_add_u32 s101, s20, s75
    buffer_load_dwordx4 v208, s[48:51], s101 offen offset:0 lds
    s_waitcnt lgkmcnt(0)
    v_mfma_f32_32x32x16_bf16 v[48:63], v[32:35], a[68:71], v[48:63]
    ds_read_b64_tr_b16 v[16:17], v176 offset:40960
    ds_read_b64_tr_b16 v[18:19], v176 offset:41984
    ds_read_b64_tr_b16 v[20:21], v179 offset:40960
    ds_read_b64_tr_b16 v[22:23], v179 offset:41984
    v_mfma_f32_32x32x16_bf16 v[64:79], v[36:39], a[68:71], v[64:79]
    ds_read_b64_tr_b16 v[24:25], v182 offset:40960
    ds_read_b64_tr_b16 v[26:27], v182 offset:41984
    ds_read_b64_tr_b16 v[28:29], v185 offset:40960
    ds_read_b64_tr_b16 v[30:31], v185 offset:41984
    v_mfma_f32_32x32x16_bf16 v[80:95], v[40:43], a[68:71], v[80:95]
    buffer_load_dwordx4 v209, s[48:51], s101 offen offset:1024 lds
    v_mfma_f32_32x32x16_bf16 v[96:111], v[44:47], a[68:71], v[96:111]
    s_waitcnt lgkmcnt(0)
    v_mfma_f32_32x32x16_bf16 v[48:63], v[16:19], a[72:75], v[48:63]
    ds_read_b64_tr_b16 v[32:33], v176 offset:45056
    ds_read_b64_tr_b16 v[34:35], v176 offset:46080
    ds_read_b64_tr_b16 v[36:37], v179 offset:45056
    ds_read_b64_tr_b16 v[38:39], v179 offset:46080
    s_waitcnt vmcnt(10)
    ds_read_b128 a[80:83], v5 offset:16384
    v_mfma_f32_32x32x16_bf16 v[64:79], v[20:23], a[72:75], v[64:79]
    ds_read_b64_tr_b16 v[40:41], v182 offset:45056
    ds_read_b64_tr_b16 v[42:43], v182 offset:46080
    ds_read_b64_tr_b16 v[44:45], v185 offset:45056
    ds_read_b64_tr_b16 v[46:47], v185 offset:46080
    buffer_load_dwordx4 v210, s[48:51], s101 offen offset:2048 lds
    ds_read_b128 a[84:87], v6 offset:16384
    v_mfma_f32_32x32x16_bf16 v[80:95], v[24:27], a[72:75], v[80:95]
    buffer_load_dwordx4 v211, s[48:51], s101 offen offset:3072 lds
    ds_read_b128 a[88:91], v7 offset:16384
    v_mfma_f32_32x32x16_bf16 v[96:111], v[28:31], a[72:75], v[96:111]
    ds_read_b128 a[92:95], v8 offset:16384
    s_waitcnt lgkmcnt(3)
    v_mfma_f32_32x32x16_bf16 v[48:63], v[32:35], a[76:79], v[48:63]
    s_barrier
    ds_read_b64_tr_b16 v[16:17], v177 offset:49152
    ds_read_b64_tr_b16 v[18:19], v177 offset:50176
    ds_read_b64_tr_b16 v[20:21], v180 offset:49152
    ds_read_b64_tr_b16 v[22:23], v180 offset:50176
    v_mfma_f32_32x32x16_bf16 v[64:79], v[36:39], a[76:79], v[64:79]
    ds_read_b64_tr_b16 v[24:25], v183 offset:49152
    ds_read_b64_tr_b16 v[26:27], v183 offset:50176
    ds_read_b64_tr_b16 v[28:29], v186 offset:49152
    ds_read_b64_tr_b16 v[30:31], v186 offset:50176
    v_mfma_f32_32x32x16_bf16 v[80:95], v[40:43], a[76:79], v[80:95]
    v_mfma_f32_32x32x16_bf16 v[96:111], v[44:47], a[76:79], v[96:111]
    s_waitcnt lgkmcnt(0)
    v_mfma_f32_32x32x16_bf16 v[48:63], v[16:19], a[80:83], v[48:63]
    ds_read_b64_tr_b16 v[32:33], v177 offset:53248
    ds_read_b64_tr_b16 v[34:35], v177 offset:54272
    ds_read_b64_tr_b16 v[36:37], v180 offset:53248
    ds_read_b64_tr_b16 v[38:39], v180 offset:54272
    v_mfma_f32_32x32x16_bf16 v[64:79], v[20:23], a[80:83], v[64:79]
    ds_read_b64_tr_b16 v[40:41], v183 offset:53248
    ds_read_b64_tr_b16 v[42:43], v183 offset:54272
    ds_read_b64_tr_b16 v[44:45], v186 offset:53248
    ds_read_b64_tr_b16 v[46:47], v186 offset:54272
    v_mfma_f32_32x32x16_bf16 v[80:95], v[24:27], a[80:83], v[80:95]
    v_mfma_f32_32x32x16_bf16 v[96:111], v[28:31], a[80:83], v[96:111]
    s_add_u32 m0, s72, 16384
    s_add_u32 s101, s21, s75
    buffer_load_dwordx4 v208, s[48:51], s101 offen offset:0 lds
    v_mov_b32 v243, 0
    buffer_load_dword v243, v243, s[8:11], 0 offen sc1
    s_waitcnt lgkmcnt(0)
    v_mfma_f32_32x32x16_bf16 v[48:63], v[32:35], a[84:87], v[48:63]
    ds_read_b64_tr_b16 v[16:17], v177 offset:57344
    ds_read_b64_tr_b16 v[18:19], v177 offset:58368
    ds_read_b64_tr_b16 v[20:21], v180 offset:57344
    ds_read_b64_tr_b16 v[22:23], v180 offset:58368
    v_mfma_f32_32x32x16_bf16 v[64:79], v[36:39], a[84:87], v[64:79]
    ds_read_b64_tr_b16 v[24:25], v183 offset:57344
    ds_read_b64_tr_b16 v[26:27], v183 offset:58368
    ds_read_b64_tr_b16 v[28:29], v186 offset:57344
    ds_read_b64_tr_b16 v[30:31], v186 offset:58368
    v_mfma_f32_32x32x16_bf16 v[80:95], v[40:43], a[84:87], v[80:95]
    buffer_load_dwordx4 v209, s[48:51], s101 offen offset:1024 lds
    v_mfma_f32_32x32x16_bf16 v[96:111], v[44:47], a[84:87], v[96:111]
    s_waitcnt lgkmcnt(0)
    v_mfma_f32_32x32x16_bf16 v[48:63], v[16:19], a[88:91], v[48:63]
    ds_read_b64_tr_b16 v[32:33], v177 offset:61440
    ds_read_b64_tr_b16 v[34:35], v177 offset:62464
    ds_read_b64_tr_b16 v[36:37], v180 offset:61440
    ds_read_b64_tr_b16 v[38:39], v180 offset:62464
    s_waitcnt vmcnt(7)
    ds_read_b128 a[96:99], v5 offset:32768
    v_mfma_f32_32x32x16_bf16 v[64:79], v[20:23], a[88:91], v[64:79]
    ds_read_b64_tr_b16 v[40:41], v183 offset:61440
    ds_read_b64_tr_b16 v[42:43], v183 offset:62464
    ds_read_b64_tr_b16 v[44:45], v186 offset:61440
    ds_read_b64_tr_b16 v[46:47], v186 offset:62464
    buffer_load_dwordx4 v210, s[48:51], s101 offen offset:2048 lds
    ds_read_b128 a[100:103], v6 offset:32768
    v_mfma_f32_32x32x16_bf16 v[80:95], v[24:27], a[88:91], v[80:95]
    buffer_load_dwordx4 v211, s[48:51], s101 offen offset:3072 lds
    ds_read_b128 a[104:107], v7 offset:32768
    v_mfma_f32_32x32x16_bf16 v[96:111], v[28:31], a[88:91], v[96:111]
    ds_read_b128 a[108:111], v8 offset:32768
    s_waitcnt lgkmcnt(3)
    v_mfma_f32_32x32x16_bf16 v[48:63], v[32:35], a[92:95], v[48:63]
    s_barrier
    ds_read_b64_tr_b16 v[16:17], v178 offset:0
    ds_read_b64_tr_b16 v[18:19], v178 offset:1024
    ds_read_b64_tr_b16 v[20:21], v181 offset:0
    ds_read_b64_tr_b16 v[22:23], v181 offset:1024
    v_mfma_f32_32x32x16_bf16 v[64:79], v[36:39], a[92:95], v[64:79]
    ds_read_b64_tr_b16 v[24:25], v184 offset:0
    ds_read_b64_tr_b16 v[26:27], v184 offset:1024
    ds_read_b64_tr_b16 v[28:29], v187 offset:0
    ds_read_b64_tr_b16 v[30:31], v187 offset:1024
    v_mfma_f32_32x32x16_bf16 v[80:95], v[40:43], a[92:95], v[80:95]
    v_mfma_f32_32x32x16_bf16 v[96:111], v[44:47], a[92:95], v[96:111]
    s_waitcnt lgkmcnt(0)
    v_mfma_f32_32x32x16_bf16 v[48:63], v[16:19], a[96:99], v[48:63]
    ds_read_b64_tr_b16 v[32:33], v178 offset:4096
    ds_read_b64_tr_b16 v[34:35], v178 offset:5120
    ds_read_b64_tr_b16 v[36:37], v181 offset:4096
    ds_read_b64_tr_b16 v[38:39], v181 offset:5120
    v_mfma_f32_32x32x16_bf16 v[64:79], v[20:23], a[96:99], v[64:79]
    s_add_u32 m0, s17, 0
    s_mul_i32 s26, s29, 229376
    s_add_u32 s26, s26, s16
    ds_read_b64_tr_b16 v[40:41], v184 offset:4096
    ds_read_b64_tr_b16 v[42:43], v184 offset:5120
    ds_read_b64_tr_b16 v[44:45], v187 offset:4096
    ds_read_b64_tr_b16 v[46:47], v187 offset:5120
    buffer_load_dwordx4 v232, s[56:59], s26 offen offset:0 lds
    v_mfma_f32_32x32x16_bf16 v[80:95], v[24:27], a[96:99], v[80:95]
    v_mfma_f32_32x32x16_bf16 v[96:111], v[28:31], a[96:99], v[96:111]
    s_add_u32 m0, s72, 32768
    s_add_u32 s101, s22, s75
    buffer_load_dwordx4 v208, s[48:51], s101 offen offset:0 lds
    s_waitcnt lgkmcnt(0)
    v_mfma_f32_32x32x16_bf16 v[48:63], v[32:35], a[100:103], v[48:63]
    ds_read_b64_tr_b16 v[16:17], v178 offset:8192
    ds_read_b64_tr_b16 v[18:19], v178 offset:9216
    ds_read_b64_tr_b16 v[20:21], v181 offset:8192
    ds_read_b64_tr_b16 v[22:23], v181 offset:9216
    v_mfma_f32_32x32x16_bf16 v[64:79], v[36:39], a[100:103], v[64:79]
    s_add_u32 m0, s17, 0
    ds_read_b64_tr_b16 v[24:25], v184 offset:8192
    ds_read_b64_tr_b16 v[26:27], v184 offset:9216
    ds_read_b64_tr_b16 v[28:29], v187 offset:8192
    ds_read_b64_tr_b16 v[30:31], v187 offset:9216
    buffer_load_dwordx4 v233, s[56:59], s26 offen offset:1024 lds
    v_mfma_f32_32x32x16_bf16 v[80:95], v[40:43], a[100:103], v[80:95]
    s_add_u32 m0, s72, 32768
    s_nop 0
    buffer_load_dwordx4 v209, s[48:51], s101 offen offset:1024 lds
    v_mfma_f32_32x32x16_bf16 v[96:111], v[44:47], a[100:103], v[96:111]
    s_waitcnt lgkmcnt(0)
    v_mfma_f32_32x32x16_bf16 v[48:63], v[16:19], a[104:107], v[48:63]
    ds_read_b64_tr_b16 v[32:33], v178 offset:12288
    ds_read_b64_tr_b16 v[34:35], v178 offset:13312
    ds_read_b64_tr_b16 v[36:37], v181 offset:12288
    ds_read_b64_tr_b16 v[38:39], v181 offset:13312
    v_mfma_f32_32x32x16_bf16 v[64:79], v[20:23], a[104:107], v[64:79]
    ds_read_b64_tr_b16 v[40:41], v184 offset:12288
    ds_read_b64_tr_b16 v[42:43], v184 offset:13312
    ds_read_b64_tr_b16 v[44:45], v187 offset:12288
    ds_read_b64_tr_b16 v[46:47], v187 offset:13312
    buffer_load_dwordx4 v210, s[48:51], s101 offen offset:2048 lds
    v_mfma_f32_32x32x16_bf16 v[80:95], v[24:27], a[104:107], v[80:95]
    buffer_load_dwordx4 v211, s[48:51], s101 offen offset:3072 lds
    v_mfma_f32_32x32x16_bf16 v[96:111], v[28:31], a[104:107], v[96:111]
    s_add_u32 m0, s17, 0
    s_nop 0
    buffer_load_dwordx4 v234, s[56:59], s26 offen offset:2048 lds
    s_waitcnt lgkmcnt(0)
    v_mfma_f32_32x32x16_bf16 v[48:63], v[32:35], a[108:111], v[48:63]
    s_waitcnt vmcnt(12)
    s_barrier
    ds_read_b64_tr_b16 v[16:17], v176 offset:0
    ds_read_b64_tr_b16 v[18:19], v176 offset:1024
    ds_read_b64_tr_b16 v[20:21], v179 offset:0
    ds_read_b64_tr_b16 v[22:23], v179 offset:1024
    v_mfma_f32_32x32x16_bf16 v[64:79], v[36:39], a[108:111], v[64:79]
    ds_read_b64_tr_b16 v[24:25], v182 offset:0
    ds_read_b64_tr_b16 v[26:27], v182 offset:1024
    ds_read_b64_tr_b16 v[28:29], v185 offset:0
    ds_read_b64_tr_b16 v[30:31], v185 offset:1024
    buffer_load_dwordx4 v235, s[56:59], s26 offen offset:3072 lds
    v_mfma_f32_32x32x16_bf16 v[80:95], v[40:43], a[108:111], v[80:95]
    v_mfma_f32_32x32x16_bf16 v[96:111], v[44:47], a[108:111], v[96:111]
    v_mov_b32 v252, v244
    s_nop 1
    v_mfma_f32_32x32x16_bf16 v[48:63], v[252:255], a[248:251], v[48:63]
    v_mov_b32 v252, v245
    s_nop 1
    v_mfma_f32_32x32x16_bf16 v[64:79], v[252:255], a[248:251], v[64:79]
    v_mov_b32 v252, v246
    s_nop 1
    v_mfma_f32_32x32x16_bf16 v[80:95], v[252:255], a[248:251], v[80:95]
    v_mov_b32 v252, v247
    s_nop 1
    v_mfma_f32_32x32x16_bf16 v[96:111], v[252:255], a[248:251], v[96:111]
    s_waitcnt lgkmcnt(0)
    v_mfma_f32_32x32x16_bf16 v[112:127], v[16:19], a[0:3], 0
    ds_read_b64_tr_b16 v[32:33], v176 offset:4096
    ds_read_b64_tr_b16 v[34:35], v176 offset:5120
    ds_read_b64_tr_b16 v[36:37], v179 offset:4096
    ds_read_b64_tr_b16 v[38:39], v179 offset:5120
    v_max_f32 v48, 0, v48
    v_mfma_f32_32x32x16_bf16 v[128:143], v[20:23], a[0:3], 0
    s_add_u32 m0, s17, 4096
    s_mul_i32 s26, s30, 229376
    s_add_u32 s26, s26, s16
    ds_read_b64_tr_b16 v[40:41], v182 offset:4096
    ds_read_b64_tr_b16 v[42:43], v182 offset:5120
    ds_read_b64_tr_b16 v[44:45], v185 offset:4096
    ds_read_b64_tr_b16 v[46:47], v185 offset:5120
    buffer_load_dwordx4 v232, s[56:59], s26 offen offset:0 lds
    v_mfma_f32_32x32x16_bf16 v[144:159], v[24:27], a[0:3], 0
    v_max_f32 v49, 0, v49
    v_max_f32 v50, 0, v50
    v_max_f32 v51, 0, v51
    v_pk_mul_f32 v[48:49], v[48:49], v[48:49]
    v_pk_mul_f32 v[50:51], v[50:51], v[50:51]
    v_mfma_f32_32x32x16_bf16 v[160:175], v[28:31], a[0:3], 0
    s_add_u32 m0, s72, 114688
    s_add_u32 s101, s23, s75
    buffer_load_dwordx4 v208, s[48:51], s101 offen offset:0 lds
    v_cvt_pk_bf16_f32 v188, v48, v49
    v_cvt_pk_bf16_f32 v189, v50, v51
    v_max_f32 v52, 0, v52
    v_max_f32 v53, 0, v53
    s_waitcnt lgkmcnt(0)
    v_mfma_f32_32x32x16_bf16 v[112:127], v[32:35], a[4:7], v[112:127]
    ds_read_b64_tr_b16 v[16:17], v176 offset:8192
    ds_read_b64_tr_b16 v[18:19], v176 offset:9216
    ds_read_b64_tr_b16 v[20:21], v179 offset:8192
    ds_read_b64_tr_b16 v[22:23], v179 offset:9216
    v_max_f32 v54, 0, v54
    v_mfma_f32_32x32x16_bf16 v[128:143], v[36:39], a[4:7], v[128:143]
    s_add_u32 m0, s17, 4096
    ds_read_b64_tr_b16 v[24:25], v182 offset:8192
    ds_read_b64_tr_b16 v[26:27], v182 offset:9216
    ds_read_b64_tr_b16 v[28:29], v185 offset:8192
    ds_read_b64_tr_b16 v[30:31], v185 offset:9216
    buffer_load_dwordx4 v233, s[56:59], s26 offen offset:1024 lds
    v_mfma_f32_32x32x16_bf16 v[144:159], v[40:43], a[4:7], v[144:159]
    s_add_u32 m0, s72, 114688
    s_nop 0
    buffer_load_dwordx4 v209, s[48:51], s101 offen offset:1024 lds
    v_max_f32 v55, 0, v55
    v_pk_mul_f32 v[52:53], v[52:53], v[52:53]
    v_pk_mul_f32 v[54:55], v[54:55], v[54:55]
    v_cvt_pk_bf16_f32 v190, v52, v53
    v_mfma_f32_32x32x16_bf16 v[160:175], v[44:47], a[4:7], v[160:175]
    v_cvt_pk_bf16_f32 v191, v54, v55
    v_max_f32 v56, 0, v56
    v_max_f32 v57, 0, v57
    v_max_f32 v58, 0, v58
    v_max_f32 v59, 0, v59
    s_waitcnt lgkmcnt(0)
    v_mfma_f32_32x32x16_bf16 v[112:127], v[16:19], a[8:11], v[112:127]
    ds_read_b64_tr_b16 v[32:33], v176 offset:12288
    ds_read_b64_tr_b16 v[34:35], v176 offset:13312
    ds_read_b64_tr_b16 v[36:37], v179 offset:12288
    ds_read_b64_tr_b16 v[38:39], v179 offset:13312
    v_pk_mul_f32 v[56:57], v[56:57], v[56:57]
    v_mfma_f32_32x32x16_bf16 v[128:143], v[20:23], a[8:11], v[128:143]
    ds_read_b64_tr_b16 v[40:41], v182 offset:12288
    ds_read_b64_tr_b16 v[42:43], v182 offset:13312
    ds_read_b64_tr_b16 v[44:45], v185 offset:12288
    ds_read_b64_tr_b16 v[46:47], v185 offset:13312
    buffer_load_dwordx4 v210, s[48:51], s101 offen offset:2048 lds
    v_mfma_f32_32x32x16_bf16 v[144:159], v[24:27], a[8:11], v[144:159]
    buffer_load_dwordx4 v211, s[48:51], s101 offen offset:3072 lds
    v_pk_mul_f32 v[58:59], v[58:59], v[58:59]
    v_cvt_pk_bf16_f32 v192, v56, v57
    v_cvt_pk_bf16_f32 v193, v58, v59
    v_max_f32 v60, 0, v60
    v_mfma_f32_32x32x16_bf16 v[160:175], v[28:31], a[8:11], v[160:175]
    s_add_u32 m0, s17, 4096
    s_nop 0
    buffer_load_dwordx4 v234, s[56:59], s26 offen offset:2048 lds
    v_max_f32 v61, 0, v61
    v_max_f32 v62, 0, v62
    v_max_f32 v63, 0, v63
    v_pk_mul_f32 v[60:61], v[60:61], v[60:61]
    s_waitcnt lgkmcnt(0)
    v_mfma_f32_32x32x16_bf16 v[112:127], v[32:35], a[12:15], v[112:127]
    s_waitcnt vmcnt(15)
    s_barrier
    ds_read_b64_tr_b16 v[16:17], v176 offset:16384
    ds_read_b64_tr_b16 v[18:19], v176 offset:17408
    ds_read_b64_tr_b16 v[20:21], v179 offset:16384
    ds_read_b64_tr_b16 v[22:23], v179 offset:17408
    v_pk_mul_f32 v[62:63], v[62:63], v[62:63]
    v_mfma_f32_32x32x16_bf16 v[128:143], v[36:39], a[12:15], v[128:143]
    ds_read_b64_tr_b16 v[24:25], v182 offset:16384
    ds_read_b64_tr_b16 v[26:27], v182 offset:17408
    ds_read_b64_tr_b16 v[28:29], v185 offset:16384
    ds_read_b64_tr_b16 v[30:31], v185 offset:17408
    buffer_load_dwordx4 v235, s[56:59], s26 offen offset:3072 lds
    v_mfma_f32_32x32x16_bf16 v[144:159], v[40:43], a[12:15], v[144:159]
    v_cvt_pk_bf16_f32 v194, v60, v61
    v_cvt_pk_bf16_f32 v195, v62, v63
    s_add_u32 s68, s80, 0
    buffer_store_dwordx4 v[188:191], v9, s[52:55], s68 offen sc1
    buffer_store_dwordx4 v[192:195], v9, s[52:55], s68 offen offset:1024 sc1
    v_max_f32 v64, 0, v64
    v_max_f32 v65, 0, v65
    v_mfma_f32_32x32x16_bf16 v[160:175], v[44:47], a[12:15], v[160:175]
    v_max_f32 v66, 0, v66
    v_max_f32 v67, 0, v67
    v_pk_mul_f32 v[64:65], v[64:65], v[64:65]
    v_pk_mul_f32 v[66:67], v[66:67], v[66:67]
    v_cvt_pk_bf16_f32 v196, v64, v65
    s_waitcnt lgkmcnt(0)
    v_mfma_f32_32x32x16_bf16 v[112:127], v[16:19], a[16:19], v[112:127]
    ds_read_b64_tr_b16 v[32:33], v176 offset:20480
    ds_read_b64_tr_b16 v[34:35], v176 offset:21504
    ds_read_b64_tr_b16 v[36:37], v179 offset:20480
    ds_read_b64_tr_b16 v[38:39], v179 offset:21504
    v_cvt_pk_bf16_f32 v197, v66, v67
    v_mfma_f32_32x32x16_bf16 v[128:143], v[20:23], a[16:19], v[128:143]
    s_add_u32 m0, s17, 8192
    s_mul_i32 s26, s31, 229376
    s_add_u32 s26, s26, s16
    ds_read_b64_tr_b16 v[40:41], v182 offset:20480
    ds_read_b64_tr_b16 v[42:43], v182 offset:21504
    ds_read_b64_tr_b16 v[44:45], v185 offset:20480
    ds_read_b64_tr_b16 v[46:47], v185 offset:21504
    buffer_load_dwordx4 v232, s[56:59], s26 offen offset:0 lds
    v_mfma_f32_32x32x16_bf16 v[144:159], v[24:27], a[16:19], v[144:159]
    v_max_f32 v68, 0, v68
    v_max_f32 v69, 0, v69
    v_max_f32 v70, 0, v70
    v_max_f32 v71, 0, v71
    v_pk_mul_f32 v[68:69], v[68:69], v[68:69]
    v_mfma_f32_32x32x16_bf16 v[160:175], v[28:31], a[16:19], v[160:175]
    s_add_u32 m0, s72, 131072
    s_add_u32 s101, s24, s75
    buffer_load_dwordx4 v208, s[48:51], s101 offen offset:0 lds
    v_pk_mul_f32 v[70:71], v[70:71], v[70:71]
    v_cvt_pk_bf16_f32 v198, v68, v69
    v_cvt_pk_bf16_f32 v199, v70, v71
    v_max_f32 v72, 0, v72
    s_waitcnt lgkmcnt(0)
    v_mfma_f32_32x32x16_bf16 v[112:127], v[32:35], a[20:23], v[112:127]
    ds_read_b64_tr_b16 v[16:17], v176 offset:24576
    ds_read_b64_tr_b16 v[18:19], v176 offset:25600
    ds_read_b64_tr_b16 v[20:21], v179 offset:24576
    ds_read_b64_tr_b16 v[22:23], v179 offset:25600
    v_max_f32 v73, 0, v73
    v_mfma_f32_32x32x16_bf16 v[128:143], v[36:39], a[20:23], v[128:143]
    s_add_u32 m0, s17, 8192
    ds_read_b64_tr_b16 v[24:25], v182 offset:24576
    ds_read_b64_tr_b16 v[26:27], v182 offset:25600
    ds_read_b64_tr_b16 v[28:29], v185 offset:24576
    ds_read_b64_tr_b16 v[30:31], v185 offset:25600
    buffer_load_dwordx4 v233, s[56:59], s26 offen offset:1024 lds
    v_mfma_f32_32x32x16_bf16 v[144:159], v[40:43], a[20:23], v[144:159]
    s_add_u32 m0, s72, 131072
    s_nop 0
    buffer_load_dwordx4 v209, s[48:51], s101 offen offset:1024 lds
    v_max_f32 v74, 0, v74
    v_max_f32 v75, 0, v75
    v_pk_mul_f32 v[72:73], v[72:73], v[72:73]
    v_pk_mul_f32 v[74:75], v[74:75], v[74:75]
    v_mfma_f32_32x32x16_bf16 v[160:175], v[44:47], a[20:23], v[160:175]
    v_cvt_pk_bf16_f32 v200, v72, v73
    v_cvt_pk_bf16_f32 v201, v74, v75
    v_max_f32 v76, 0, v76
    v_max_f32 v77, 0, v77
    v_max_f32 v78, 0, v78
    s_waitcnt lgkmcnt(0)
    v_mfma_f32_32x32x16_bf16 v[112:127], v[16:19], a[24:27], v[112:127]
    ds_read_b64_tr_b16 v[32:33], v176 offset:28672
    ds_read_b64_tr_b16 v[34:35], v176 offset:29696
    ds_read_b64_tr_b16 v[36:37], v179 offset:28672
    ds_read_b64_tr_b16 v[38:39], v179 offset:29696
    v_max_f32 v79, 0, v79
    v_mfma_f32_32x32x16_bf16 v[128:143], v[20:23], a[24:27], v[128:143]
    ds_read_b64_tr_b16 v[40:41], v182 offset:28672
    ds_read_b64_tr_b16 v[42:43], v182 offset:29696
    ds_read_b64_tr_b16 v[44:45], v185 offset:28672
    ds_read_b64_tr_b16 v[46:47], v185 offset:29696
    buffer_load_dwordx4 v210, s[48:51], s101 offen offset:2048 lds
    v_mfma_f32_32x32x16_bf16 v[144:159], v[24:27], a[24:27], v[144:159]
    buffer_load_dwordx4 v211, s[48:51], s101 offen offset:3072 lds
    v_pk_mul_f32 v[76:77], v[76:77], v[76:77]
    v_pk_mul_f32 v[78:79], v[78:79], v[78:79]
    v_cvt_pk_bf16_f32 v202, v76, v77
    v_cvt_pk_bf16_f32 v203, v78, v79
    v_mfma_f32_32x32x16_bf16 v[160:175], v[28:31], a[24:27], v[160:175]
    s_add_u32 m0, s17, 8192
    s_nop 0
    buffer_load_dwordx4 v234, s[56:59], s26 offen offset:2048 lds
    s_add_u32 s68, s80, 2048
    buffer_store_dwordx4 v[196:199], v9, s[52:55], s68 offen sc1
    buffer_store_dwordx4 v[200:203], v9, s[52:55], s68 offen offset:1024 sc1
    v_max_f32 v80, 0, v80
    v_max_f32 v81, 0, v81
    v_max_f32 v82, 0, v82
    s_waitcnt lgkmcnt(0)
    v_mfma_f32_32x32x16_bf16 v[112:127], v[32:35], a[28:31], v[112:127]
    s_waitcnt vmcnt(21)
    s_barrier
    ds_read_b64_tr_b16 v[16:17], v176 offset:32768
    ds_read_b64_tr_b16 v[18:19], v176 offset:33792
    ds_read_b64_tr_b16 v[20:21], v179 offset:32768
    ds_read_b64_tr_b16 v[22:23], v179 offset:33792
    v_max_f32 v83, 0, v83
    v_mfma_f32_32x32x16_bf16 v[128:143], v[36:39], a[28:31], v[128:143]
    ds_read_b64_tr_b16 v[24:25], v182 offset:32768
    ds_read_b64_tr_b16 v[26:27], v182 offset:33792
    ds_read_b64_tr_b16 v[28:29], v185 offset:32768
    ds_read_b64_tr_b16 v[30:31], v185 offset:33792
    buffer_load_dwordx4 v235, s[56:59], s26 offen offset:3072 lds
    v_mfma_f32_32x32x16_bf16 v[144:159], v[40:43], a[28:31], v[144:159]
    v_pk_mul_f32 v[80:81], v[80:81], v[80:81]
    v_pk_mul_f32 v[82:83], v[82:83], v[82:83]
    v_cvt_pk_bf16_f32 v188, v80, v81
    v_cvt_pk_bf16_f32 v189, v82, v83
    v_max_f32 v84, 0, v84
    v_mfma_f32_32x32x16_bf16 v[160:175], v[44:47], a[28:31], v[160:175]
    v_max_f32 v85, 0, v85
    v_max_f32 v86, 0, v86
    v_max_f32 v87, 0, v87
    v_pk_mul_f32 v[84:85], v[84:85], v[84:85]
    v_pk_mul_f32 v[86:87], v[86:87], v[86:87]
    s_waitcnt lgkmcnt(0)
    v_mfma_f32_32x32x16_bf16 v[112:127], v[16:19], a[32:35], v[112:127]
    ds_read_b64_tr_b16 v[32:33], v176 offset:36864
    ds_read_b64_tr_b16 v[34:35], v176 offset:37888
    ds_read_b64_tr_b16 v[36:37], v179 offset:36864
    ds_read_b64_tr_b16 v[38:39], v179 offset:37888
    v_cvt_pk_bf16_f32 v190, v84, v85
    v_mfma_f32_32x32x16_bf16 v[128:143], v[20:23], a[32:35], v[128:143]
    ds_read_b64_tr_b16 v[40:41], v182 offset:36864
    ds_read_b64_tr_b16 v[42:43], v182 offset:37888
    ds_read_b64_tr_b16 v[44:45], v185 offset:36864
    ds_read_b64_tr_b16 v[46:47], v185 offset:37888
    s_waitcnt vmcnt(20)
    ds_read_b64_tr_b16 a[112:113], v236 offset:0
    ds_read_b64_tr_b16 a[114:115], v236 offset:1024
    v_mfma_f32_32x32x16_bf16 v[144:159], v[24:27], a[32:35], v[144:159]
    s_add_u32 m0, s17, 12288
    s_mul_i32 s26, s32, 229376
    s_add_u32 s26, s26, s16
    buffer_load_dwordx4 v232, s[56:59], s26 offen offset:0 lds
    v_cvt_pk_bf16_f32 v191, v86, v87
    v_max_f32 v88, 0, v88
    v_max_f32 v89, 0, v89
    v_max_f32 v90, 0, v90
    v_mfma_f32_32x32x16_bf16 v[160:175], v[28:31], a[32:35], v[160:175]
    s_add_u32 m0, s72, 0
    s_add_u32 s101, s25, s75
    buffer_load_dwordx4 v208, s[48:51], s101 offen offset:0 lds
    v_max_f32 v91, 0, v91
    v_pk_mul_f32 v[88:89], v[88:89], v[88:89]
    v_pk_mul_f32 v[90:91], v[90:91], v[90:91]
    v_cvt_pk_bf16_f32 v192, v88, v89
    s_waitcnt lgkmcnt(2)
    v_mfma_f32_32x32x16_bf16 v[112:127], v[32:35], a[36:39], v[112:127]
    ds_read_b64_tr_b16 v[16:17], v176 offset:40960
    ds_read_b64_tr_b16 v[18:19], v176 offset:41984
    ds_read_b64_tr_b16 v[20:21], v179 offset:40960
    ds_read_b64_tr_b16 v[22:23], v179 offset:41984
    v_cvt_pk_bf16_f32 v193, v90, v91
    v_mfma_f32_32x32x16_bf16 v[128:143], v[36:39], a[36:39], v[128:143]
    s_add_u32 m0, s72, 147456
    s_mul_i32 s95, s29, 229376
    s_add_u32 s95, s95, s16
    s_add_u32 s95, s95, 114688
    ds_read_b64_tr_b16 v[24:25], v182 offset:40960
    ds_read_b64_tr_b16 v[26:27], v182 offset:41984
    ds_read_b64_tr_b16 v[28:29], v185 offset:40960
    ds_read_b64_tr_b16 v[30:31], v185 offset:41984
    buffer_load_dwordx4 v232, s[56:59], s95 offen offset:0 lds
    v_mfma_f32_32x32x16_bf16 v[144:159], v[40:43], a[36:39], v[144:159]
    s_add_u32 m0, s72, 0
    s_nop 0
    buffer_load_dwordx4 v209, s[48:51], s101 offen offset:1024 lds
    v_max_f32 v92, 0, v92
    v_max_f32 v93, 0, v93
    v_max_f32 v94, 0, v94
    v_max_f32 v95, 0, v95
    v_mfma_f32_32x32x16_bf16 v[160:175], v[44:47], a[36:39], v[160:175]
    ds_read_b64_tr_b16 a[116:117], v237 offset:0
    ds_read_b64_tr_b16 a[118:119], v237 offset:1024
    v_pk_mul_f32 v[92:93], v[92:93], v[92:93]
    v_pk_mul_f32 v[94:95], v[94:95], v[94:95]
    v_cvt_pk_bf16_f32 v194, v92, v93
    v_cvt_pk_bf16_f32 v195, v94, v95
    s_waitcnt lgkmcnt(2)
    v_mfma_f32_32x32x16_bf16 v[112:127], v[16:19], a[40:43], v[112:127]
    ds_read_b64_tr_b16 v[32:33], v176 offset:45056
    ds_read_b64_tr_b16 v[34:35], v176 offset:46080
    ds_read_b64_tr_b16 v[36:37], v179 offset:45056
    ds_read_b64_tr_b16 v[38:39], v179 offset:46080
    s_add_u32 s68, s80, 4096
    buffer_store_dwordx4 v[188:191], v9, s[52:55], s68 offen sc1
    buffer_store_dwordx4 v[192:195], v9, s[52:55], s68 offen offset:1024 sc1
    v_mfma_f32_32x32x16_bf16 v[128:143], v[20:23], a[40:43], v[128:143]
    ds_read_b64_tr_b16 v[40:41], v182 offset:45056
    ds_read_b64_tr_b16 v[42:43], v182 offset:46080
    ds_read_b64_tr_b16 v[44:45], v185 offset:45056
    ds_read_b64_tr_b16 v[46:47], v185 offset:46080
    buffer_load_dwordx4 v210, s[48:51], s101 offen offset:2048 lds
    v_mfma_f32_32x32x16_bf16 v[144:159], v[24:27], a[40:43], v[144:159]
    buffer_load_dwordx4 v211, s[48:51], s101 offen offset:3072 lds
    v_max_f32 v96, 0, v96
    v_max_f32 v97, 0, v97
    v_max_f32 v98, 0, v98
    v_max_f32 v99, 0, v99
    v_mfma_f32_32x32x16_bf16 v[160:175], v[28:31], a[40:43], v[160:175]
    s_add_u32 m0, s17, 12288
    s_nop 0
    buffer_load_dwordx4 v233, s[56:59], s26 offen offset:1024 lds
    v_pk_mul_f32 v[96:97], v[96:97], v[96:97]
    v_pk_mul_f32 v[98:99], v[98:99], v[98:99]
    v_cvt_pk_bf16_f32 v196, v96, v97
    v_cvt_pk_bf16_f32 v197, v98, v99
    s_waitcnt lgkmcnt(0)
    v_mfma_f32_32x32x16_bf16 v[112:127], v[32:35], a[44:47], v[112:127]
    s_waitcnt vmcnt(23)
    s_barrier
    ds_read_b64_tr_b16 v[16:17], v177 offset:49152
    ds_read_b64_tr_b16 v[18:19], v177 offset:50176
    ds_read_b64_tr_b16 v[20:21], v180 offset:49152
    ds_read_b64_tr_b16 v[22:23], v180 offset:50176
    v_max_f32 v100, 0, v100
    v_mfma_f32_32x32x16_bf16 v[128:143], v[36:39], a[44:47], v[128:143]
    s_add_u32 m0, s72, 147456
    ds_read_b64_tr_b16 v[24:25], v183 offset:49152
    ds_read_b64_tr_b16 v[26:27], v183 offset:50176
    ds_read_b64_tr_b16 v[28:29], v186 offset:49152
    ds_read_b64_tr_b16 v[30:31], v186 offset:50176
    buffer_load_dwordx4 v233, s[56:59], s95 offen offset:1024 lds
    v_mfma_f32_32x32x16_bf16 v[144:159], v[40:43], a[44:47], v[144:159]
    ds_read_b64_tr_b16 a[120:121], v236 offset:2048
    ds_read_b64_tr_b16 a[122:123], v236 offset:3072
    v_max_f32 v101, 0, v101
    v_max_f32 v102, 0, v102
    v_max_f32 v103, 0, v103
    v_pk_mul_f32 v[100:101], v[100:101], v[100:101]
    v_mfma_f32_32x32x16_bf16 v[160:175], v[44:47], a[44:47], v[160:175]
    s_add_u32 m0, s17, 12288
    s_nop 0
    buffer_load_dwordx4 v234, s[56:59], s26 offen offset:2048 lds
    v_pk_mul_f32 v[102:103], v[102:103], v[102:103]
    v_cvt_pk_bf16_f32 v198, v100, v101
    v_cvt_pk_bf16_f32 v199, v102, v103
    v_max_f32 v104, 0, v104
    s_waitcnt lgkmcnt(2)
    v_mfma_f32_32x32x16_bf16 v[112:127], v[16:19], a[48:51], v[112:127]
    ds_read_b64_tr_b16 v[32:33], v177 offset:53248
    ds_read_b64_tr_b16 v[34:35], v177 offset:54272
    ds_read_b64_tr_b16 v[36:37], v180 offset:53248
    ds_read_b64_tr_b16 v[38:39], v180 offset:54272
    v_max_f32 v105, 0, v105
    v_mfma_f32_32x32x16_bf16 v[128:143], v[20:23], a[48:51], v[128:143]
    s_add_u32 m0, s72, 147456
    ds_read_b64_tr_b16 v[40:41], v183 offset:53248
    ds_read_b64_tr_b16 v[42:43], v183 offset:54272
    ds_read_b64_tr_b16 v[44:45], v186 offset:53248
    ds_read_b64_tr_b16 v[46:47], v186 offset:54272
    buffer_load_dwordx4 v234, s[56:59], s95 offen offset:2048 lds
    v_mfma_f32_32x32x16_bf16 v[144:159], v[24:27], a[48:51], v[144:159]
    ds_read_b64_tr_b16 a[124:125], v237 offset:2048
    ds_read_b64_tr_b16 a[126:127], v237 offset:3072
    v_max_f32 v106, 0, v106
    v_max_f32 v107, 0, v107
    v_pk_mul_f32 v[104:105], v[104:105], v[104:105]
    v_pk_mul_f32 v[106:107], v[106:107], v[106:107]
    v_mfma_f32_32x32x16_bf16 v[160:175], v[28:31], a[48:51], v[160:175]
    s_add_u32 m0, s72, 16384
    s_add_u32 s101, s28, s75
    buffer_load_dwordx4 v208, s[48:51], s101 offen offset:0 lds
    v_cvt_pk_bf16_f32 v200, v104, v105
    v_cvt_pk_bf16_f32 v201, v106, v107
    v_max_f32 v108, 0, v108
    v_max_f32 v109, 0, v109
    v_readfirstlane_b32 s76, v243
    s_nop 1
    s_cmp_lg_u32 s76, 0
    s_cbranch_scc1 nz_done_3
    s_mov_b32 s96, 0x8000
nz_4:
    v_mov_b32 v243, 0
    buffer_load_dword v243, v243, s[8:11], 0 offen sc1
    s_waitcnt vmcnt(0)
    v_readfirstlane_b32 s76, v243
    s_nop 1
    s_cmp_lg_u32 s76, 0
    s_cbranch_scc1 nz_done_3
    s_sleep 2
    s_sub_u32 s96, s96, 1
    s_cbranch_scc0 nz_4
nz_done_3:
    s_waitcnt lgkmcnt(2)
    v_mfma_f32_32x32x16_bf16 v[112:127], v[32:35], a[52:55], v[112:127]
    ds_read_b64_tr_b16 v[16:17], v177 offset:57344
    ds_read_b64_tr_b16 v[18:19], v177 offset:58368
    ds_read_b64_tr_b16 v[20:21], v180 offset:57344
    ds_read_b64_tr_b16 v[22:23], v180 offset:58368
    v_max_f32 v110, 0, v110
    v_mfma_f32_32x32x16_bf16 v[128:143], v[36:39], a[52:55], v[128:143]
    s_add_u32 m0, s17, 12288
    ds_read_b64_tr_b16 v[24:25], v183 offset:57344
    ds_read_b64_tr_b16 v[26:27], v183 offset:58368
    ds_read_b64_tr_b16 v[28:29], v186 offset:57344
    ds_read_b64_tr_b16 v[30:31], v186 offset:58368
    buffer_load_dwordx4 v235, s[56:59], s26 offen offset:3072 lds
    v_mfma_f32_32x32x16_bf16 v[144:159], v[40:43], a[52:55], v[144:159]
    s_add_u32 m0, s72, 16384
    s_nop 0
    buffer_load_dwordx4 v209, s[48:51], s101 offen offset:1024 lds
    v_max_f32 v111, 0, v111
    v_pk_mul_f32 v[108:109], v[108:109], v[108:109]
    v_pk_mul_f32 v[110:111], v[110:111], v[110:111]
    v_cvt_pk_bf16_f32 v202, v108, v109
    v_mfma_f32_32x32x16_bf16 v[160:175], v[44:47], a[52:55], v[160:175]
    s_add_u32 m0, s72, 147456
    s_nop 0
    buffer_load_dwordx4 v235, s[56:59], s95 offen offset:3072 lds
    v_cvt_pk_bf16_f32 v203, v110, v111
    s_add_u32 s68, s80, 6144
    buffer_store_dwordx4 v[196:199], v9, s[52:55], s68 offen sc1
    buffer_store_dwordx4 v[200:203], v9, s[52:55], s68 offen offset:1024 sc1
    s_waitcnt lgkmcnt(0)
    v_mfma_f32_32x32x16_bf16 v[112:127], v[16:19], a[56:59], v[112:127]
    ds_read_b64_tr_b16 v[32:33], v177 offset:61440
    ds_read_b64_tr_b16 v[34:35], v177 offset:62464
    ds_read_b64_tr_b16 v[36:37], v180 offset:61440
    ds_read_b64_tr_b16 v[38:39], v180 offset:62464
    v_mfma_f32_32x32x16_bf16 v[128:143], v[20:23], a[56:59], v[128:143]
    s_add_u32 m0, s72, 16384
    ds_read_b64_tr_b16 v[40:41], v183 offset:61440
    ds_read_b64_tr_b16 v[42:43], v183 offset:62464
    ds_read_b64_tr_b16 v[44:45], v186 offset:61440
    ds_read_b64_tr_b16 v[46:47], v186 offset:62464
    buffer_load_dwordx4 v210, s[48:51], s101 offen offset:2048 lds
    v_mfma_f32_32x32x16_bf16 v[144:159], v[24:27], a[56:59], v[144:159]
    buffer_load_dwordx4 v211, s[48:51], s101 offen offset:3072 lds
    v_mfma_f32_32x32x16_bf16 v[160:175], v[28:31], a[56:59], v[160:175]
    s_waitcnt vmcnt(32)
    ds_read_b64_tr_b16 a[128:129], v236 offset:4096
    ds_read_b64_tr_b16 a[130:131], v236 offset:5120
    s_waitcnt lgkmcnt(2)
    v_mfma_f32_32x32x16_bf16 v[112:127], v[32:35], a[60:63], v[112:127]
    s_waitcnt vmcnt(24)
    s_barrier
    ds_read_b64_tr_b16 v[16:17], v178 offset:0
    ds_read_b64_tr_b16 v[18:19], v178 offset:1024
    ds_read_b64_tr_b16 v[20:21], v181 offset:0
    ds_read_b64_tr_b16 v[22:23], v181 offset:1024
    v_mfma_f32_32x32x16_bf16 v[128:143], v[36:39], a[60:63], v[128:143]
    s_waitcnt lgkmcnt(15)
    s_add_u32 m0, s17, 0
    s_mul_i32 s26, s33, 229376
    s_add_u32 s26, s26, s16
    ds_read_b64_tr_b16 v[24:25], v184 offset:0
    ds_read_b64_tr_b16 v[26:27], v184 offset:1024
    ds_read_b64_tr_b16 v[28:29], v187 offset:0
    ds_read_b64_tr_b16 v[30:31], v187 offset:1024
    buffer_load_dwordx4 v232, s[56:59], s26 offen offset:0 lds
    v_mfma_f32_32x32x16_bf16 v[144:159], v[40:43], a[60:63], v[144:159]
    ds_read_b64_tr_b16 a[132:133], v237 offset:4096
    ds_read_b64_tr_b16 a[134:135], v237 offset:5120
    v_mfma_f32_32x32x16_bf16 v[160:175], v[44:47], a[60:63], v[160:175]
    buffer_load_dwordx4 v233, s[56:59], s26 offen offset:1024 lds
    s_waitcnt lgkmcnt(2)
    v_mfma_f32_32x32x16_bf16 v[112:127], v[16:19], a[64:67], v[112:127]
    ds_read_b64_tr_b16 v[32:33], v178 offset:4096
    ds_read_b64_tr_b16 v[34:35], v178 offset:5120
    ds_read_b64_tr_b16 v[36:37], v181 offset:4096
    ds_read_b64_tr_b16 v[38:39], v181 offset:5120
    v_mfma_f32_32x32x16_bf16 v[128:143], v[20:23], a[64:67], v[128:143]
    ds_read_b64_tr_b16 v[40:41], v184 offset:4096
    ds_read_b64_tr_b16 v[42:43], v184 offset:5120
    ds_read_b64_tr_b16 v[44:45], v187 offset:4096
    ds_read_b64_tr_b16 v[46:47], v187 offset:5120
    ds_read_b64_tr_b16 a[136:137], v236 offset:6144
    ds_read_b64_tr_b16 a[138:139], v236 offset:7168
    v_mfma_f32_32x32x16_bf16 v[144:159], v[24:27], a[64:67], v[144:159]
    buffer_load_dwordx4 v234, s[56:59], s26 offen offset:2048 lds
    v_mfma_f32_32x32x16_bf16 v[160:175], v[28:31], a[64:67], v[160:175]
    ds_read_b64_tr_b16 a[140:141], v237 offset:6144
    ds_read_b64_tr_b16 a[142:143], v237 offset:7168
    s_waitcnt lgkmcnt(4)
    v_mfma_f32_32x32x16_bf16 v[112:127], v[32:35], a[68:71], v[112:127]
    ds_read_b64_tr_b16 v[16:17], v178 offset:8192
    ds_read_b64_tr_b16 v[18:19], v178 offset:9216
    ds_read_b64_tr_b16 v[20:21], v181 offset:8192
    ds_read_b64_tr_b16 v[22:23], v181 offset:9216
    v_mfma_f32_32x32x16_bf16 v[128:143], v[36:39], a[68:71], v[128:143]
    ds_read_b64_tr_b16 v[24:25], v184 offset:8192
    ds_read_b64_tr_b16 v[26:27], v184 offset:9216
    ds_read_b64_tr_b16 v[28:29], v187 offset:8192
    ds_read_b64_tr_b16 v[30:31], v187 offset:9216
    buffer_load_dwordx4 v235, s[56:59], s26 offen offset:3072 lds
    v_mfma_f32_32x32x16_bf16 v[144:159], v[40:43], a[68:71], v[144:159]
    s_waitcnt vmcnt(24)
    ds_read_b64_tr_b16 a[144:145], v236 offset:8192
    ds_read_b64_tr_b16 a[146:147], v236 offset:9216
    v_mfma_f32_32x32x16_bf16 v[160:175], v[44:47], a[68:71], v[160:175]
    s_waitcnt lgkmcnt(10)
    s_add_u32 m0, s17, 4096
    s_mul_i32 s26, s36, 229376
    s_add_u32 s26, s26, s16
    buffer_load_dwordx4 v232, s[56:59], s26 offen offset:0 lds
    s_waitcnt lgkmcnt(2)
    v_mfma_f32_32x32x16_bf16 v[112:127], v[16:19], a[72:75], v[112:127]
    ds_read_b64_tr_b16 v[32:33], v178 offset:12288
    ds_read_b64_tr_b16 v[34:35], v178 offset:13312
    ds_read_b64_tr_b16 v[36:37], v181 offset:12288
    ds_read_b64_tr_b16 v[38:39], v181 offset:13312
    v_mfma_f32_32x32x16_bf16 v[128:143], v[20:23], a[72:75], v[128:143]
    s_add_u32 m0, s72, 32768
    s_mul_i32 s95, s30, 229376
    s_add_u32 s95, s95, s16
    s_add_u32 s95, s95, 114688
    ds_read_b64_tr_b16 v[40:41], v184 offset:12288
    ds_read_b64_tr_b16 v[42:43], v184 offset:13312
    ds_read_b64_tr_b16 v[44:45], v187 offset:12288
    ds_read_b64_tr_b16 v[46:47], v187 offset:13312
    buffer_load_dwordx4 v232, s[56:59], s95 offen offset:0 lds
    v_mfma_f32_32x32x16_bf16 v[144:159], v[24:27], a[72:75], v[144:159]
    ds_read_b64_tr_b16 a[148:149], v237 offset:8192
    ds_read_b64_tr_b16 a[150:151], v237 offset:9216
    v_mfma_f32_32x32x16_bf16 v[160:175], v[28:31], a[72:75], v[160:175]
    s_add_u32 m0, s17, 4096
    s_nop 0
    buffer_load_dwordx4 v233, s[56:59], s26 offen offset:1024 lds
    s_waitcnt lgkmcnt(2)
    v_mfma_f32_32x32x16_bf16 v[112:127], v[32:35], a[76:79], v[112:127]
    s_waitcnt vmcnt(19)
    s_barrier
    ds_read_b64_tr_b16 v[16:17], v176 offset:0
    ds_read_b64_tr_b16 v[18:19], v176 offset:1024
    ds_read_b64_tr_b16 v[20:21], v179 offset:0
    ds_read_b64_tr_b16 v[22:23], v179 offset:1024
    v_mfma_f32_32x32x16_bf16 v[128:143], v[36:39], a[76:79], v[128:143]
    s_add_u32 m0, s72, 32768
    ds_read_b64_tr_b16 v[24:25], v182 offset:0
    ds_read_b64_tr_b16 v[26:27], v182 offset:1024
    ds_read_b64_tr_b16 v[28:29], v185 offset:0
    ds_read_b64_tr_b16 v[30:31], v185 offset:1024
    buffer_load_dwordx4 v233, s[56:59], s95 offen offset:1024 lds
    v_mfma_f32_32x32x16_bf16 v[144:159], v[40:43], a[76:79], v[144:159]
    ds_read_b64_tr_b16 a[152:153], v236 offset:10240
    ds_read_b64_tr_b16 a[154:155], v236 offset:11264
    v_mfma_f32_32x32x16_bf16 v[160:175], v[44:47], a[76:79], v[160:175]
    s_add_u32 m0, s17, 4096
    s_nop 0
    buffer_load_dwordx4 v234, s[56:59], s26 offen offset:2048 lds
    s_waitcnt lgkmcnt(2)
    v_mfma_f32_32x32x16_bf16 v[112:127], v[16:19], a[80:83], v[112:127]
    ds_read_b64_tr_b16 v[32:33], v176 offset:4096
    ds_read_b64_tr_b16 v[34:35], v176 offset:5120
    ds_read_b64_tr_b16 v[36:37], v179 offset:4096
    ds_read_b64_tr_b16 v[38:39], v179 offset:5120
    v_mfma_f32_32x32x16_bf16 v[128:143], v[20:23], a[80:83], v[128:143]
    s_add_u32 m0, s72, 32768
    ds_read_b64_tr_b16 v[40:41], v182 offset:4096
    ds_read_b64_tr_b16 v[42:43], v182 offset:5120
    ds_read_b64_tr_b16 v[44:45], v185 offset:4096
    ds_read_b64_tr_b16 v[46:47], v185 offset:5120
    buffer_load_dwordx4 v234, s[56:59], s95 offen offset:2048 lds
    v_mfma_f32_32x32x16_bf16 v[144:159], v[24:27], a[80:83], v[144:159]
    ds_read_b64_tr_b16 a[156:157], v237 offset:10240
    ds_read_b64_tr_b16 a[158:159], v237 offset:11264
    v_mfma_f32_32x32x16_bf16 v[160:175], v[28:31], a[80:83], v[160:175]
    s_add_u32 m0, s17, 4096
    s_nop 0
    buffer_load_dwordx4 v235, s[56:59], s26 offen offset:3072 lds
    s_waitcnt lgkmcnt(2)
    v_mfma_f32_32x32x16_bf16 v[112:127], v[32:35], a[84:87], v[112:127]
    ds_read_b64_tr_b16 v[16:17], v176 offset:8192
    ds_read_b64_tr_b16 v[18:19], v176 offset:9216
    ds_read_b64_tr_b16 v[20:21], v179 offset:8192
    ds_read_b64_tr_b16 v[22:23], v179 offset:9216
    v_mfma_f32_32x32x16_bf16 v[128:143], v[36:39], a[84:87], v[128:143]
    s_add_u32 m0, s72, 32768
    ds_read_b64_tr_b16 v[24:25], v182 offset:8192
    ds_read_b64_tr_b16 v[26:27], v182 offset:9216
    ds_read_b64_tr_b16 v[28:29], v185 offset:8192
    ds_read_b64_tr_b16 v[30:31], v185 offset:9216
    buffer_load_dwordx4 v235, s[56:59], s95 offen offset:3072 lds
    v_mfma_f32_32x32x16_bf16 v[144:159], v[40:43], a[84:87], v[144:159]
    s_waitcnt vmcnt(18)
    ds_read_b64_tr_b16 a[160:161], v236 offset:12288
    ds_read_b64_tr_b16 a[162:163], v236 offset:13312
    v_mfma_f32_32x32x16_bf16 v[160:175], v[44:47], a[84:87], v[160:175]
    s_waitcnt lgkmcnt(10)
    s_add_u32 m0, s17, 8192
    s_mul_i32 s26, s37, 229376
    s_add_u32 s26, s26, s16
    buffer_load_dwordx4 v232, s[56:59], s26 offen offset:0 lds
    s_waitcnt lgkmcnt(2)
    v_mfma_f32_32x32x16_bf16 v[112:127], v[16:19], a[88:91], v[112:127]
    ds_read_b64_tr_b16 v[32:33], v176 offset:12288
    ds_read_b64_tr_b16 v[34:35], v176 offset:13312
    ds_read_b64_tr_b16 v[36:37], v179 offset:12288
    ds_read_b64_tr_b16 v[38:39], v179 offset:13312
    v_mfma_f32_32x32x16_bf16 v[128:143], v[20:23], a[88:91], v[128:143]
    s_add_u32 m0, s72, 114688
    s_mul_i32 s95, s31, 229376
    s_add_u32 s95, s95, s16
    s_add_u32 s95, s95, 114688
    ds_read_b64_tr_b16 v[40:41], v182 offset:12288
    ds_read_b64_tr_b16 v[42:43], v182 offset:13312
    ds_read_b64_tr_b16 v[44:45], v185 offset:12288
    ds_read_b64_tr_b16 v[46:47], v185 offset:13312
    buffer_load_dwordx4 v232, s[56:59], s95 offen offset:0 lds
    v_mfma_f32_32x32x16_bf16 v[144:159], v[24:27], a[88:91], v[144:159]
    ds_read_b64_tr_b16 a[164:165], v237 offset:12288
    ds_read_b64_tr_b16 a[166:167], v237 offset:13312
    v_mfma_f32_32x32x16_bf16 v[160:175], v[28:31], a[88:91], v[160:175]
    s_add_u32 m0, s17, 8192
    s_nop 0
    buffer_load_dwordx4 v233, s[56:59], s26 offen offset:1024 lds
    s_waitcnt vmcnt(17)
    s_lshl_b32 s68, s65, 9
    s_lshl_b32 s69, s66, 4
    s_add_u32 s68, s68, s69
    s_lshl_b32 s69, s64, 2
    s_add_u32 s68, s68, s69
    s_add_u32 s68, s68, 9510912
    v_mov_b32 v238, s76
    v_mov_b32 v239, 0
    s_mov_b64 exec, 1
    buffer_store_dword v238, v239, s[52:55], s68 offen sc1
    s_mov_b64 exec, -1
    s_waitcnt lgkmcnt(2)
    v_mfma_f32_32x32x16_bf16 v[112:127], v[32:35], a[92:95], v[112:127]
    s_waitcnt vmcnt(16)
    s_barrier
    ds_read_b64_tr_b16 v[16:17], v176 offset:16384
    ds_read_b64_tr_b16 v[18:19], v176 offset:17408
    ds_read_b64_tr_b16 v[20:21], v179 offset:16384
    ds_read_b64_tr_b16 v[22:23], v179 offset:17408
    v_mfma_f32_32x32x16_bf16 v[128:143], v[36:39], a[92:95], v[128:143]
    s_add_u32 m0, s72, 114688
    ds_read_b64_tr_b16 v[24:25], v182 offset:16384
    ds_read_b64_tr_b16 v[26:27], v182 offset:17408
    ds_read_b64_tr_b16 v[28:29], v185 offset:16384
    ds_read_b64_tr_b16 v[30:31], v185 offset:17408
    buffer_load_dwordx4 v233, s[56:59], s95 offen offset:1024 lds
    v_mfma_f32_32x32x16_bf16 v[144:159], v[40:43], a[92:95], v[144:159]
    ds_read_b64_tr_b16 a[168:169], v236 offset:14336
    ds_read_b64_tr_b16 a[170:171], v236 offset:15360
    v_mfma_f32_32x32x16_bf16 v[160:175], v[44:47], a[92:95], v[160:175]
    s_add_u32 m0, s17, 8192
    s_nop 0
    buffer_load_dwordx4 v234, s[56:59], s26 offen offset:2048 lds
    s_waitcnt lgkmcnt(2)
    v_mfma_f32_32x32x16_bf16 v[112:127], v[16:19], a[96:99], v[112:127]
    ds_read_b64_tr_b16 v[32:33], v176 offset:20480
    ds_read_b64_tr_b16 v[34:35], v176 offset:21504
    ds_read_b64_tr_b16 v[36:37], v179 offset:20480
    ds_read_b64_tr_b16 v[38:39], v179 offset:21504
    v_mfma_f32_32x32x16_bf16 v[128:143], v[20:23], a[96:99], v[128:143]
    s_add_u32 m0, s72, 114688
    ds_read_b64_tr_b16 v[40:41], v182 offset:20480
    ds_read_b64_tr_b16 v[42:43], v182 offset:21504
    ds_read_b64_tr_b16 v[44:45], v185 offset:20480
    ds_read_b64_tr_b16 v[46:47], v185 offset:21504
    buffer_load_dwordx4 v234, s[56:59], s95 offen offset:2048 lds
    v_mfma_f32_32x32x16_bf16 v[144:159], v[24:27], a[96:99], v[144:159]
    ds_read_b64_tr_b16 a[172:173], v237 offset:14336
    ds_read_b64_tr_b16 a[174:175], v237 offset:15360
    v_mfma_f32_32x32x16_bf16 v[160:175], v[28:31], a[96:99], v[160:175]
    s_add_u32 m0, s17, 8192
    s_nop 0
    buffer_load_dwordx4 v235, s[56:59], s26 offen offset:3072 lds
    s_waitcnt lgkmcnt(2)
    v_mfma_f32_32x32x16_bf16 v[112:127], v[32:35], a[100:103], v[112:127]
    ds_read_b64_tr_b16 v[16:17], v176 offset:24576
    ds_read_b64_tr_b16 v[18:19], v176 offset:25600
    ds_read_b64_tr_b16 v[20:21], v179 offset:24576
    ds_read_b64_tr_b16 v[22:23], v179 offset:25600
    v_mfma_f32_32x32x16_bf16 v[128:143], v[36:39], a[100:103], v[128:143]
    s_add_u32 m0, s72, 114688
    ds_read_b64_tr_b16 v[24:25], v182 offset:24576
    ds_read_b64_tr_b16 v[26:27], v182 offset:25600
    ds_read_b64_tr_b16 v[28:29], v185 offset:24576
    ds_read_b64_tr_b16 v[30:31], v185 offset:25600
    buffer_load_dwordx4 v235, s[56:59], s95 offen offset:3072 lds
    v_mfma_f32_32x32x16_bf16 v[144:159], v[40:43], a[100:103], v[144:159]
    s_waitcnt vmcnt(17)
    ds_read_b64_tr_b16 a[176:177], v236 offset:0
    ds_read_b64_tr_b16 a[178:179], v236 offset:1024
    v_mfma_f32_32x32x16_bf16 v[160:175], v[44:47], a[100:103], v[160:175]
    s_add_u32 m0, s72, 131072
    s_mul_i32 s95, s32, 229376
    s_add_u32 s95, s95, s16
    s_add_u32 s95, s95, 114688
    buffer_load_dwordx4 v232, s[56:59], s95 offen offset:0 lds
    s_waitcnt lgkmcnt(2)
    v_mfma_f32_32x32x16_bf16 v[112:127], v[16:19], a[104:107], v[112:127]
    ds_read_b64_tr_b16 v[32:33], v176 offset:28672
    ds_read_b64_tr_b16 v[34:35], v176 offset:29696
    ds_read_b64_tr_b16 v[36:37], v179 offset:28672
    ds_read_b64_tr_b16 v[38:39], v179 offset:29696
    v_mfma_f32_32x32x16_bf16 v[128:143], v[20:23], a[104:107], v[128:143]
    ds_read_b64_tr_b16 v[40:41], v182 offset:28672
    ds_read_b64_tr_b16 v[42:43], v182 offset:29696
    ds_read_b64_tr_b16 v[44:45], v185 offset:28672
    ds_read_b64_tr_b16 v[46:47], v185 offset:29696
    ds_read_b64_tr_b16 a[180:181], v237 offset:0
    ds_read_b64_tr_b16 a[182:183], v237 offset:1024
    v_mfma_f32_32x32x16_bf16 v[144:159], v[24:27], a[104:107], v[144:159]
    buffer_load_dwordx4 v233, s[56:59], s95 offen offset:1024 lds
    v_mfma_f32_32x32x16_bf16 v[160:175], v[28:31], a[104:107], v[160:175]
    ds_read_b64_tr_b16 a[184:185], v236 offset:2048
    ds_read_b64_tr_b16 a[186:187], v236 offset:3072
    s_waitcnt lgkmcnt(4)
    v_mfma_f32_32x32x16_bf16 v[112:127], v[32:35], a[108:111], v[112:127]
    v_mfma_f32_32x32x16_bf16 v[128:143], v[36:39], a[108:111], v[128:143]
    buffer_load_dwordx4 v234, s[56:59], s95 offen offset:2048 lds
    v_mfma_f32_32x32x16_bf16 v[144:159], v[40:43], a[108:111], v[144:159]
    ds_read_b64_tr_b16 a[188:189], v237 offset:2048
    ds_read_b64_tr_b16 a[190:191], v237 offset:3072
    v_mfma_f32_32x32x16_bf16 v[160:175], v[44:47], a[108:111], v[160:175]
    buffer_load_dwordx4 v235, s[56:59], s95 offen offset:3072 lds
    v_mov_b32 v252, v248
    s_nop 1
    v_mfma_f32_32x32x16_bf16 v[112:127], v[252:255], a[248:251], v[112:127]
    v_mov_b32 v252, v249
    s_nop 1
    v_mfma_f32_32x32x16_bf16 v[128:143], v[252:255], a[248:251], v[128:143]
    v_mov_b32 v252, v250
    s_nop 1
    v_mfma_f32_32x32x16_bf16 v[144:159], v[252:255], a[248:251], v[144:159]
    v_mov_b32 v252, v251
    s_nop 1
    v_mfma_f32_32x32x16_bf16 v[160:175], v[252:255], a[248:251], v[160:175]
    v_lshlrev_b32 v2, 2, v1
    v_max_f32 v112, 0, v112
    v_max_f32 v113, 0, v113
    v_max_f32 v114, 0, v114
    v_max_f32 v115, 0, v115
    v_max_f32 v116, 0, v116
    v_max_f32 v117, 0, v117
    v_max_f32 v118, 0, v118
    v_max_f32 v119, 0, v119
    v_max_f32 v120, 0, v120
    v_max_f32 v121, 0, v121
    v_max_f32 v122, 0, v122
    v_max_f32 v123, 0, v123
    v_max_f32 v124, 0, v124
    v_max_f32 v125, 0, v125
    v_max_f32 v126, 0, v126
    v_max_f32 v127, 0, v127
    v_pk_mul_f32 v[112:113], v[112:113], v[112:113]
    v_pk_mul_f32 v[114:115], v[114:115], v[114:115]
    v_pk_mul_f32 v[116:117], v[116:117], v[116:117]
    v_pk_mul_f32 v[118:119], v[118:119], v[118:119]
    v_pk_mul_f32 v[120:121], v[120:121], v[120:121]
    v_pk_mul_f32 v[122:123], v[122:123], v[122:123]
    v_pk_mul_f32 v[124:125], v[124:125], v[124:125]
    v_pk_mul_f32 v[126:127], v[126:127], v[126:127]
    v_cvt_pk_bf16_f32 v188, v112, v113
    v_cvt_pk_bf16_f32 v189, v114, v115
    v_cvt_pk_bf16_f32 v190, v116, v117
    v_cvt_pk_bf16_f32 v191, v118, v119
    v_cvt_pk_bf16_f32 v192, v120, v121
    v_cvt_pk_bf16_f32 v193, v122, v123
    v_cvt_pk_bf16_f32 v194, v124, v125
    v_cvt_pk_bf16_f32 v195, v126, v127
    s_add_u32 s68, s80, 8192
    buffer_store_dwordx4 v[188:191], v9, s[52:55], s68 offen sc1
    buffer_store_dwordx4 v[192:195], v9, s[52:55], s68 offen offset:1024 sc1
    v_max_f32 v128, 0, v128
    v_max_f32 v129, 0, v129
    v_max_f32 v130, 0, v130
    v_max_f32 v131, 0, v131
    v_max_f32 v132, 0, v132
    v_max_f32 v133, 0, v133
    v_max_f32 v134, 0, v134
    v_max_f32 v135, 0, v135
    v_max_f32 v136, 0, v136
    v_max_f32 v137, 0, v137
    v_max_f32 v138, 0, v138
    v_max_f32 v139, 0, v139
    v_max_f32 v140, 0, v140
    v_max_f32 v141, 0, v141
    v_max_f32 v142, 0, v142
    v_max_f32 v143, 0, v143
    v_pk_mul_f32 v[128:129], v[128:129], v[128:129]
    v_pk_mul_f32 v[130:131], v[130:131], v[130:131]
    v_pk_mul_f32 v[132:133], v[132:133], v[132:133]
    v_pk_mul_f32 v[134:135], v[134:135], v[134:135]
    v_pk_mul_f32 v[136:137], v[136:137], v[136:137]
    v_pk_mul_f32 v[138:139], v[138:139], v[138:139]
    v_pk_mul_f32 v[140:141], v[140:141], v[140:141]
    v_pk_mul_f32 v[142:143], v[142:143], v[142:143]
    v_cvt_pk_bf16_f32 v196, v128, v129
    v_cvt_pk_bf16_f32 v197, v130, v131
    v_cvt_pk_bf16_f32 v198, v132, v133
    v_cvt_pk_bf16_f32 v199, v134, v135
    v_cvt_pk_bf16_f32 v200, v136, v137
    v_cvt_pk_bf16_f32 v201, v138, v139
    v_cvt_pk_bf16_f32 v202, v140, v141
    v_cvt_pk_bf16_f32 v203, v142, v143
    s_add_u32 s68, s80, 10240
    buffer_store_dwordx4 v[196:199], v9, s[52:55], s68 offen sc1
    buffer_store_dwordx4 v[200:203], v9, s[52:55], s68 offen offset:1024 sc1
    v_max_f32 v144, 0, v144
    v_max_f32 v145, 0, v145
    v_max_f32 v146, 0, v146
    v_max_f32 v147, 0, v147
    v_max_f32 v148, 0, v148
    v_max_f32 v149, 0, v149
    v_max_f32 v150, 0, v150
    v_max_f32 v151, 0, v151
    v_max_f32 v152, 0, v152
    v_max_f32 v153, 0, v153
    v_max_f32 v154, 0, v154
    v_max_f32 v155, 0, v155
    v_max_f32 v156, 0, v156
    v_max_f32 v157, 0, v157
    v_max_f32 v158, 0, v158
    v_max_f32 v159, 0, v159
    v_pk_mul_f32 v[144:145], v[144:145], v[144:145]
    v_pk_mul_f32 v[146:147], v[146:147], v[146:147]
    v_pk_mul_f32 v[148:149], v[148:149], v[148:149]
    v_pk_mul_f32 v[150:151], v[150:151], v[150:151]
    v_pk_mul_f32 v[152:153], v[152:153], v[152:153]
    v_pk_mul_f32 v[154:155], v[154:155], v[154:155]
    v_pk_mul_f32 v[156:157], v[156:157], v[156:157]
    v_pk_mul_f32 v[158:159], v[158:159], v[158:159]
    v_cvt_pk_bf16_f32 v204, v144, v145
    v_cvt_pk_bf16_f32 v205, v146, v147
    v_cvt_pk_bf16_f32 v206, v148, v149
    v_cvt_pk_bf16_f32 v207, v150, v151
    v_cvt_pk_bf16_f32 v208, v152, v153
    v_cvt_pk_bf16_f32 v209, v154, v155
    v_cvt_pk_bf16_f32 v210, v156, v157
    v_cvt_pk_bf16_f32 v211, v158, v159
    s_add_u32 s68, s80, 12288
    buffer_store_dwordx4 v[204:207], v9, s[52:55], s68 offen sc1
    buffer_store_dwordx4 v[208:211], v9, s[52:55], s68 offen offset:1024 sc1
    v_max_f32 v160, 0, v160
    v_max_f32 v161, 0, v161
    v_max_f32 v162, 0, v162
    v_max_f32 v163, 0, v163
    v_max_f32 v164, 0, v164
    v_max_f32 v165, 0, v165
    v_max_f32 v166, 0, v166
    v_max_f32 v167, 0, v167
    v_max_f32 v168, 0, v168
    v_max_f32 v169, 0, v169
    v_max_f32 v170, 0, v170
    v_max_f32 v171, 0, v171
    v_max_f32 v172, 0, v172
    v_max_f32 v173, 0, v173
    v_max_f32 v174, 0, v174
    v_max_f32 v175, 0, v175
    v_pk_mul_f32 v[160:161], v[160:161], v[160:161]
    v_pk_mul_f32 v[162:163], v[162:163], v[162:163]
    v_pk_mul_f32 v[164:165], v[164:165], v[164:165]
    v_pk_mul_f32 v[166:167], v[166:167], v[166:167]
    v_pk_mul_f32 v[168:169], v[168:169], v[168:169]
    v_pk_mul_f32 v[170:171], v[170:171], v[170:171]
    v_pk_mul_f32 v[172:173], v[172:173], v[172:173]
    v_pk_mul_f32 v[174:175], v[174:175], v[174:175]
    v_cvt_pk_bf16_f32 v212, v160, v161
    v_cvt_pk_bf16_f32 v213, v162, v163
    v_cvt_pk_bf16_f32 v214, v164, v165
    v_cvt_pk_bf16_f32 v215, v166, v167
    v_cvt_pk_bf16_f32 v216, v168, v169
    v_cvt_pk_bf16_f32 v217, v170, v171
    v_cvt_pk_bf16_f32 v218, v172, v173
    v_cvt_pk_bf16_f32 v219, v174, v175
    s_add_u32 s68, s80, 14336
    buffer_store_dwordx4 v[212:215], v9, s[52:55], s68 offen sc1
    buffer_store_dwordx4 v[216:219], v9, s[52:55], s68 offen offset:1024 sc1
    s_waitcnt vmcnt(22)
    ds_read_b64_tr_b16 a[192:193], v236 offset:4096
    ds_read_b64_tr_b16 a[194:195], v236 offset:5120
    ds_read_b64_tr_b16 a[196:197], v237 offset:4096
    ds_read_b64_tr_b16 a[198:199], v237 offset:5120
    ds_read_b64_tr_b16 a[200:201], v236 offset:6144
    ds_read_b64_tr_b16 a[202:203], v236 offset:7168
    ds_read_b64_tr_b16 a[204:205], v237 offset:6144
    ds_read_b64_tr_b16 a[206:207], v237 offset:7168
    s_waitcnt vmcnt(13)
    ds_read_b64_tr_b16 a[208:209], v236 offset:8192
    ds_read_b64_tr_b16 a[210:211], v236 offset:9216
    ds_read_b64_tr_b16 a[212:213], v237 offset:8192
    ds_read_b64_tr_b16 a[214:215], v237 offset:9216
    ds_read_b64_tr_b16 a[216:217], v236 offset:10240
    ds_read_b64_tr_b16 a[218:219], v236 offset:11264
    ds_read_b64_tr_b16 a[220:221], v237 offset:10240
    ds_read_b64_tr_b16 a[222:223], v237 offset:11264
    s_waitcnt lgkmcnt(0)
    s_add_u32 m0, s17, 12288
    s_mul_i32 s26, s33, 229376
    s_add_u32 s26, s26, s16
    s_add_u32 s26, s26, 114688
    buffer_load_dwordx4 v232, s[56:59], s26 offen offset:0 lds
    buffer_load_dwordx4 v233, s[56:59], s26 offen offset:1024 lds
    buffer_load_dwordx4 v234, s[56:59], s26 offen offset:2048 lds
    buffer_load_dwordx4 v235, s[56:59], s26 offen offset:3072 lds
    s_add_u32 m0, s17, 0
    s_mul_i32 s26, s36, 229376
    s_add_u32 s26, s26, s16
    s_add_u32 s26, s26, 114688
    buffer_load_dwordx4 v232, s[56:59], s26 offen offset:0 lds
    buffer_load_dwordx4 v233, s[56:59], s26 offen offset:1024 lds
    buffer_load_dwordx4 v234, s[56:59], s26 offen offset:2048 lds
    buffer_load_dwordx4 v235, s[56:59], s26 offen offset:3072 lds
    s_waitcnt vmcnt(16)
    s_add_u32 s67, s72, 147456
    s_sub_u32 s67, s67, s17
    v_add_u32 v12, s67, v236
    v_add_u32 v13, s67, v237
    ds_read_b64_tr_b16 a[0:1], v12 offset:0
    ds_read_b64_tr_b16 a[2:3], v12 offset:1024
    ds_read_b64_tr_b16 a[4:5], v13 offset:0
    ds_read_b64_tr_b16 a[6:7], v13 offset:1024
    ds_read_b64_tr_b16 a[8:9], v12 offset:2048
    ds_read_b64_tr_b16 a[10:11], v12 offset:3072
    ds_read_b64_tr_b16 a[12:13], v13 offset:2048
    ds_read_b64_tr_b16 a[14:15], v13 offset:3072
    s_add_u32 s67, s72, 32768
    s_sub_u32 s67, s67, s17
    v_add_u32 v10, s67, v236
    v_add_u32 v11, s67, v237
    ds_read_b64_tr_b16 a[16:17], v10 offset:0
    ds_read_b64_tr_b16 a[18:19], v10 offset:1024
    ds_read_b64_tr_b16 a[20:21], v11 offset:0
    ds_read_b64_tr_b16 a[22:23], v11 offset:1024
    ds_read_b64_tr_b16 a[24:25], v10 offset:2048
    ds_read_b64_tr_b16 a[26:27], v10 offset:3072
    ds_read_b64_tr_b16 a[28:29], v11 offset:2048
    ds_read_b64_tr_b16 a[30:31], v11 offset:3072
    s_add_u32 s67, s72, 114688
    s_sub_u32 s67, s67, s17
    v_add_u32 v12, s67, v236
    v_add_u32 v13, s67, v237
    ds_read_b64_tr_b16 a[32:33], v12 offset:0
    ds_read_b64_tr_b16 a[34:35], v12 offset:1024
    ds_read_b64_tr_b16 a[36:37], v13 offset:0
    ds_read_b64_tr_b16 a[38:39], v13 offset:1024
    ds_read_b64_tr_b16 a[40:41], v12 offset:2048
    ds_read_b64_tr_b16 a[42:43], v12 offset:3072
    ds_read_b64_tr_b16 a[44:45], v13 offset:2048
    ds_read_b64_tr_b16 a[46:47], v13 offset:3072
    s_add_u32 s67, s72, 131072
    s_sub_u32 s67, s67, s17
    v_add_u32 v10, s67, v236
    v_add_u32 v11, s67, v237
    ds_read_b64_tr_b16 a[48:49], v10 offset:0
    ds_read_b64_tr_b16 a[50:51], v10 offset:1024
    ds_read_b64_tr_b16 a[52:53], v11 offset:0
    ds_read_b64_tr_b16 a[54:55], v11 offset:1024
    ds_read_b64_tr_b16 a[56:57], v10 offset:2048
    ds_read_b64_tr_b16 a[58:59], v10 offset:3072
    ds_read_b64_tr_b16 a[60:61], v11 offset:2048
    ds_read_b64_tr_b16 a[62:63], v11 offset:3072
    v_mov_b32 v15, 2130706432
    buffer_store_dword v15, v15, s[52:55], 0 offen
    buffer_store_dword v15, v15, s[52:55], 0 offen
    buffer_store_dword v15, v15, s[52:55], 0 offen
    buffer_store_dword v15, v15, s[52:55], 0 offen
    v_mov_b32 v240, v232
    v_mov_b32 v241, v233
    v_mov_b32 v242, v234
    v_mov_b32 v243, v235
    v_mov_b32 v4, v236
    v_mov_b32 v5, v237
    s_branch L_p2
L_notF:
    s_cmp_lt_u32 s66, 13
    s_cbranch_scc0 L_Q
    s_lshl_b32 s67, s77, 2
    s_lshr_b32 s78, 0xDB9630, s67
    s_and_b32 s78, s78, 15
    s_lshr_b32 s79, 0x322333, s67
    s_and_b32 s79, s79, 15
    s_lshl_b32 s68, s77, 7
    s_mul_i32 s92, s78, 56
    s_sub_u32 s92, s92, s68
    s_add_u32 s90, s92, 56
    s_add_u32 s91, s92, 112
    s_cmp_eq_u32 s79, 3
    s_cselect_b32 s91, s91, s92
    v_bfe_u32 v10, v1, 2, 2
    v_and_b32 v11, 3, v1
    v_bfe_u32 v12, v1, 4, 1
    v_lshrrev_b32 v13, 5, v1
    v_lshlrev_b32 v11, 3, v11
    v_lshl_add_u32 v11, v12, 5, v11
    v_lshlrev_b32 v14, 8, v10
    v_lshl_add_u32 v14, v13, 11, v14
    v_lshlrev_b32 v10, 6, v10
    v_add_u32 v15, s92, v11
    v_xor_b32 v15, v15, v10
    v_add_u32 v176, v15, v14
    v_add_u32 v177, 0x10000, v176
    v_add_u32 v178, 0x20000, v176
    v_add_u32 v15, s90, v11
    v_xor_b32 v15, v15, v10
    v_add_u32 v179, v15, v14
    v_add_u32 v180, 0x10000, v179
    v_add_u32 v181, 0x20000, v179
    v_add_u32 v15, s91, v11
    v_xor_b32 v15, v15, v10
    v_add_u32 v182, v15, v14
    v_add_u32 v183, 0x10000, v182
    v_add_u32 v184, 0x20000, v182
    s_add_u32 s20, s3, 0
    s_cmp_ge_u32 s20, 7
    s_cselect_b32 s7, 7, 0
    s_sub_u32 s20, s20, s7
    s_mul_i32 s20, s20, 172032
    s_add_u32 s29, s19, 0
    s_cmp_ge_u32 s29, 7
    s_cselect_b32 s7, 7, 0
    s_sub_u32 s29, s29, s7
    s_add_u32 s21, s3, 1
    s_cmp_ge_u32 s21, 7
    s_cselect_b32 s7, 7, 0
    s_sub_u32 s21, s21, s7
    s_mul_i32 s21, s21, 172032
    s_add_u32 s30, s19, 1
    s_cmp_ge_u32 s30, 7
    s_cselect_b32 s7, 7, 0
    s_sub_u32 s30, s30, s7
    s_add_u32 s22, s3, 2
    s_cmp_ge_u32 s22, 7
    s_cselect_b32 s7, 7, 0
    s_sub_u32 s22, s22, s7
    s_mul_i32 s22, s22, 172032
    s_add_u32 s31, s19, 2
    s_cmp_ge_u32 s31, 7
    s_cselect_b32 s7, 7, 0
    s_sub_u32 s31, s31, s7
    s_add_u32 s23, s3, 3
    s_cmp_ge_u32 s23, 7
    s_cselect_b32 s7, 7, 0
    s_sub_u32 s23, s23, s7
    s_mul_i32 s23, s23, 172032
    s_add_u32 s32, s19, 3
    s_cmp_ge_u32 s32, 7
    s_cselect_b32 s7, 7, 0
    s_sub_u32 s32, s32, s7
    s_add_u32 s24, s3, 4
    s_cmp_ge_u32 s24, 7
    s_cselect_b32 s7, 7, 0
    s_sub_u32 s24, s24, s7
    s_mul_i32 s24, s24, 172032
    s_add_u32 s33, s19, 4
    s_cmp_ge_u32 s33, 7
    s_cselect_b32 s7, 7, 0
    s_sub_u32 s33, s33, s7
    s_add_u32 s25, s3, 5
    s_cmp_ge_u32 s25, 7
    s_cselect_b32 s7, 7, 0
    s_sub_u32 s25, s25, s7
    s_mul_i32 s25, s25, 172032
    s_add_u32 s36, s19, 5
    s_cmp_ge_u32 s36, 7
    s_cselect_b32 s7, 7, 0
    s_sub_u32 s36, s36, s7
    s_add_u32 s28, s3, 6
    s_cmp_ge_u32 s28, 7
    s_cselect_b32 s7, 7, 0
    s_sub_u32 s28, s28, s7
    s_mul_i32 s28, s28, 172032
    s_add_u32 s37, s19, 6
    s_cmp_ge_u32 s37, 7
    s_cselect_b32 s7, 7, 0
    s_sub_u32 s37, s37, s7
    v_lshrrev_b32 v10, 3, v1
    v_mul_u32_u24 v10, 896, v10
    v_bfe_u32 v11, v1, 4, 1
    v_lshlrev_b32 v11, 2, v11
    v_and_b32 v12, 7, v1
    v_xor_b32 v12, v12, v11
    v_lshl_add_u32 v244, v12, 4, v10
    v_add_u32 v245, 6144, v244
    v_add_u32 v246, 12288, v244
    v_add_u32 v247, 18432, v244
    v_bfe_u32 v10, v1, 2, 2
    v_lshrrev_b32 v11, 5, v1
    v_lshl_add_u32 v11, v11, 2, v10
    v_lshlrev_b32 v11, 7, v11
    v_and_b32 v12, 3, v1
    v_lshlrev_b32 v12, 3, v12
    v_bfe_u32 v13, v1, 4, 1
    v_lshl_add_u32 v12, v13, 5, v12
    v_add_u32 v11, v11, v12
    v_add_u32 v11, s17, v11
    v_lshrrev_b32 v10, 1, v10
    s_and_b32 s67, s64, 1
    v_xor_b32 v10, s67, v10
    v_lshlrev_b32 v10, 6, v10
    v_add_u32 v252, v11, v10
    v_xor_b32 v10, 64, v10
    v_add_u32 v253, v11, v10
    s_cmp_lg_u32 s65, 0
    s_cbranch_scc1 noz_5
    v_mov_b32 v112, 0
    v_mov_b32 v113, 0
    v_mov_b32 v114, 0
    v_mov_b32 v115, 0
    s_lshl_b32 s68, s78, 12
    s_lshl_b32 s69, s64, 10
    s_add_u32 s68, s68, s69
    s_add_u32 s68, s68, 9445376
    buffer_store_dwordx4 v[112:115], v9, s[52:55], s68 offen sc1
    s_add_u32 s68, s68, 4096
    buffer_store_dwordx4 v[112:115], v9, s[52:55], s68 offen sc1
    s_add_u32 s68, s68, 4096
    s_cmp_eq_u32 s79, 3
    s_cselect_b32 s69, 0, 2130706432
    v_or_b32 v116, s69, v9
    buffer_store_dwordx4 v[112:115], v116, s[52:55], s68 offen sc1
    s_waitcnt vmcnt(0)
    s_barrier
    s_cmp_lg_u32 s64, 0
    s_cbranch_scc1 noz_5
    s_lshl_b32 s68, s77, 2
    s_add_u32 s68, s68, 64
    v_mov_b32 v112, 1
    v_mov_b32 v113, 0
    s_mov_b64 exec, 1
    buffer_store_dword v112, v113, s[8:11], s68 offen sc1
    s_mov_b64 exec, -1
noz_5:
    s_waitcnt vmcnt(13)
    ds_read_b128 a[0:3], v5 offset:0
    ds_read_b128 a[4:7], v6 offset:0
    ds_read_b128 a[8:11], v7 offset:0
    ds_read_b128 a[12:15], v8 offset:0
    s_waitcnt vmcnt(9)
    s_waitcnt lgkmcnt(0)
    s_barrier
    ds_read_b64_tr_b16 v[16:17], v177 offset:49152
    ds_read_b64_tr_b16 v[18:19], v177 offset:50176
    ds_read_b64_tr_b16 v[20:21], v180 offset:49152
    ds_read_b64_tr_b16 v[22:23], v180 offset:50176
    ds_read_b64_tr_b16 v[24:25], v183 offset:49152
    ds_read_b64_tr_b16 v[26:27], v183 offset:50176
    s_waitcnt lgkmcnt(0)
    v_mfma_f32_32x32x16_bf16 v[48:63], a[0:3], v[16:19], 0
    s_add_u32 m0, s72, 32768
    s_add_u32 s100, s3, 2
    s_cmp_ge_u32 s100, 7
    s_cselect_b32 s7, 7, 0
    s_sub_u32 s100, s100, s7
    s_lshl_b32 s100, s100, 7
    s_add_u32 s100, s100, s73
    ds_read_b64_tr_b16 v[32:33], v177 offset:53248
    ds_read_b64_tr_b16 v[34:35], v177 offset:54272
    ds_read_b64_tr_b16 v[36:37], v180 offset:53248
    ds_read_b64_tr_b16 v[38:39], v180 offset:54272
    buffer_load_dwordx4 v188, s[44:47], s100 offen offset:0 lds
    v_mfma_f32_32x32x16_bf16 v[64:79], a[0:3], v[20:23], 0
    ds_read_b64_tr_b16 v[40:41], v183 offset:53248
    ds_read_b64_tr_b16 v[42:43], v183 offset:54272
    buffer_load_dwordx4 v189, s[44:47], s100 offen offset:1024 lds
    v_mfma_f32_32x32x16_bf16 v[80:95], a[0:3], v[24:27], 0
    buffer_load_dwordx4 v190, s[44:47], s100 offen offset:2048 lds
    s_waitcnt lgkmcnt(0)
    v_mfma_f32_32x32x16_bf16 v[48:63], a[4:7], v[32:35], v[48:63]
    ds_read_b64_tr_b16 v[16:17], v177 offset:57344
    ds_read_b64_tr_b16 v[18:19], v177 offset:58368
    ds_read_b64_tr_b16 v[20:21], v180 offset:57344
    ds_read_b64_tr_b16 v[22:23], v180 offset:58368
    buffer_load_dwordx4 v191, s[44:47], s100 offen offset:3072 lds
    v_mfma_f32_32x32x16_bf16 v[64:79], a[4:7], v[36:39], v[64:79]
    s_add_u32 m0, s72, 0
    s_add_u32 s101, s22, s74
    ds_read_b64_tr_b16 v[24:25], v183 offset:57344
    ds_read_b64_tr_b16 v[26:27], v183 offset:58368
    buffer_load_dwordx4 v208, s[48:51], s101 offen offset:0 lds
    v_mfma_f32_32x32x16_bf16 v[80:95], a[4:7], v[40:43], v[80:95]
    buffer_load_dwordx4 v209, s[48:51], s101 offen offset:1024 lds
    s_waitcnt lgkmcnt(0)
    v_mfma_f32_32x32x16_bf16 v[48:63], a[8:11], v[16:19], v[48:63]
    ds_read_b64_tr_b16 v[32:33], v177 offset:61440
    ds_read_b64_tr_b16 v[34:35], v177 offset:62464
    ds_read_b64_tr_b16 v[36:37], v180 offset:61440
    ds_read_b64_tr_b16 v[38:39], v180 offset:62464
    buffer_load_dwordx4 v210, s[48:51], s101 offen offset:2048 lds
    s_waitcnt vmcnt(11)
    ds_read_b128 a[16:19], v5 offset:16384
    v_mfma_f32_32x32x16_bf16 v[64:79], a[8:11], v[20:23], v[64:79]
    ds_read_b64_tr_b16 v[40:41], v183 offset:61440
    ds_read_b64_tr_b16 v[42:43], v183 offset:62464
    buffer_load_dwordx4 v211, s[48:51], s101 offen offset:3072 lds
    ds_read_b128 a[20:23], v6 offset:16384
    v_mfma_f32_32x32x16_bf16 v[80:95], a[8:11], v[24:27], v[80:95]
    ds_read_b128 a[24:27], v7 offset:16384
    ds_read_b128 a[28:31], v8 offset:16384
    s_sub_u32 s68, s66, 7
    s_lshl_b32 s68, s68, 4
    s_add_u32 s68, s68, s65
    s_lshl_b32 s68, s68, 2
    s_add_u32 s68, s68, s64
    v_lshlrev_b32 v2, 7, v1
    s_mul_i32 s69, s68, 2816
    s_mov_b64 exec, 4194303
    buffer_load_dword v3, v2, s[56:59], s69 offen
    s_mul_i32 s69, s68, 768
    s_mov_b64 exec, 63
    buffer_load_dword v4, v2, s[60:63], s69 offen
    s_mov_b64 exec, -1
    s_waitcnt lgkmcnt(3)
    v_mfma_f32_32x32x16_bf16 v[48:63], a[12:15], v[32:35], v[48:63]
    s_waitcnt vmcnt(10)
    s_waitcnt lgkmcnt(0)
    s_barrier
    ds_read_b64_tr_b16 v[16:17], v178 offset:0
    ds_read_b64_tr_b16 v[18:19], v178 offset:1024
    ds_read_b64_tr_b16 v[20:21], v181 offset:0
    ds_read_b64_tr_b16 v[22:23], v181 offset:1024
    v_mfma_f32_32x32x16_bf16 v[64:79], a[12:15], v[36:39], v[64:79]
    ds_read_b64_tr_b16 v[24:25], v184 offset:0
    ds_read_b64_tr_b16 v[26:27], v184 offset:1024
    v_mfma_f32_32x32x16_bf16 v[80:95], a[12:15], v[40:43], v[80:95]
    s_add_u32 m0, s72, 16384
    s_add_u32 s101, s23, s74
    buffer_load_dwordx4 v208, s[48:51], s101 offen offset:0 lds
    s_waitcnt lgkmcnt(0)
    v_mfma_f32_32x32x16_bf16 v[48:63], a[16:19], v[16:19], v[48:63]
    ds_read_b64_tr_b16 v[32:33], v178 offset:4096
    ds_read_b64_tr_b16 v[34:35], v178 offset:5120
    ds_read_b64_tr_b16 v[36:37], v181 offset:4096
    ds_read_b64_tr_b16 v[38:39], v181 offset:5120
    v_mfma_f32_32x32x16_bf16 v[64:79], a[16:19], v[20:23], v[64:79]
    ds_read_b64_tr_b16 v[40:41], v184 offset:4096
    ds_read_b64_tr_b16 v[42:43], v184 offset:5120
    buffer_load_dwordx4 v209, s[48:51], s101 offen offset:1024 lds
    v_mfma_f32_32x32x16_bf16 v[80:95], a[16:19], v[24:27], v[80:95]
    buffer_load_dwordx4 v210, s[48:51], s101 offen offset:2048 lds
    s_waitcnt lgkmcnt(0)
    v_mfma_f32_32x32x16_bf16 v[48:63], a[20:23], v[32:35], v[48:63]
    ds_read_b64_tr_b16 v[16:17], v178 offset:8192
    ds_read_b64_tr_b16 v[18:19], v178 offset:9216
    ds_read_b64_tr_b16 v[20:21], v181 offset:8192
    ds_read_b64_tr_b16 v[22:23], v181 offset:9216
    buffer_load_dwordx4 v211, s[48:51], s101 offen offset:3072 lds
    v_mfma_f32_32x32x16_bf16 v[64:79], a[20:23], v[36:39], v[64:79]
    s_add_u32 m0, s72, 49152
    s_add_u32 s100, s3, 3
    s_cmp_ge_u32 s100, 7
    s_cselect_b32 s7, 7, 0
    s_sub_u32 s100, s100, s7
    s_lshl_b32 s100, s100, 7
    s_add_u32 s100, s100, s73
    ds_read_b64_tr_b16 v[24:25], v184 offset:8192
    ds_read_b64_tr_b16 v[26:27], v184 offset:9216
    buffer_load_dwordx4 v188, s[44:47], s100 offen offset:0 lds
    v_mfma_f32_32x32x16_bf16 v[80:95], a[20:23], v[40:43], v[80:95]
    buffer_load_dwordx4 v189, s[44:47], s100 offen offset:1024 lds
    s_waitcnt lgkmcnt(0)
    v_mfma_f32_32x32x16_bf16 v[48:63], a[24:27], v[16:19], v[48:63]
    ds_read_b64_tr_b16 v[32:33], v178 offset:12288
    ds_read_b64_tr_b16 v[34:35], v178 offset:13312
    ds_read_b64_tr_b16 v[36:37], v181 offset:12288
    ds_read_b64_tr_b16 v[38:39], v181 offset:13312
    buffer_load_dwordx4 v190, s[44:47], s100 offen offset:2048 lds
    s_waitcnt vmcnt(13)
    ds_read_b128 a[32:35], v5 offset:32768
    v_mfma_f32_32x32x16_bf16 v[64:79], a[24:27], v[20:23], v[64:79]
    ds_read_b64_tr_b16 v[40:41], v184 offset:12288
    ds_read_b64_tr_b16 v[42:43], v184 offset:13312
    buffer_load_dwordx4 v191, s[44:47], s100 offen offset:3072 lds
    ds_read_b128 a[36:39], v6 offset:32768
    v_mfma_f32_32x32x16_bf16 v[80:95], a[24:27], v[24:27], v[80:95]
    ds_read_b128 a[40:43], v7 offset:32768
    ds_read_b128 a[44:47], v8 offset:32768
    s_waitcnt lgkmcnt(3)
    v_mfma_f32_32x32x16_bf16 v[48:63], a[28:31], v[32:35], v[48:63]
    s_waitcnt vmcnt(10)
    s_waitcnt lgkmcnt(0)
    s_barrier
    ds_read_b64_tr_b16 v[16:17], v176 offset:0
    ds_read_b64_tr_b16 v[18:19], v176 offset:1024
    ds_read_b64_tr_b16 v[20:21], v179 offset:0
    ds_read_b64_tr_b16 v[22:23], v179 offset:1024
    s_add_u32 m0, s72, 32768
    s_add_u32 s101, s24, s74
    buffer_load_dwordx4 v208, s[48:51], s101 offen offset:0 lds
    buffer_load_dwordx4 v209, s[48:51], s101 offen offset:1024 lds
    v_mfma_f32_32x32x16_bf16 v[64:79], a[28:31], v[36:39], v[64:79]
    ds_read_b64_tr_b16 v[24:25], v182 offset:0
    ds_read_b64_tr_b16 v[26:27], v182 offset:1024
    buffer_load_dwordx4 v210, s[48:51], s101 offen offset:2048 lds
    buffer_load_dwordx4 v211, s[48:51], s101 offen offset:3072 lds
    v_mfma_f32_32x32x16_bf16 v[80:95], a[28:31], v[40:43], v[80:95]
    s_add_u32 m0, s72, 65536
    s_add_u32 s100, s3, 4
    s_cmp_ge_u32 s100, 7
    s_cselect_b32 s7, 7, 0
    s_sub_u32 s100, s100, s7
    s_lshl_b32 s100, s100, 7
    s_add_u32 s100, s100, s73
    buffer_load_dwordx4 v188, s[44:47], s100 offen offset:0 lds
    buffer_load_dwordx4 v189, s[44:47], s100 offen offset:1024 lds
    s_waitcnt lgkmcnt(0)
    v_mfma_f32_32x32x16_bf16 v[48:63], a[32:35], v[16:19], v[48:63]
    ds_read_b64_tr_b16 v[32:33], v176 offset:4096
    ds_read_b64_tr_b16 v[34:35], v176 offset:5120
    ds_read_b64_tr_b16 v[36:37], v179 offset:4096
    ds_read_b64_tr_b16 v[38:39], v179 offset:5120
    buffer_load_dwordx4 v190, s[44:47], s100 offen offset:2048 lds
    buffer_load_dwordx4 v191, s[44:47], s100 offen offset:3072 lds
    v_mfma_f32_32x32x16_bf16 v[64:79], a[32:35], v[20:23], v[64:79]
    s_add_u32 m0, s72, 114688
    s_add_u32 s101, s25, s74
    ds_read_b64_tr_b16 v[40:41], v182 offset:4096
    ds_read_b64_tr_b16 v[42:43], v182 offset:5120
    buffer_load_dwordx4 v208, s[48:51], s101 offen offset:0 lds
    v_mfma_f32_32x32x16_bf16 v[80:95], a[32:35], v[24:27], v[80:95]
    buffer_load_dwordx4 v209, s[48:51], s101 offen offset:1024 lds
    s_waitcnt lgkmcnt(0)
    v_mfma_f32_32x32x16_bf16 v[48:63], a[36:39], v[32:35], v[48:63]
    ds_read_b64_tr_b16 v[16:17], v176 offset:8192
    ds_read_b64_tr_b16 v[18:19], v176 offset:9216
    ds_read_b64_tr_b16 v[20:21], v179 offset:8192
    ds_read_b64_tr_b16 v[22:23], v179 offset:9216
    buffer_load_dwordx4 v210, s[48:51], s101 offen offset:2048 lds
    v_mfma_f32_32x32x16_bf16 v[64:79], a[36:39], v[36:39], v[64:79]
    ds_read_b64_tr_b16 v[24:25], v182 offset:8192
    ds_read_b64_tr_b16 v[26:27], v182 offset:9216
    buffer_load_dwordx4 v211, s[48:51], s101 offen offset:3072 lds
    v_mfma_f32_32x32x16_bf16 v[80:95], a[36:39], v[40:43], v[80:95]
    s_add_u32 m0, s72, 81920
    s_add_u32 s100, s3, 5
    s_cmp_ge_u32 s100, 7
    s_cselect_b32 s7, 7, 0
    s_sub_u32 s100, s100, s7
    s_lshl_b32 s100, s100, 7
    s_add_u32 s100, s100, s73
    buffer_load_dwordx4 v188, s[44:47], s100 offen offset:0 lds
    s_waitcnt lgkmcnt(0)
    v_mfma_f32_32x32x16_bf16 v[48:63], a[40:43], v[16:19], v[48:63]
    ds_read_b64_tr_b16 v[32:33], v176 offset:12288
    ds_read_b64_tr_b16 v[34:35], v176 offset:13312
    ds_read_b64_tr_b16 v[36:37], v179 offset:12288
    ds_read_b64_tr_b16 v[38:39], v179 offset:13312
    buffer_load_dwordx4 v189, s[44:47], s100 offen offset:1024 lds
    s_waitcnt vmcnt(14)
    ds_read_b128 a[48:51], v5 offset:49152
    v_mfma_f32_32x32x16_bf16 v[64:79], a[40:43], v[20:23], v[64:79]
    ds_read_b64_tr_b16 v[40:41], v182 offset:12288
    ds_read_b64_tr_b16 v[42:43], v182 offset:13312
    buffer_load_dwordx4 v190, s[44:47], s100 offen offset:2048 lds
    ds_read_b128 a[52:55], v6 offset:49152
    v_mfma_f32_32x32x16_bf16 v[80:95], a[40:43], v[24:27], v[80:95]
    buffer_load_dwordx4 v191, s[44:47], s100 offen offset:3072 lds
    ds_read_b128 a[56:59], v7 offset:49152
    ds_read_b128 a[60:63], v8 offset:49152
    s_waitcnt lgkmcnt(3)
    v_mfma_f32_32x32x16_bf16 v[48:63], a[44:47], v[32:35], v[48:63]
    s_barrier
    ds_read_b64_tr_b16 v[16:17], v176 offset:16384
    ds_read_b64_tr_b16 v[18:19], v176 offset:17408
    ds_read_b64_tr_b16 v[20:21], v179 offset:16384
    ds_read_b64_tr_b16 v[22:23], v179 offset:17408
    v_mfma_f32_32x32x16_bf16 v[64:79], a[44:47], v[36:39], v[64:79]
    ds_read_b64_tr_b16 v[24:25], v182 offset:16384
    ds_read_b64_tr_b16 v[26:27], v182 offset:17408
    v_mfma_f32_32x32x16_bf16 v[80:95], a[44:47], v[40:43], v[80:95]
    s_add_u32 m0, s72, 131072
    s_add_u32 s101, s28, s74
    buffer_load_dwordx4 v208, s[48:51], s101 offen offset:0 lds
    s_waitcnt lgkmcnt(0)
    v_mfma_f32_32x32x16_bf16 v[48:63], a[48:51], v[16:19], v[48:63]
    ds_read_b64_tr_b16 v[32:33], v176 offset:20480
    ds_read_b64_tr_b16 v[34:35], v176 offset:21504
    ds_read_b64_tr_b16 v[36:37], v179 offset:20480
    ds_read_b64_tr_b16 v[38:39], v179 offset:21504
    v_mfma_f32_32x32x16_bf16 v[64:79], a[48:51], v[20:23], v[64:79]
    ds_read_b64_tr_b16 v[40:41], v182 offset:20480
    ds_read_b64_tr_b16 v[42:43], v182 offset:21504
    buffer_load_dwordx4 v209, s[48:51], s101 offen offset:1024 lds
    v_mfma_f32_32x32x16_bf16 v[80:95], a[48:51], v[24:27], v[80:95]
    buffer_load_dwordx4 v210, s[48:51], s101 offen offset:2048 lds
    s_waitcnt lgkmcnt(0)
    v_mfma_f32_32x32x16_bf16 v[48:63], a[52:55], v[32:35], v[48:63]
    ds_read_b64_tr_b16 v[16:17], v176 offset:24576
    ds_read_b64_tr_b16 v[18:19], v176 offset:25600
    ds_read_b64_tr_b16 v[20:21], v179 offset:24576
    ds_read_b64_tr_b16 v[22:23], v179 offset:25600
    buffer_load_dwordx4 v211, s[48:51], s101 offen offset:3072 lds
    v_mfma_f32_32x32x16_bf16 v[64:79], a[52:55], v[36:39], v[64:79]
    s_add_u32 m0, s72, 98304
    s_add_u32 s100, s3, 6
    s_cmp_ge_u32 s100, 7
    s_cselect_b32 s7, 7, 0
    s_sub_u32 s100, s100, s7
    s_lshl_b32 s100, s100, 7
    s_add_u32 s100, s100, s73
    ds_read_b64_tr_b16 v[24:25], v182 offset:24576
    ds_read_b64_tr_b16 v[26:27], v182 offset:25600
    buffer_load_dwordx4 v188, s[44:47], s100 offen offset:0 lds
    v_mfma_f32_32x32x16_bf16 v[80:95], a[52:55], v[40:43], v[80:95]
    buffer_load_dwordx4 v189, s[44:47], s100 offen offset:1024 lds
    s_waitcnt lgkmcnt(0)
    v_mfma_f32_32x32x16_bf16 v[48:63], a[56:59], v[16:19], v[48:63]
    ds_read_b64_tr_b16 v[32:33], v176 offset:28672
    ds_read_b64_tr_b16 v[34:35], v176 offset:29696
    ds_read_b64_tr_b16 v[36:37], v179 offset:28672
    ds_read_b64_tr_b16 v[38:39], v179 offset:29696
    buffer_load_dwordx4 v190, s[44:47], s100 offen offset:2048 lds
    s_waitcnt vmcnt(15)
    v_add_u32 v5, 0x10000, v5
    v_add_u32 v6, 0x10000, v6
    v_add_u32 v7, 0x10000, v7
    v_add_u32 v8, 0x10000, v8
    ds_read_b128 a[64:67], v5 offset:0
    v_mfma_f32_32x32x16_bf16 v[64:79], a[56:59], v[20:23], v[64:79]
    ds_read_b64_tr_b16 v[40:41], v182 offset:28672
    ds_read_b64_tr_b16 v[42:43], v182 offset:29696
    buffer_load_dwordx4 v191, s[44:47], s100 offen offset:3072 lds
    ds_read_b128 a[68:71], v6 offset:0
    v_mfma_f32_32x32x16_bf16 v[80:95], a[56:59], v[24:27], v[80:95]
    ds_read_b128 a[72:75], v7 offset:0
    ds_read_b128 a[76:79], v8 offset:0
    s_waitcnt lgkmcnt(3)
    v_mfma_f32_32x32x16_bf16 v[48:63], a[60:63], v[32:35], v[48:63]
    s_barrier
    ds_read_b64_tr_b16 v[16:17], v176 offset:32768
    ds_read_b64_tr_b16 v[18:19], v176 offset:33792
    ds_read_b64_tr_b16 v[20:21], v179 offset:32768
    ds_read_b64_tr_b16 v[22:23], v179 offset:33792
    v_mfma_f32_32x32x16_bf16 v[64:79], a[60:63], v[36:39], v[64:79]
    ds_read_b64_tr_b16 v[24:25], v182 offset:32768
    ds_read_b64_tr_b16 v[26:27], v182 offset:33792
    v_mfma_f32_32x32x16_bf16 v[80:95], a[60:63], v[40:43], v[80:95]
    s_waitcnt lgkmcnt(0)
    v_mfma_f32_32x32x16_bf16 v[48:63], a[64:67], v[16:19], v[48:63]
    ds_read_b64_tr_b16 v[32:33], v176 offset:36864
    ds_read_b64_tr_b16 v[34:35], v176 offset:37888
    ds_read_b64_tr_b16 v[36:37], v179 offset:36864
    ds_read_b64_tr_b16 v[38:39], v179 offset:37888
    v_mfma_f32_32x32x16_bf16 v[64:79], a[64:67], v[20:23], v[64:79]
    ds_read_b64_tr_b16 v[40:41], v182 offset:36864
    ds_read_b64_tr_b16 v[42:43], v182 offset:37888
    v_mfma_f32_32x32x16_bf16 v[80:95], a[64:67], v[24:27], v[80:95]
    s_add_u32 m0, s72, 0
    s_add_u32 s101, s20, s75
    buffer_load_dwordx4 v208, s[48:51], s101 offen offset:0 lds
    s_waitcnt lgkmcnt(0)
    v_mfma_f32_32x32x16_bf16 v[48:63], a[68:71], v[32:35], v[48:63]
    ds_read_b64_tr_b16 v[16:17], v176 offset:40960
    ds_read_b64_tr_b16 v[18:19], v176 offset:41984
    ds_read_b64_tr_b16 v[20:21], v179 offset:40960
    ds_read_b64_tr_b16 v[22:23], v179 offset:41984
    v_mfma_f32_32x32x16_bf16 v[64:79], a[68:71], v[36:39], v[64:79]
    ds_read_b64_tr_b16 v[24:25], v182 offset:40960
    ds_read_b64_tr_b16 v[26:27], v182 offset:41984
    v_mfma_f32_32x32x16_bf16 v[80:95], a[68:71], v[40:43], v[80:95]
    buffer_load_dwordx4 v209, s[48:51], s101 offen offset:1024 lds
    s_waitcnt lgkmcnt(0)
    v_mfma_f32_32x32x16_bf16 v[48:63], a[72:75], v[16:19], v[48:63]
    ds_read_b64_tr_b16 v[32:33], v176 offset:45056
    ds_read_b64_tr_b16 v[34:35], v176 offset:46080
    ds_read_b64_tr_b16 v[36:37], v179 offset:45056
    ds_read_b64_tr_b16 v[38:39], v179 offset:46080
    buffer_load_dwordx4 v210, s[48:51], s101 offen offset:2048 lds
    s_waitcnt vmcnt(11)
    ds_read_b128 a[80:83], v5 offset:16384
    v_mfma_f32_32x32x16_bf16 v[64:79], a[72:75], v[20:23], v[64:79]
    ds_read_b64_tr_b16 v[40:41], v182 offset:45056
    ds_read_b64_tr_b16 v[42:43], v182 offset:46080
    buffer_load_dwordx4 v211, s[48:51], s101 offen offset:3072 lds
    ds_read_b128 a[84:87], v6 offset:16384
    v_mfma_f32_32x32x16_bf16 v[80:95], a[72:75], v[24:27], v[80:95]
    ds_read_b128 a[88:91], v7 offset:16384
    ds_read_b128 a[92:95], v8 offset:16384
    s_waitcnt lgkmcnt(3)
    v_mfma_f32_32x32x16_bf16 v[48:63], a[76:79], v[32:35], v[48:63]
    s_barrier
    ds_read_b64_tr_b16 v[16:17], v177 offset:49152
    ds_read_b64_tr_b16 v[18:19], v177 offset:50176
    ds_read_b64_tr_b16 v[20:21], v180 offset:49152
    ds_read_b64_tr_b16 v[22:23], v180 offset:50176
    v_mfma_f32_32x32x16_bf16 v[64:79], a[76:79], v[36:39], v[64:79]
    ds_read_b64_tr_b16 v[24:25], v183 offset:49152
    ds_read_b64_tr_b16 v[26:27], v183 offset:50176
    v_mfma_f32_32x32x16_bf16 v[80:95], a[76:79], v[40:43], v[80:95]
    s_waitcnt lgkmcnt(0)
    v_mfma_f32_32x32x16_bf16 v[48:63], a[80:83], v[16:19], v[48:63]
    ds_read_b64_tr_b16 v[32:33], v177 offset:53248
    ds_read_b64_tr_b16 v[34:35], v177 offset:54272
    ds_read_b64_tr_b16 v[36:37], v180 offset:53248
    ds_read_b64_tr_b16 v[38:39], v180 offset:54272
    v_mfma_f32_32x32x16_bf16 v[64:79], a[80:83], v[20:23], v[64:79]
    ds_read_b64_tr_b16 v[40:41], v183 offset:53248
    ds_read_b64_tr_b16 v[42:43], v183 offset:54272
    v_mfma_f32_32x32x16_bf16 v[80:95], a[80:83], v[24:27], v[80:95]
    s_add_u32 m0, s72, 16384
    s_add_u32 s101, s21, s75
    buffer_load_dwordx4 v208, s[48:51], s101 offen offset:0 lds
    v_mov_b32 v250, 0
    buffer_load_dword v250, v250, s[8:11], 0 offen sc1
    s_waitcnt lgkmcnt(0)
    v_mfma_f32_32x32x16_bf16 v[48:63], a[84:87], v[32:35], v[48:63]
    ds_read_b64_tr_b16 v[16:17], v177 offset:57344
    ds_read_b64_tr_b16 v[18:19], v177 offset:58368
    ds_read_b64_tr_b16 v[20:21], v180 offset:57344
    ds_read_b64_tr_b16 v[22:23], v180 offset:58368
    v_mfma_f32_32x32x16_bf16 v[64:79], a[84:87], v[36:39], v[64:79]
    ds_read_b64_tr_b16 v[24:25], v183 offset:57344
    ds_read_b64_tr_b16 v[26:27], v183 offset:58368
    v_mfma_f32_32x32x16_bf16 v[80:95], a[84:87], v[40:43], v[80:95]
    buffer_load_dwordx4 v209, s[48:51], s101 offen offset:1024 lds
    s_waitcnt lgkmcnt(0)
    v_mfma_f32_32x32x16_bf16 v[48:63], a[88:91], v[16:19], v[48:63]
    ds_read_b64_tr_b16 v[32:33], v177 offset:61440
    ds_read_b64_tr_b16 v[34:35], v177 offset:62464
    ds_read_b64_tr_b16 v[36:37], v180 offset:61440
    ds_read_b64_tr_b16 v[38:39], v180 offset:62464
    buffer_load_dwordx4 v210, s[48:51], s101 offen offset:2048 lds
    s_waitcnt vmcnt(8)
    ds_read_b128 a[96:99], v5 offset:32768
    v_mfma_f32_32x32x16_bf16 v[64:79], a[88:91], v[20:23], v[64:79]
    ds_read_b64_tr_b16 v[40:41], v183 offset:61440
    ds_read_b64_tr_b16 v[42:43], v183 offset:62464
    buffer_load_dwordx4 v211, s[48:51], s101 offen offset:3072 lds
    ds_read_b128 a[100:103], v6 offset:32768
    v_mfma_f32_32x32x16_bf16 v[80:95], a[88:91], v[24:27], v[80:95]
    ds_read_b128 a[104:107], v7 offset:32768
    ds_read_b128 a[108:111], v8 offset:32768
    s_waitcnt lgkmcnt(3)
    v_mfma_f32_32x32x16_bf16 v[48:63], a[92:95], v[32:35], v[48:63]
    s_barrier
    ds_read_b64_tr_b16 v[16:17], v178 offset:0
    ds_read_b64_tr_b16 v[18:19], v178 offset:1024
    ds_read_b64_tr_b16 v[20:21], v181 offset:0
    ds_read_b64_tr_b16 v[22:23], v181 offset:1024
    v_mfma_f32_32x32x16_bf16 v[64:79], a[92:95], v[36:39], v[64:79]
    ds_read_b64_tr_b16 v[24:25], v184 offset:0
    ds_read_b64_tr_b16 v[26:27], v184 offset:1024
    v_mfma_f32_32x32x16_bf16 v[80:95], a[92:95], v[40:43], v[80:95]
    s_waitcnt lgkmcnt(0)
    v_mfma_f32_32x32x16_bf16 v[48:63], a[96:99], v[16:19], v[48:63]
    ds_read_b64_tr_b16 v[32:33], v178 offset:4096
    ds_read_b64_tr_b16 v[34:35], v178 offset:5120
    ds_read_b64_tr_b16 v[36:37], v181 offset:4096
    ds_read_b64_tr_b16 v[38:39], v181 offset:5120
    v_mfma_f32_32x32x16_bf16 v[64:79], a[96:99], v[20:23], v[64:79]
    s_add_u32 m0, s17, 0
    s_mul_i32 s26, s29, 229376
    s_add_u32 s26, s26, s16
    ds_read_b64_tr_b16 v[40:41], v184 offset:4096
    ds_read_b64_tr_b16 v[42:43], v184 offset:5120
    buffer_load_dwordx4 v244, s[56:59], s26 offen offset:0 lds
    v_mfma_f32_32x32x16_bf16 v[80:95], a[96:99], v[24:27], v[80:95]
    s_add_u32 m0, s72, 32768
    s_add_u32 s101, s22, s75
    buffer_load_dwordx4 v208, s[48:51], s101 offen offset:0 lds
    s_waitcnt lgkmcnt(0)
    v_mfma_f32_32x32x16_bf16 v[48:63], a[100:103], v[32:35], v[48:63]
    ds_read_b64_tr_b16 v[16:17], v178 offset:8192
    ds_read_b64_tr_b16 v[18:19], v178 offset:9216
    ds_read_b64_tr_b16 v[20:21], v181 offset:8192
    ds_read_b64_tr_b16 v[22:23], v181 offset:9216
    v_mfma_f32_32x32x16_bf16 v[64:79], a[100:103], v[36:39], v[64:79]
    s_add_u32 m0, s17, 0
    ds_read_b64_tr_b16 v[24:25], v184 offset:8192
    ds_read_b64_tr_b16 v[26:27], v184 offset:9216
    buffer_load_dwordx4 v245, s[56:59], s26 offen offset:1024 lds
    v_mfma_f32_32x32x16_bf16 v[80:95], a[100:103], v[40:43], v[80:95]
    s_add_u32 m0, s72, 32768
    s_nop 0
    buffer_load_dwordx4 v209, s[48:51], s101 offen offset:1024 lds
    s_waitcnt lgkmcnt(0)
    v_mfma_f32_32x32x16_bf16 v[48:63], a[104:107], v[16:19], v[48:63]
    ds_read_b64_tr_b16 v[32:33], v178 offset:12288
    ds_read_b64_tr_b16 v[34:35], v178 offset:13312
    ds_read_b64_tr_b16 v[36:37], v181 offset:12288
    ds_read_b64_tr_b16 v[38:39], v181 offset:13312
    buffer_load_dwordx4 v210, s[48:51], s101 offen offset:2048 lds
    v_mfma_f32_32x32x16_bf16 v[64:79], a[104:107], v[20:23], v[64:79]
    ds_read_b64_tr_b16 v[40:41], v184 offset:12288
    ds_read_b64_tr_b16 v[42:43], v184 offset:13312
    buffer_load_dwordx4 v211, s[48:51], s101 offen offset:3072 lds
    v_mfma_f32_32x32x16_bf16 v[80:95], a[104:107], v[24:27], v[80:95]
    s_add_u32 m0, s17, 0
    s_nop 0
    buffer_load_dwordx4 v246, s[56:59], s26 offen offset:2048 lds
    s_waitcnt lgkmcnt(0)
    v_mfma_f32_32x32x16_bf16 v[48:63], a[108:111], v[32:35], v[48:63]
    s_waitcnt vmcnt(12)
    s_barrier
    ds_read_b64_tr_b16 v[16:17], v176 offset:0
    ds_read_b64_tr_b16 v[18:19], v176 offset:1024
    ds_read_b64_tr_b16 v[20:21], v179 offset:0
    ds_read_b64_tr_b16 v[22:23], v179 offset:1024
    v_mfma_f32_32x32x16_bf16 v[64:79], a[108:111], v[36:39], v[64:79]
    ds_read_b64_tr_b16 v[24:25], v182 offset:0
    ds_read_b64_tr_b16 v[26:27], v182 offset:1024
    buffer_load_dwordx4 v247, s[56:59], s26 offen offset:3072 lds
    v_mfma_f32_32x32x16_bf16 v[80:95], a[108:111], v[40:43], v[80:95]
    s_waitcnt lgkmcnt(0)
    v_mfma_f32_32x32x16_bf16 v[112:127], a[0:3], v[16:19], 0
    ds_read_b64_tr_b16 v[32:33], v176 offset:4096
    ds_read_b64_tr_b16 v[34:35], v176 offset:5120
    ds_read_b64_tr_b16 v[36:37], v179 offset:4096
    ds_read_b64_tr_b16 v[38:39], v179 offset:5120
    v_mul_f32 v204, s88, v48
    v_mfma_f32_32x32x16_bf16 v[128:143], a[0:3], v[20:23], 0
    s_add_u32 m0, s17, 4096
    s_mul_i32 s26, s30, 229376
    s_add_u32 s26, s26, s16
    ds_read_b64_tr_b16 v[40:41], v182 offset:4096
    ds_read_b64_tr_b16 v[42:43], v182 offset:5120
    buffer_load_dwordx4 v244, s[56:59], s26 offen offset:0 lds
    v_mfma_f32_32x32x16_bf16 v[144:159], a[0:3], v[24:27], 0
    s_add_u32 m0, s72, 114688
    s_add_u32 s101, s23, s75
    buffer_load_dwordx4 v208, s[48:51], s101 offen offset:0 lds
    v_mul_f32 v205, s88, v49
    v_exp_f32_e64 v204, v204 clamp
    v_exp_f32_e64 v205, v205 clamp
    v_max_f32 v48, 0, v48
    s_waitcnt lgkmcnt(0)
    v_mfma_f32_32x32x16_bf16 v[112:127], a[4:7], v[32:35], v[112:127]
    ds_read_b64_tr_b16 v[16:17], v176 offset:8192
    ds_read_b64_tr_b16 v[18:19], v176 offset:9216
    ds_read_b64_tr_b16 v[20:21], v179 offset:8192
    ds_read_b64_tr_b16 v[22:23], v179 offset:9216
    v_max_f32 v49, 0, v49
    v_mfma_f32_32x32x16_bf16 v[128:143], a[4:7], v[36:39], v[128:143]
    s_add_u32 m0, s17, 4096
    ds_read_b64_tr_b16 v[24:25], v182 offset:8192
    ds_read_b64_tr_b16 v[26:27], v182 offset:9216
    buffer_load_dwordx4 v245, s[56:59], s26 offen offset:1024 lds
    v_mfma_f32_32x32x16_bf16 v[144:159], a[4:7], v[40:43], v[144:159]
    s_add_u32 m0, s72, 114688
    s_nop 0
    buffer_load_dwordx4 v209, s[48:51], s101 offen offset:1024 lds
    v_add_f32 v204, s89, v204
    v_add_f32 v205, s89, v205
    v_add_f32 v48, v48, v204
    v_add_f32 v49, v49, v205
    s_waitcnt lgkmcnt(0)
    v_mfma_f32_32x32x16_bf16 v[112:127], a[8:11], v[16:19], v[112:127]
    ds_read_b64_tr_b16 v[32:33], v176 offset:12288
    ds_read_b64_tr_b16 v[34:35], v176 offset:13312
    ds_read_b64_tr_b16 v[36:37], v179 offset:12288
    ds_read_b64_tr_b16 v[38:39], v179 offset:13312
    buffer_load_dwordx4 v210, s[48:51], s101 offen offset:2048 lds
    v_mfma_f32_32x32x16_bf16 v[128:143], a[8:11], v[20:23], v[128:143]
    ds_read_b64_tr_b16 v[40:41], v182 offset:12288
    ds_read_b64_tr_b16 v[42:43], v182 offset:13312
    buffer_load_dwordx4 v211, s[48:51], s101 offen offset:3072 lds
    v_mfma_f32_32x32x16_bf16 v[144:159], a[8:11], v[24:27], v[144:159]
    s_add_u32 m0, s17, 4096
    s_nop 0
    buffer_load_dwordx4 v246, s[56:59], s26 offen offset:2048 lds
    v_cvt_pk_bf16_f32 v220, v48, v49
    v_mul_f32 v204, s88, v50
    v_mul_f32 v205, s88, v51
    v_exp_f32_e64 v204, v204 clamp
    s_waitcnt lgkmcnt(0)
    v_mfma_f32_32x32x16_bf16 v[112:127], a[12:15], v[32:35], v[112:127]
    s_waitcnt vmcnt(15)
    s_barrier
    ds_read_b64_tr_b16 v[16:17], v176 offset:16384
    ds_read_b64_tr_b16 v[18:19], v176 offset:17408
    ds_read_b64_tr_b16 v[20:21], v179 offset:16384
    ds_read_b64_tr_b16 v[22:23], v179 offset:17408
    v_exp_f32_e64 v205, v205 clamp
    v_mfma_f32_32x32x16_bf16 v[128:143], a[12:15], v[36:39], v[128:143]
    ds_read_b64_tr_b16 v[24:25], v182 offset:16384
    ds_read_b64_tr_b16 v[26:27], v182 offset:17408
    buffer_load_dwordx4 v247, s[56:59], s26 offen offset:3072 lds
    v_mfma_f32_32x32x16_bf16 v[144:159], a[12:15], v[40:43], v[144:159]
    v_max_f32 v50, 0, v50
    v_max_f32 v51, 0, v51
    v_add_f32 v204, s89, v204
    v_add_f32 v205, s89, v205
    v_add_f32 v50, v50, v204
    s_waitcnt lgkmcnt(0)
    v_mfma_f32_32x32x16_bf16 v[112:127], a[16:19], v[16:19], v[112:127]
    ds_read_b64_tr_b16 v[32:33], v176 offset:20480
    ds_read_b64_tr_b16 v[34:35], v176 offset:21504
    ds_read_b64_tr_b16 v[36:37], v179 offset:20480
    ds_read_b64_tr_b16 v[38:39], v179 offset:21504
    v_add_f32 v51, v51, v205
    v_mfma_f32_32x32x16_bf16 v[128:143], a[16:19], v[20:23], v[128:143]
    s_add_u32 m0, s17, 8192
    s_mul_i32 s26, s31, 229376
    s_add_u32 s26, s26, s16
    ds_read_b64_tr_b16 v[40:41], v182 offset:20480
    ds_read_b64_tr_b16 v[42:43], v182 offset:21504
    buffer_load_dwordx4 v244, s[56:59], s26 offen offset:0 lds
    v_mfma_f32_32x32x16_bf16 v[144:159], a[16:19], v[24:27], v[144:159]
    s_add_u32 m0, s72, 131072
    s_add_u32 s101, s24, s75
    buffer_load_dwordx4 v208, s[48:51], s101 offen offset:0 lds
    v_cvt_pk_bf16_f32 v221, v50, v51
    v_mul_f32 v204, s88, v52
    v_mul_f32 v205, s88, v53
    v_exp_f32_e64 v204, v204 clamp
    s_waitcnt lgkmcnt(0)
    v_mfma_f32_32x32x16_bf16 v[112:127], a[20:23], v[32:35], v[112:127]
    ds_read_b64_tr_b16 v[16:17], v176 offset:24576
    ds_read_b64_tr_b16 v[18:19], v176 offset:25600
    ds_read_b64_tr_b16 v[20:21], v179 offset:24576
    ds_read_b64_tr_b16 v[22:23], v179 offset:25600
    v_exp_f32_e64 v205, v205 clamp
    v_mfma_f32_32x32x16_bf16 v[128:143], a[20:23], v[36:39], v[128:143]
    s_add_u32 m0, s17, 8192
    ds_read_b64_tr_b16 v[24:25], v182 offset:24576
    ds_read_b64_tr_b16 v[26:27], v182 offset:25600
    buffer_load_dwordx4 v245, s[56:59], s26 offen offset:1024 lds
    v_mfma_f32_32x32x16_bf16 v[144:159], a[20:23], v[40:43], v[144:159]
    s_add_u32 m0, s72, 131072
    s_nop 0
    buffer_load_dwordx4 v209, s[48:51], s101 offen offset:1024 lds
    v_max_f32 v52, 0, v52
    v_max_f32 v53, 0, v53
    v_add_f32 v204, s89, v204
    v_add_f32 v205, s89, v205
    s_waitcnt lgkmcnt(0)
    v_mfma_f32_32x32x16_bf16 v[112:127], a[24:27], v[16:19], v[112:127]
    ds_read_b64_tr_b16 v[32:33], v176 offset:28672
    ds_read_b64_tr_b16 v[34:35], v176 offset:29696
    ds_read_b64_tr_b16 v[36:37], v179 offset:28672
    ds_read_b64_tr_b16 v[38:39], v179 offset:29696
    buffer_load_dwordx4 v210, s[48:51], s101 offen offset:2048 lds
    v_mfma_f32_32x32x16_bf16 v[128:143], a[24:27], v[20:23], v[128:143]
    ds_read_b64_tr_b16 v[40:41], v182 offset:28672
    ds_read_b64_tr_b16 v[42:43], v182 offset:29696
    buffer_load_dwordx4 v211, s[48:51], s101 offen offset:3072 lds
    v_mfma_f32_32x32x16_bf16 v[144:159], a[24:27], v[24:27], v[144:159]
    s_add_u32 m0, s17, 8192
    s_nop 0
    buffer_load_dwordx4 v246, s[56:59], s26 offen offset:2048 lds
    v_add_f32 v52, v52, v204
    v_add_f32 v53, v53, v205
    v_cvt_pk_bf16_f32 v222, v52, v53
    v_mul_f32 v204, s88, v54
    s_waitcnt lgkmcnt(0)
    v_mfma_f32_32x32x16_bf16 v[112:127], a[28:31], v[32:35], v[112:127]
    s_waitcnt vmcnt(17)
    s_barrier
    ds_read_b64_tr_b16 v[16:17], v176 offset:32768
    ds_read_b64_tr_b16 v[18:19], v176 offset:33792
    ds_read_b64_tr_b16 v[20:21], v179 offset:32768
    ds_read_b64_tr_b16 v[22:23], v179 offset:33792
    v_mul_f32 v205, s88, v55
    v_mfma_f32_32x32x16_bf16 v[128:143], a[28:31], v[36:39], v[128:143]
    ds_read_b64_tr_b16 v[24:25], v182 offset:32768
    ds_read_b64_tr_b16 v[26:27], v182 offset:33792
    buffer_load_dwordx4 v247, s[56:59], s26 offen offset:3072 lds
    v_mfma_f32_32x32x16_bf16 v[144:159], a[28:31], v[40:43], v[144:159]
    v_exp_f32_e64 v204, v204 clamp
    v_exp_f32_e64 v205, v205 clamp
    v_max_f32 v54, 0, v54
    v_max_f32 v55, 0, v55
    v_add_f32 v204, s89, v204
    s_waitcnt lgkmcnt(0)
    v_mfma_f32_32x32x16_bf16 v[112:127], a[32:35], v[16:19], v[112:127]
    ds_read_b64_tr_b16 v[32:33], v176 offset:36864
    ds_read_b64_tr_b16 v[34:35], v176 offset:37888
    ds_read_b64_tr_b16 v[36:37], v179 offset:36864
    ds_read_b64_tr_b16 v[38:39], v179 offset:37888
    v_add_f32 v205, s89, v205
    v_mfma_f32_32x32x16_bf16 v[128:143], a[32:35], v[20:23], v[128:143]
    ds_read_b64_tr_b16 v[40:41], v182 offset:36864
    ds_read_b64_tr_b16 v[42:43], v182 offset:37888
    s_waitcnt vmcnt(16)
    ds_read_b64_tr_b16 a[112:113], v252 offset:0
    ds_read_b64_tr_b16 a[114:115], v252 offset:1024
    v_mfma_f32_32x32x16_bf16 v[144:159], a[32:35], v[24:27], v[144:159]
    s_add_u32 m0, s72, 0
    s_add_u32 s101, s25, s75
    buffer_load_dwordx4 v208, s[48:51], s101 offen offset:0 lds
    v_add_f32 v54, v54, v204
    v_add_f32 v55, v55, v205
    v_cvt_pk_bf16_f32 v223, v54, v55
    v_mul_f32 v204, s88, v56
    s_waitcnt lgkmcnt(2)
    v_mfma_f32_32x32x16_bf16 v[112:127], a[36:39], v[32:35], v[112:127]
    ds_read_b64_tr_b16 v[16:17], v176 offset:40960
    ds_read_b64_tr_b16 v[18:19], v176 offset:41984
    ds_read_b64_tr_b16 v[20:21], v179 offset:40960
    ds_read_b64_tr_b16 v[22:23], v179 offset:41984
    v_mul_f32 v205, s88, v57
    v_mfma_f32_32x32x16_bf16 v[128:143], a[36:39], v[36:39], v[128:143]
    s_add_u32 m0, s17, 12288
    s_mul_i32 s26, s32, 229376
    s_add_u32 s26, s26, s16
    ds_read_b64_tr_b16 v[24:25], v182 offset:40960
    ds_read_b64_tr_b16 v[26:27], v182 offset:41984
    buffer_load_dwordx4 v244, s[56:59], s26 offen offset:0 lds
    v_mfma_f32_32x32x16_bf16 v[144:159], a[36:39], v[40:43], v[144:159]
    s_add_u32 m0, s72, 0
    s_nop 0
    buffer_load_dwordx4 v209, s[48:51], s101 offen offset:1024 lds
    v_exp_f32_e64 v204, v204 clamp
    v_exp_f32_e64 v205, v205 clamp
    v_max_f32 v56, 0, v56
    v_max_f32 v57, 0, v57
    s_waitcnt lgkmcnt(0)
    v_mfma_f32_32x32x16_bf16 v[112:127], a[40:43], v[16:19], v[112:127]
    ds_read_b64_tr_b16 v[32:33], v176 offset:45056
    ds_read_b64_tr_b16 v[34:35], v176 offset:46080
    ds_read_b64_tr_b16 v[36:37], v179 offset:45056
    ds_read_b64_tr_b16 v[38:39], v179 offset:46080
    buffer_load_dwordx4 v210, s[48:51], s101 offen offset:2048 lds
    v_mfma_f32_32x32x16_bf16 v[128:143], a[40:43], v[20:23], v[128:143]
    ds_read_b64_tr_b16 v[40:41], v182 offset:45056
    ds_read_b64_tr_b16 v[42:43], v182 offset:46080
    buffer_load_dwordx4 v211, s[48:51], s101 offen offset:3072 lds
    v_mfma_f32_32x32x16_bf16 v[144:159], a[40:43], v[24:27], v[144:159]
    s_add_u32 m0, s72, 147456
    s_mul_i32 s95, s29, 229376
    s_add_u32 s95, s95, s16
    s_add_u32 s95, s95, 114688
    buffer_load_dwordx4 v244, s[56:59], s95 offen offset:0 lds
    v_add_f32 v204, s89, v204
    v_add_f32 v205, s89, v205
    v_add_f32 v56, v56, v204
    v_add_f32 v57, v57, v205
    s_waitcnt lgkmcnt(0)
    v_mfma_f32_32x32x16_bf16 v[112:127], a[44:47], v[32:35], v[112:127]
    s_waitcnt vmcnt(16)
    s_barrier
    ds_read_b64_tr_b16 v[16:17], v177 offset:49152
    ds_read_b64_tr_b16 v[18:19], v177 offset:50176
    ds_read_b64_tr_b16 v[20:21], v180 offset:49152
    ds_read_b64_tr_b16 v[22:23], v180 offset:50176
    v_cvt_pk_bf16_f32 v224, v56, v57
    v_mfma_f32_32x32x16_bf16 v[128:143], a[44:47], v[36:39], v[128:143]
    ds_read_b64_tr_b16 v[24:25], v183 offset:49152
    ds_read_b64_tr_b16 v[26:27], v183 offset:50176
    ds_read_b64_tr_b16 a[116:117], v253 offset:0
    ds_read_b64_tr_b16 a[118:119], v253 offset:1024
    v_mfma_f32_32x32x16_bf16 v[144:159], a[44:47], v[40:43], v[144:159]
    s_add_u32 m0, s17, 12288
    s_nop 0
    buffer_load_dwordx4 v245, s[56:59], s26 offen offset:1024 lds
    v_mul_f32 v204, s88, v58
    v_mul_f32 v205, s88, v59
    v_exp_f32_e64 v204, v204 clamp
    v_exp_f32_e64 v205, v205 clamp
    s_waitcnt lgkmcnt(2)
    v_mfma_f32_32x32x16_bf16 v[112:127], a[48:51], v[16:19], v[112:127]
    ds_read_b64_tr_b16 v[32:33], v177 offset:53248
    ds_read_b64_tr_b16 v[34:35], v177 offset:54272
    ds_read_b64_tr_b16 v[36:37], v180 offset:53248
    ds_read_b64_tr_b16 v[38:39], v180 offset:54272
    v_max_f32 v58, 0, v58
    v_mfma_f32_32x32x16_bf16 v[128:143], a[48:51], v[20:23], v[128:143]
    s_add_u32 m0, s72, 147456
    ds_read_b64_tr_b16 v[40:41], v183 offset:53248
    ds_read_b64_tr_b16 v[42:43], v183 offset:54272
    buffer_load_dwordx4 v245, s[56:59], s95 offen offset:1024 lds
    v_mfma_f32_32x32x16_bf16 v[144:159], a[48:51], v[24:27], v[144:159]
    s_add_u32 m0, s72, 16384
    s_add_u32 s101, s28, s75
    buffer_load_dwordx4 v208, s[48:51], s101 offen offset:0 lds
    v_max_f32 v59, 0, v59
    v_add_f32 v204, s89, v204
    v_add_f32 v205, s89, v205
    v_add_f32 v58, v58, v204
    v_readfirstlane_b32 s76, v250
    s_nop 1
    s_cmp_lg_u32 s76, 0
    s_cbranch_scc1 nz_done_6
    s_mov_b32 s96, 0x8000
nz_7:
    v_mov_b32 v250, 0
    buffer_load_dword v250, v250, s[8:11], 0 offen sc1
    s_waitcnt vmcnt(0)
    v_readfirstlane_b32 s76, v250
    s_nop 1
    s_cmp_lg_u32 s76, 0
    s_cbranch_scc1 nz_done_6
    s_sleep 2
    s_sub_u32 s96, s96, 1
    s_cbranch_scc0 nz_7
nz_done_6:
    s_waitcnt lgkmcnt(0)
    v_mfma_f32_32x32x16_bf16 v[112:127], a[52:55], v[32:35], v[112:127]
    ds_read_b64_tr_b16 v[16:17], v177 offset:57344
    ds_read_b64_tr_b16 v[18:19], v177 offset:58368
    ds_read_b64_tr_b16 v[20:21], v180 offset:57344
    ds_read_b64_tr_b16 v[22:23], v180 offset:58368
    v_add_f32 v59, v59, v205
    v_mfma_f32_32x32x16_bf16 v[128:143], a[52:55], v[36:39], v[128:143]
    ds_read_b64_tr_b16 v[24:25], v183 offset:57344
    ds_read_b64_tr_b16 v[26:27], v183 offset:58368
    ds_read_b64_tr_b16 a[120:121], v252 offset:2048
    ds_read_b64_tr_b16 a[122:123], v252 offset:3072
    v_mfma_f32_32x32x16_bf16 v[144:159], a[52:55], v[40:43], v[144:159]
    buffer_load_dwordx4 v209, s[48:51], s101 offen offset:1024 lds
    v_cvt_pk_bf16_f32 v225, v58, v59
    v_mul_f32 v204, s88, v60
    v_mul_f32 v205, s88, v61
    v_exp_f32_e64 v204, v204 clamp
    s_waitcnt lgkmcnt(2)
    v_mfma_f32_32x32x16_bf16 v[112:127], a[56:59], v[16:19], v[112:127]
    ds_read_b64_tr_b16 v[32:33], v177 offset:61440
    ds_read_b64_tr_b16 v[34:35], v177 offset:62464
    ds_read_b64_tr_b16 v[36:37], v180 offset:61440
    ds_read_b64_tr_b16 v[38:39], v180 offset:62464
    buffer_load_dwordx4 v210, s[48:51], s101 offen offset:2048 lds
    v_mfma_f32_32x32x16_bf16 v[128:143], a[56:59], v[20:23], v[128:143]
    ds_read_b64_tr_b16 v[40:41], v183 offset:61440
    ds_read_b64_tr_b16 v[42:43], v183 offset:62464
    buffer_load_dwordx4 v211, s[48:51], s101 offen offset:3072 lds
    v_mfma_f32_32x32x16_bf16 v[144:159], a[56:59], v[24:27], v[144:159]
    s_add_u32 m0, s17, 12288
    s_nop 0
    buffer_load_dwordx4 v246, s[56:59], s26 offen offset:2048 lds
    v_exp_f32_e64 v205, v205 clamp
    v_max_f32 v60, 0, v60
    v_max_f32 v61, 0, v61
    v_add_f32 v204, s89, v204
    s_waitcnt lgkmcnt(0)
    v_mfma_f32_32x32x16_bf16 v[112:127], a[60:63], v[32:35], v[112:127]
    s_waitcnt vmcnt(15)
    s_barrier
    ds_read_b64_tr_b16 v[16:17], v178 offset:0
    ds_read_b64_tr_b16 v[18:19], v178 offset:1024
    ds_read_b64_tr_b16 v[20:21], v181 offset:0
    ds_read_b64_tr_b16 v[22:23], v181 offset:1024
    v_add_f32 v205, s89, v205
    v_mfma_f32_32x32x16_bf16 v[128:143], a[60:63], v[36:39], v[128:143]
    s_add_u32 m0, s72, 147456
    ds_read_b64_tr_b16 v[24:25], v184 offset:0
    ds_read_b64_tr_b16 v[26:27], v184 offset:1024
    buffer_load_dwordx4 v246, s[56:59], s95 offen offset:2048 lds
    v_mfma_f32_32x32x16_bf16 v[144:159], a[60:63], v[40:43], v[144:159]
    ds_read_b64_tr_b16 a[124:125], v253 offset:2048
    ds_read_b64_tr_b16 a[126:127], v253 offset:3072
    v_add_f32 v60, v60, v204
    v_add_f32 v61, v61, v205
    v_cvt_pk_bf16_f32 v226, v60, v61
    v_mul_f32 v204, s88, v62
    s_waitcnt lgkmcnt(2)
    v_mfma_f32_32x32x16_bf16 v[112:127], a[64:67], v[16:19], v[112:127]
    ds_read_b64_tr_b16 v[32:33], v178 offset:4096
    ds_read_b64_tr_b16 v[34:35], v178 offset:5120
    ds_read_b64_tr_b16 v[36:37], v181 offset:4096
    ds_read_b64_tr_b16 v[38:39], v181 offset:5120
    v_mul_f32 v205, s88, v63
    v_mfma_f32_32x32x16_bf16 v[128:143], a[64:67], v[20:23], v[128:143]
    s_add_u32 m0, s17, 12288
    ds_read_b64_tr_b16 v[40:41], v184 offset:4096
    ds_read_b64_tr_b16 v[42:43], v184 offset:5120
    buffer_load_dwordx4 v247, s[56:59], s26 offen offset:3072 lds
    v_mfma_f32_32x32x16_bf16 v[144:159], a[64:67], v[24:27], v[144:159]
    s_add_u32 m0, s72, 147456
    s_nop 0
    buffer_load_dwordx4 v247, s[56:59], s95 offen offset:3072 lds
    v_exp_f32_e64 v204, v204 clamp
    v_exp_f32_e64 v205, v205 clamp
    v_max_f32 v62, 0, v62
    v_max_f32 v63, 0, v63
    s_lshl_b32 s68, s77, 2
    s_add_u32 s68, s68, 64
    v_mov_b32 v251, 0
    buffer_load_dword v251, v251, s[8:11], s68 offen sc1
    s_waitcnt lgkmcnt(0)
    v_mfma_f32_32x32x16_bf16 v[112:127], a[68:71], v[32:35], v[112:127]
    ds_read_b64_tr_b16 v[16:17], v178 offset:8192
    ds_read_b64_tr_b16 v[18:19], v178 offset:9216
    ds_read_b64_tr_b16 v[20:21], v181 offset:8192
    ds_read_b64_tr_b16 v[22:23], v181 offset:9216
    v_add_f32 v204, s89, v204
    v_mfma_f32_32x32x16_bf16 v[128:143], a[68:71], v[36:39], v[128:143]
    ds_read_b64_tr_b16 v[24:25], v184 offset:8192
    ds_read_b64_tr_b16 v[26:27], v184 offset:9216
    ds_read_b64_tr_b16 a[128:129], v252 offset:4096
    ds_read_b64_tr_b16 a[130:131], v252 offset:5120
    v_mfma_f32_32x32x16_bf16 v[144:159], a[68:71], v[40:43], v[144:159]
    s_waitcnt lgkmcnt(14)
    s_add_u32 m0, s17, 0
    s_mul_i32 s26, s33, 229376
    s_add_u32 s26, s26, s16
    buffer_load_dwordx4 v244, s[56:59], s26 offen offset:0 lds
    v_add_f32 v205, s89, v205
    v_add_f32 v62, v62, v204
    v_add_f32 v63, v63, v205
    v_cvt_pk_bf16_f32 v227, v62, v63
    s_waitcnt lgkmcnt(2)
    v_mfma_f32_32x32x16_bf16 v[112:127], a[72:75], v[16:19], v[112:127]
    ds_read_b64_tr_b16 v[32:33], v178 offset:12288
    ds_read_b64_tr_b16 v[34:35], v178 offset:13312
    ds_read_b64_tr_b16 v[36:37], v181 offset:12288
    ds_read_b64_tr_b16 v[38:39], v181 offset:13312
    v_mfma_f32_32x32x16_bf16 v[128:143], a[72:75], v[20:23], v[128:143]
    ds_read_b64_tr_b16 v[40:41], v184 offset:12288
    ds_read_b64_tr_b16 v[42:43], v184 offset:13312
    ds_read_b64_tr_b16 a[132:133], v253 offset:4096
    ds_read_b64_tr_b16 a[134:135], v253 offset:5120
    v_mfma_f32_32x32x16_bf16 v[144:159], a[72:75], v[24:27], v[144:159]
    buffer_load_dwordx4 v245, s[56:59], s26 offen offset:1024 lds
    v_cndmask_b32 v220, v220, 0, s[82:83]
    v_cndmask_b32 v221, v221, 0, s[82:83]
    v_cndmask_b32 v222, v222, 0, s[82:83]
    s_waitcnt lgkmcnt(2)
    v_mfma_f32_32x32x16_bf16 v[112:127], a[76:79], v[32:35], v[112:127]
    s_waitcnt vmcnt(14)
    s_barrier
    ds_read_b64_tr_b16 v[16:17], v176 offset:0
    ds_read_b64_tr_b16 v[18:19], v176 offset:1024
    ds_read_b64_tr_b16 v[20:21], v179 offset:0
    ds_read_b64_tr_b16 v[22:23], v179 offset:1024
    v_mfma_f32_32x32x16_bf16 v[128:143], a[76:79], v[36:39], v[128:143]
    ds_read_b64_tr_b16 v[24:25], v182 offset:0
    ds_read_b64_tr_b16 v[26:27], v182 offset:1024
    ds_read_b64_tr_b16 a[136:137], v252 offset:6144
    ds_read_b64_tr_b16 a[138:139], v252 offset:7168
    v_mfma_f32_32x32x16_bf16 v[144:159], a[76:79], v[40:43], v[144:159]
    buffer_load_dwordx4 v246, s[56:59], s26 offen offset:2048 lds
    v_cndmask_b32 v223, v223, 0, s[82:83]
    v_cndmask_b32 v224, v224, 0, s[82:83]
    v_cndmask_b32 v225, v225, 0, s[82:83]
    s_waitcnt lgkmcnt(2)
    v_mfma_f32_32x32x16_bf16 v[112:127], a[80:83], v[16:19], v[112:127]
    ds_read_b64_tr_b16 v[32:33], v176 offset:4096
    ds_read_b64_tr_b16 v[34:35], v176 offset:5120
    ds_read_b64_tr_b16 v[36:37], v179 offset:4096
    ds_read_b64_tr_b16 v[38:39], v179 offset:5120
    v_mfma_f32_32x32x16_bf16 v[128:143], a[80:83], v[20:23], v[128:143]
    ds_read_b64_tr_b16 v[40:41], v182 offset:4096
    ds_read_b64_tr_b16 v[42:43], v182 offset:5120
    ds_read_b64_tr_b16 a[140:141], v253 offset:6144
    ds_read_b64_tr_b16 a[142:143], v253 offset:7168
    v_mfma_f32_32x32x16_bf16 v[144:159], a[80:83], v[24:27], v[144:159]
    buffer_load_dwordx4 v247, s[56:59], s26 offen offset:3072 lds
    v_cndmask_b32 v226, v226, 0, s[82:83]
    v_cndmask_b32 v227, v227, 0, s[82:83]
    v_mul_f32 v204, s88, v64
    s_waitcnt lgkmcnt(2)
    v_mfma_f32_32x32x16_bf16 v[112:127], a[84:87], v[32:35], v[112:127]
    ds_read_b64_tr_b16 v[16:17], v176 offset:8192
    ds_read_b64_tr_b16 v[18:19], v176 offset:9216
    ds_read_b64_tr_b16 v[20:21], v179 offset:8192
    ds_read_b64_tr_b16 v[22:23], v179 offset:9216
    v_mfma_f32_32x32x16_bf16 v[128:143], a[84:87], v[36:39], v[128:143]
    ds_read_b64_tr_b16 v[24:25], v182 offset:8192
    ds_read_b64_tr_b16 v[26:27], v182 offset:9216
    ds_read_b64_tr_b16 a[144:145], v252 offset:8192
    ds_read_b64_tr_b16 a[146:147], v252 offset:9216
    v_mfma_f32_32x32x16_bf16 v[144:159], a[84:87], v[40:43], v[144:159]
    s_waitcnt lgkmcnt(8)
    s_add_u32 m0, s17, 4096
    s_mul_i32 s26, s36, 229376
    s_add_u32 s26, s26, s16
    buffer_load_dwordx4 v244, s[56:59], s26 offen offset:0 lds
    v_mul_f32 v205, s88, v65
    v_exp_f32_e64 v204, v204 clamp
    v_exp_f32_e64 v205, v205 clamp
    s_waitcnt lgkmcnt(2)
    v_mfma_f32_32x32x16_bf16 v[112:127], a[88:91], v[16:19], v[112:127]
    ds_read_b64_tr_b16 v[32:33], v176 offset:12288
    ds_read_b64_tr_b16 v[34:35], v176 offset:13312
    ds_read_b64_tr_b16 v[36:37], v179 offset:12288
    ds_read_b64_tr_b16 v[38:39], v179 offset:13312
    v_mfma_f32_32x32x16_bf16 v[128:143], a[88:91], v[20:23], v[128:143]
    s_add_u32 m0, s72, 32768
    s_mul_i32 s95, s30, 229376
    s_add_u32 s95, s95, s16
    s_add_u32 s95, s95, 114688
    ds_read_b64_tr_b16 v[40:41], v182 offset:12288
    ds_read_b64_tr_b16 v[42:43], v182 offset:13312
    buffer_load_dwordx4 v244, s[56:59], s95 offen offset:0 lds
    v_mfma_f32_32x32x16_bf16 v[144:159], a[88:91], v[24:27], v[144:159]
    ds_read_b64_tr_b16 a[148:149], v253 offset:8192
    ds_read_b64_tr_b16 a[150:151], v253 offset:9216
    v_max_f32 v64, 0, v64
    v_max_f32 v65, 0, v65
    v_add_f32 v204, s89, v204
    s_waitcnt lgkmcnt(2)
    v_mfma_f32_32x32x16_bf16 v[112:127], a[92:95], v[32:35], v[112:127]
    s_waitcnt vmcnt(11)
    s_barrier
    ds_read_b64_tr_b16 v[16:17], v176 offset:16384
    ds_read_b64_tr_b16 v[18:19], v176 offset:17408
    ds_read_b64_tr_b16 v[20:21], v179 offset:16384
    ds_read_b64_tr_b16 v[22:23], v179 offset:17408
    v_mfma_f32_32x32x16_bf16 v[128:143], a[92:95], v[36:39], v[128:143]
    s_add_u32 m0, s17, 4096
    ds_read_b64_tr_b16 v[24:25], v182 offset:16384
    ds_read_b64_tr_b16 v[26:27], v182 offset:17408
    buffer_load_dwordx4 v245, s[56:59], s26 offen offset:1024 lds
    v_mfma_f32_32x32x16_bf16 v[144:159], a[92:95], v[40:43], v[144:159]
    s_add_u32 m0, s72, 32768
    s_nop 0
    buffer_load_dwordx4 v245, s[56:59], s95 offen offset:1024 lds
    v_add_f32 v205, s89, v205
    v_add_f32 v64, v64, v204
    v_add_f32 v65, v65, v205
    s_waitcnt lgkmcnt(0)
    v_mfma_f32_32x32x16_bf16 v[112:127], a[96:99], v[16:19], v[112:127]
    ds_read_b64_tr_b16 v[32:33], v176 offset:20480
    ds_read_b64_tr_b16 v[34:35], v176 offset:21504
    ds_read_b64_tr_b16 v[36:37], v179 offset:20480
    ds_read_b64_tr_b16 v[38:39], v179 offset:21504
    v_mfma_f32_32x32x16_bf16 v[128:143], a[96:99], v[20:23], v[128:143]
    ds_read_b64_tr_b16 v[40:41], v182 offset:20480
    ds_read_b64_tr_b16 v[42:43], v182 offset:21504
    ds_read_b64_tr_b16 a[152:153], v252 offset:10240
    ds_read_b64_tr_b16 a[154:155], v252 offset:11264
    v_mfma_f32_32x32x16_bf16 v[144:159], a[96:99], v[24:27], v[144:159]
    s_add_u32 m0, s17, 4096
    s_nop 0
    buffer_load_dwordx4 v246, s[56:59], s26 offen offset:2048 lds
    v_cvt_pk_bf16_f32 v228, v64, v65
    v_mul_f32 v204, s88, v66
    v_mul_f32 v205, s88, v67
    s_waitcnt lgkmcnt(2)
    v_mfma_f32_32x32x16_bf16 v[112:127], a[100:103], v[32:35], v[112:127]
    ds_read_b64_tr_b16 v[16:17], v176 offset:24576
    ds_read_b64_tr_b16 v[18:19], v176 offset:25600
    ds_read_b64_tr_b16 v[20:21], v179 offset:24576
    ds_read_b64_tr_b16 v[22:23], v179 offset:25600
    v_mfma_f32_32x32x16_bf16 v[128:143], a[100:103], v[36:39], v[128:143]
    s_add_u32 m0, s72, 32768
    ds_read_b64_tr_b16 v[24:25], v182 offset:24576
    ds_read_b64_tr_b16 v[26:27], v182 offset:25600
    buffer_load_dwordx4 v246, s[56:59], s95 offen offset:2048 lds
    v_mfma_f32_32x32x16_bf16 v[144:159], a[100:103], v[40:43], v[144:159]
    ds_read_b64_tr_b16 a[156:157], v253 offset:10240
    ds_read_b64_tr_b16 a[158:159], v253 offset:11264
    v_exp_f32_e64 v204, v204 clamp
    v_exp_f32_e64 v205, v205 clamp
    v_max_f32 v66, 0, v66
    s_waitcnt lgkmcnt(2)
    v_mfma_f32_32x32x16_bf16 v[112:127], a[104:107], v[16:19], v[112:127]
    ds_read_b64_tr_b16 v[32:33], v176 offset:28672
    ds_read_b64_tr_b16 v[34:35], v176 offset:29696
    ds_read_b64_tr_b16 v[36:37], v179 offset:28672
    ds_read_b64_tr_b16 v[38:39], v179 offset:29696
    v_mfma_f32_32x32x16_bf16 v[128:143], a[104:107], v[20:23], v[128:143]
    s_add_u32 m0, s17, 4096
    ds_read_b64_tr_b16 v[40:41], v182 offset:28672
    ds_read_b64_tr_b16 v[42:43], v182 offset:29696
    buffer_load_dwordx4 v247, s[56:59], s26 offen offset:3072 lds
    v_mfma_f32_32x32x16_bf16 v[144:159], a[104:107], v[24:27], v[144:159]
    s_add_u32 m0, s72, 32768
    s_nop 0
    buffer_load_dwordx4 v247, s[56:59], s95 offen offset:3072 lds
    v_max_f32 v67, 0, v67
    v_add_f32 v204, s89, v204
    v_add_f32 v205, s89, v205
    s_waitcnt lgkmcnt(0)
    v_mfma_f32_32x32x16_bf16 v[112:127], a[108:111], v[32:35], v[112:127]
    v_mfma_f32_32x32x16_bf16 v[128:143], a[108:111], v[36:39], v[128:143]
    s_waitcnt vmcnt(14)
    ds_read_b64_tr_b16 a[160:161], v252 offset:12288
    ds_read_b64_tr_b16 a[162:163], v252 offset:13312
    v_mfma_f32_32x32x16_bf16 v[144:159], a[108:111], v[40:43], v[144:159]
    s_waitcnt lgkmcnt(8)
    s_add_u32 m0, s17, 8192
    s_mul_i32 s26, s37, 229376
    s_add_u32 s26, s26, s16
    buffer_load_dwordx4 v244, s[56:59], s26 offen offset:0 lds
    v_add_f32 v66, v66, v204
    v_add_f32 v67, v67, v205
    v_cvt_pk_bf16_f32 v229, v66, v67
    v_mul_f32 v204, s88, v68
    v_mul_f32 v205, s88, v69
    v_exp_f32_e64 v204, v204 clamp
    v_exp_f32_e64 v205, v205 clamp
    v_max_f32 v68, 0, v68
    v_max_f32 v69, 0, v69
    v_add_f32 v204, s89, v204
    v_add_f32 v205, s89, v205
    v_add_f32 v68, v68, v204
    v_add_f32 v69, v69, v205
    v_cvt_pk_bf16_f32 v230, v68, v69
    v_mul_f32 v204, s88, v70
    v_mul_f32 v205, s88, v71
    v_exp_f32_e64 v204, v204 clamp
    v_exp_f32_e64 v205, v205 clamp
    v_max_f32 v70, 0, v70
    v_max_f32 v71, 0, v71
    v_add_f32 v204, s89, v204
    v_add_f32 v205, s89, v205
    v_add_f32 v70, v70, v204
    v_add_f32 v71, v71, v205
    v_cvt_pk_bf16_f32 v231, v70, v71
    v_mul_f32 v204, s88, v72
    v_mul_f32 v205, s88, v73
    v_exp_f32_e64 v204, v204 clamp
    v_exp_f32_e64 v205, v205 clamp
    v_max_f32 v72, 0, v72
    v_max_f32 v73, 0, v73
    v_add_f32 v204, s89, v204
    v_add_f32 v205, s89, v205
    v_add_f32 v72, v72, v204
    v_add_f32 v73, v73, v205
    v_cvt_pk_bf16_f32 v232, v72, v73
    v_mul_f32 v204, s88, v74
    v_mul_f32 v205, s88, v75
    v_exp_f32_e64 v204, v204 clamp
    v_exp_f32_e64 v205, v205 clamp
    v_max_f32 v74, 0, v74
    v_max_f32 v75, 0, v75
    v_add_f32 v204, s89, v204
    v_add_f32 v205, s89, v205
    v_add_f32 v74, v74, v204
    v_add_f32 v75, v75, v205
    v_cvt_pk_bf16_f32 v233, v74, v75
    v_mul_f32 v204, s88, v76
    v_mul_f32 v205, s88, v77
    v_exp_f32_e64 v204, v204 clamp
    v_exp_f32_e64 v205, v205 clamp
    v_max_f32 v76, 0, v76
    v_max_f32 v77, 0, v77
    v_add_f32 v204, s89, v204
    v_add_f32 v205, s89, v205
    v_add_f32 v76, v76, v204
    v_add_f32 v77, v77, v205
    v_cvt_pk_bf16_f32 v234, v76, v77
    v_mul_f32 v204, s88, v78
    v_mul_f32 v205, s88, v79
    v_exp_f32_e64 v204, v204 clamp
    v_exp_f32_e64 v205, v205 clamp
    v_max_f32 v78, 0, v78
    v_max_f32 v79, 0, v79
    v_add_f32 v204, s89, v204
    v_add_f32 v205, s89, v205
    v_add_f32 v78, v78, v204
    v_add_f32 v79, v79, v205
    v_cvt_pk_bf16_f32 v235, v78, v79
    v_cndmask_b32 v228, v228, 0, s[82:83]
    v_cndmask_b32 v229, v229, 0, s[82:83]
    v_cndmask_b32 v230, v230, 0, s[82:83]
    v_cndmask_b32 v231, v231, 0, s[82:83]
    v_cndmask_b32 v232, v232, 0, s[82:83]
    v_cndmask_b32 v233, v233, 0, s[82:83]
    v_cndmask_b32 v234, v234, 0, s[82:83]
    v_cndmask_b32 v235, v235, 0, s[82:83]
    v_mul_f32 v204, s88, v80
    v_mul_f32 v205, s88, v81
    v_exp_f32_e64 v204, v204 clamp
    v_exp_f32_e64 v205, v205 clamp
    v_max_f32 v80, 0, v80
    v_max_f32 v81, 0, v81
    v_add_f32 v204, s89, v204
    v_add_f32 v205, s89, v205
    v_add_f32 v80, v80, v204
    v_add_f32 v81, v81, v205
    v_cvt_pk_bf16_f32 v236, v80, v81
    v_mul_f32 v204, s88, v82
    v_mul_f32 v205, s88, v83
    v_exp_f32_e64 v204, v204 clamp
    v_exp_f32_e64 v205, v205 clamp
    v_max_f32 v82, 0, v82
    v_max_f32 v83, 0, v83
    v_add_f32 v204, s89, v204
    v_add_f32 v205, s89, v205
    v_add_f32 v82, v82, v204
    v_add_f32 v83, v83, v205
    v_cvt_pk_bf16_f32 v237, v82, v83
    v_mul_f32 v204, s88, v84
    v_mul_f32 v205, s88, v85
    v_exp_f32_e64 v204, v204 clamp
    v_exp_f32_e64 v205, v205 clamp
    v_max_f32 v84, 0, v84
    v_max_f32 v85, 0, v85
    v_add_f32 v204, s89, v204
    v_add_f32 v205, s89, v205
    v_add_f32 v84, v84, v204
    v_add_f32 v85, v85, v205
    v_cvt_pk_bf16_f32 v238, v84, v85
    v_mul_f32 v204, s88, v86
    v_mul_f32 v205, s88, v87
    v_exp_f32_e64 v204, v204 clamp
    v_exp_f32_e64 v205, v205 clamp
    v_max_f32 v86, 0, v86
    v_max_f32 v87, 0, v87
    v_add_f32 v204, s89, v204
    v_add_f32 v205, s89, v205
    v_add_f32 v86, v86, v204
    v_add_f32 v87, v87, v205
    v_cvt_pk_bf16_f32 v239, v86, v87
    v_mul_f32 v204, s88, v88
    v_mul_f32 v205, s88, v89
    v_exp_f32_e64 v204, v204 clamp
    v_exp_f32_e64 v205, v205 clamp
    v_max_f32 v88, 0, v88
    v_max_f32 v89, 0, v89
    v_add_f32 v204, s89, v204
    v_add_f32 v205, s89, v205
    v_add_f32 v88, v88, v204
    v_add_f32 v89, v89, v205
    v_cvt_pk_bf16_f32 v240, v88, v89
    v_mul_f32 v204, s88, v90
    v_mul_f32 v205, s88, v91
    v_exp_f32_e64 v204, v204 clamp
    v_exp_f32_e64 v205, v205 clamp
    v_max_f32 v90, 0, v90
    v_max_f32 v91, 0, v91
    v_add_f32 v204, s89, v204
    v_add_f32 v205, s89, v205
    v_add_f32 v90, v90, v204
    v_add_f32 v91, v91, v205
    v_cvt_pk_bf16_f32 v241, v90, v91
    v_mul_f32 v204, s88, v92
    v_mul_f32 v205, s88, v93
    v_exp_f32_e64 v204, v204 clamp
    v_exp_f32_e64 v205, v205 clamp
    v_max_f32 v92, 0, v92
    v_max_f32 v93, 0, v93
    v_add_f32 v204, s89, v204
    v_add_f32 v205, s89, v205
    v_add_f32 v92, v92, v204
    v_add_f32 v93, v93, v205
    v_cvt_pk_bf16_f32 v242, v92, v93
    v_mul_f32 v204, s88, v94
    v_mul_f32 v205, s88, v95
    v_exp_f32_e64 v204, v204 clamp
    v_exp_f32_e64 v205, v205 clamp
    v_max_f32 v94, 0, v94
    v_max_f32 v95, 0, v95
    v_add_f32 v204, s89, v204
    v_add_f32 v205, s89, v205
    v_add_f32 v94, v94, v204
    v_add_f32 v95, v95, v205
    v_cvt_pk_bf16_f32 v243, v94, v95
    v_cndmask_b32 v236, v236, 0, s[82:83]
    v_cndmask_b32 v237, v237, 0, s[82:83]
    v_cndmask_b32 v238, v238, 0, s[82:83]
    v_cndmask_b32 v239, v239, 0, s[82:83]
    v_cndmask_b32 v240, v240, 0, s[82:83]
    v_cndmask_b32 v241, v241, 0, s[82:83]
    v_cndmask_b32 v242, v242, 0, s[82:83]
    v_cndmask_b32 v243, v243, 0, s[82:83]
    v_lshlrev_b32 v2, 2, v1
    buffer_load_dwordx4 v245, s[56:59], s26 offen offset:1024 lds
    buffer_load_dwordx4 v246, s[56:59], s26 offen offset:2048 lds
    buffer_load_dwordx4 v247, s[56:59], s26 offen offset:3072 lds
    v_and_b32 v212, 31, v1
    v_cmp_eq_u32 vcc, 28, v212
    v_mov_b32 v213, 0x3f803f80
    s_nop 0
    v_cndmask_b32 v212, 0, v213, vcc
    v_cvt_pk_bf16_f32 v188, v112, v113
    v_cvt_pk_bf16_f32 v189, v114, v115
    v_cvt_pk_bf16_f32 v190, v116, v117
    v_cvt_pk_bf16_f32 v191, v118, v119
    v_cvt_pk_bf16_f32 v192, v120, v121
    v_cvt_pk_bf16_f32 v193, v122, v123
    v_cvt_pk_bf16_f32 v194, v124, v125
    v_cvt_pk_bf16_f32 v195, v126, v127
    v_cndmask_b32 v188, v188, v212, s[82:83]
    v_cndmask_b32 v189, v189, v212, s[82:83]
    v_cndmask_b32 v190, v190, v212, s[82:83]
    v_cndmask_b32 v191, v191, v212, s[82:83]
    v_cndmask_b32 v192, v192, v212, s[82:83]
    v_cndmask_b32 v193, v193, v212, s[82:83]
    v_cndmask_b32 v194, v194, v212, s[82:83]
    v_cndmask_b32 v195, v195, v212, s[82:83]
    v_mfma_f32_32x32x16_bf16 v[48:63], v[220:223], v[188:191], 0
    s_nop 0
    v_mfma_f32_32x32x16_bf16 v[48:63], v[224:227], v[192:195], v[48:63]
    v_cvt_pk_bf16_f32 v196, v128, v129
    v_cvt_pk_bf16_f32 v197, v130, v131
    v_cvt_pk_bf16_f32 v198, v132, v133
    v_cvt_pk_bf16_f32 v199, v134, v135
    v_cvt_pk_bf16_f32 v200, v136, v137
    v_cvt_pk_bf16_f32 v201, v138, v139
    v_cvt_pk_bf16_f32 v202, v140, v141
    v_cvt_pk_bf16_f32 v203, v142, v143
    v_cndmask_b32 v196, v196, v212, s[82:83]
    v_cndmask_b32 v197, v197, v212, s[82:83]
    v_cndmask_b32 v198, v198, v212, s[82:83]
    v_cndmask_b32 v199, v199, v212, s[82:83]
    v_cndmask_b32 v200, v200, v212, s[82:83]
    v_cndmask_b32 v201, v201, v212, s[82:83]
    v_cndmask_b32 v202, v202, v212, s[82:83]
    v_cndmask_b32 v203, v203, v212, s[82:83]
    v_mfma_f32_32x32x16_bf16 v[64:79], v[228:231], v[196:199], 0
    s_nop 0
    v_mfma_f32_32x32x16_bf16 v[64:79], v[232:235], v[200:203], v[64:79]
    v_cvt_pk_bf16_f32 v204, v144, v145
    v_cvt_pk_bf16_f32 v205, v146, v147
    v_cvt_pk_bf16_f32 v206, v148, v149
    v_cvt_pk_bf16_f32 v207, v150, v151
    v_cvt_pk_bf16_f32 v208, v152, v153
    v_cvt_pk_bf16_f32 v209, v154, v155
    v_cvt_pk_bf16_f32 v210, v156, v157
    v_cvt_pk_bf16_f32 v211, v158, v159
    v_cndmask_b32 v204, v204, v212, s[82:83]
    v_cndmask_b32 v205, v205, v212, s[82:83]
    v_cndmask_b32 v206, v206, v212, s[82:83]
    v_cndmask_b32 v207, v207, v212, s[82:83]
    v_cndmask_b32 v208, v208, v212, s[82:83]
    v_cndmask_b32 v209, v209, v212, s[82:83]
    v_cndmask_b32 v210, v210, v212, s[82:83]
    v_cndmask_b32 v211, v211, v212, s[82:83]
    v_mfma_f32_32x32x16_bf16 v[80:95], v[236:239], v[204:207], 0
    s_nop 0
    v_mfma_f32_32x32x16_bf16 v[80:95], v[240:243], v[208:211], v[80:95]
    s_waitcnt lgkmcnt(0)
    s_barrier
    s_and_b32 s67, s64, 1
    s_lshl_b32 s67, s67, 14
    s_lshr_b32 s68, s64, 1
    s_mul_i32 s68, s68, 114688
    s_add_u32 s67, s67, s68
    v_add_u32 v10, s67, v9
    ds_write_b128 v10, v[48:51] offset:0
    ds_write_b128 v10, v[52:55] offset:1024
    ds_write_b128 v10, v[56:59] offset:2048
    ds_write_b128 v10, v[60:63] offset:3072
    ds_write_b128 v10, v[64:67] offset:4096
    ds_write_b128 v10, v[68:71] offset:5120
    ds_write_b128 v10, v[72:75] offset:6144
    ds_write_b128 v10, v[76:79] offset:7168
    ds_write_b128 v10, v[80:83] offset:8192
    ds_write_b128 v10, v[84:87] offset:9216
    ds_write_b128 v10, v[88:91] offset:10240
    ds_write_b128 v10, v[92:95] offset:11264
    s_waitcnt lgkmcnt(0)
    s_barrier
    s_mul_i32 s67, s64, 3072
    v_lshlrev_b32 v11, 2, v1
    v_add_u32 v10, s67, v11
    v_add_u32 v12, 114688, v10
    ds_read2st64_b32 v[176:177], v10 offset0:0 offset1:64
    ds_read2st64_b32 v[178:179], v12 offset0:0 offset1:64
    ds_read2st64_b32 v[180:181], v10 offset0:1 offset1:65
    ds_read2st64_b32 v[182:183], v12 offset0:1 offset1:65
    ds_read2st64_b32 v[184:185], v10 offset0:2 offset1:66
    ds_read2st64_b32 v[186:187], v12 offset0:2 offset1:66
    ds_read2st64_b32 v[188:189], v10 offset0:3 offset1:67
    ds_read2st64_b32 v[190:191], v12 offset0:3 offset1:67
    ds_read2st64_b32 v[192:193], v10 offset0:4 offset1:68
    ds_read2st64_b32 v[194:195], v12 offset0:4 offset1:68
    ds_read2st64_b32 v[196:197], v10 offset0:5 offset1:69
    ds_read2st64_b32 v[198:199], v12 offset0:5 offset1:69
    s_waitcnt lgkmcnt(6)
    ds_read2st64_b32 v[200:201], v10 offset0:6 offset1:70
    ds_read2st64_b32 v[202:203], v12 offset0:6 offset1:70
    ds_read2st64_b32 v[204:205], v10 offset0:7 offset1:71
    ds_read2st64_b32 v[206:207], v12 offset0:7 offset1:71
    ds_read2st64_b32 v[208:209], v10 offset0:8 offset1:72
    ds_read2st64_b32 v[210:211], v12 offset0:8 offset1:72
    ds_read2st64_b32 v[212:213], v10 offset0:9 offset1:73
    ds_read2st64_b32 v[214:215], v12 offset0:9 offset1:73
    ds_read2st64_b32 v[216:217], v10 offset0:10 offset1:74
    ds_read2st64_b32 v[218:219], v12 offset0:10 offset1:74
    ds_read2st64_b32 v[220:221], v10 offset0:11 offset1:75
    ds_read2st64_b32 v[222:223], v12 offset0:11 offset1:75
    s_waitcnt vmcnt(16)
    v_readfirstlane_b32 s69, v251
    s_nop 1
    s_cmp_lg_u32 s69, 0
    s_cbranch_scc1 z_ok_8
    s_lshl_b32 s68, s77, 2
    s_add_u32 s68, s68, 64
    v_mov_b32 v12, 0
    s_mov_b32 s96, 0x8000
zp_9:
    buffer_load_dword v251, v12, s[8:11], s68 offen sc1
    s_waitcnt vmcnt(0)
    v_readfirstlane_b32 s69, v251
    s_nop 1
    s_cmp_lg_u32 s69, 0
    s_cbranch_scc1 zp_done_10
    s_sleep 2
    s_sub_u32 s96, s96, 1
    s_cbranch_scc0 zp_9
zp_done_10:
z_ok_8:
    s_waitcnt lgkmcnt(0)
    s_barrier
    ds_read_b64_tr_b16 a[164:165], v253 offset:12288
    ds_read_b64_tr_b16 a[166:167], v253 offset:13312
    ds_read_b64_tr_b16 a[168:169], v252 offset:14336
    ds_read_b64_tr_b16 a[170:171], v252 offset:15360
    ds_read_b64_tr_b16 a[172:173], v253 offset:14336
    ds_read_b64_tr_b16 a[174:175], v253 offset:15360
    s_waitcnt vmcnt(12)
    ds_read_b64_tr_b16 a[176:177], v252 offset:0
    ds_read_b64_tr_b16 a[178:179], v252 offset:1024
    ds_read_b64_tr_b16 a[180:181], v253 offset:0
    ds_read_b64_tr_b16 a[182:183], v253 offset:1024
    ds_read_b64_tr_b16 a[184:185], v252 offset:2048
    ds_read_b64_tr_b16 a[186:187], v252 offset:3072
    ds_read_b64_tr_b16 a[188:189], v253 offset:2048
    ds_read_b64_tr_b16 a[190:191], v253 offset:3072
    s_waitcnt vmcnt(5)
    ds_read_b64_tr_b16 a[192:193], v252 offset:4096
    ds_read_b64_tr_b16 a[194:195], v252 offset:5120
    ds_read_b64_tr_b16 a[196:197], v253 offset:4096
    ds_read_b64_tr_b16 a[198:199], v253 offset:5120
    ds_read_b64_tr_b16 a[200:201], v252 offset:6144
    ds_read_b64_tr_b16 a[202:203], v252 offset:7168
    ds_read_b64_tr_b16 a[204:205], v253 offset:6144
    ds_read_b64_tr_b16 a[206:207], v253 offset:7168
    s_waitcnt vmcnt(0)
    ds_read_b64_tr_b16 a[208:209], v252 offset:8192
    ds_read_b64_tr_b16 a[210:211], v252 offset:9216
    ds_read_b64_tr_b16 a[212:213], v253 offset:8192
    ds_read_b64_tr_b16 a[214:215], v253 offset:9216
    ds_read_b64_tr_b16 a[216:217], v252 offset:10240
    ds_read_b64_tr_b16 a[218:219], v252 offset:11264
    ds_read_b64_tr_b16 a[220:221], v253 offset:10240
    ds_read_b64_tr_b16 a[222:223], v253 offset:11264
    s_add_u32 m0, s72, 114688
    s_mul_i32 s95, s31, 229376
    s_add_u32 s95, s95, s16
    s_add_u32 s95, s95, 114688
    buffer_load_dwordx4 v244, s[56:59], s95 offen offset:0 lds
    buffer_load_dwordx4 v245, s[56:59], s95 offen offset:1024 lds
    buffer_load_dwordx4 v246, s[56:59], s95 offen offset:2048 lds
    buffer_load_dwordx4 v247, s[56:59], s95 offen offset:3072 lds
    s_add_u32 m0, s72, 131072
    s_mul_i32 s95, s32, 229376
    s_add_u32 s95, s95, s16
    s_add_u32 s95, s95, 114688
    buffer_load_dwordx4 v244, s[56:59], s95 offen offset:0 lds
    buffer_load_dwordx4 v245, s[56:59], s95 offen offset:1024 lds
    buffer_load_dwordx4 v246, s[56:59], s95 offen offset:2048 lds
    buffer_load_dwordx4 v247, s[56:59], s95 offen offset:3072 lds
    s_lshl_b32 s80, s78, 12
    s_add_u32 s80, s80, s67
    s_add_u32 s80, s80, 9445376
    s_lshl_b32 s69, s79, 4
    s_mul_i32 s70, s64, 12
    v_lshlrev_b32 v14, 2, v1
    v_add_f32 v176, v176, v177
    v_add_f32 v178, v178, v179
    s_add_u32 s90, s70, 0
    s_cmp_lt_u32 s90, s69
    s_cselect_b32 s91, 0, 2130706432
    v_add_f32 v176, v176, v178
    v_or_b32 v177, s91, v14
    v_add_f32 v180, v180, v181
    v_add_f32 v182, v182, v183
    s_add_u32 s90, s70, 1
    s_cmp_lt_u32 s90, s69
    s_cselect_b32 s91, 0, 2130706432
    v_add_f32 v180, v180, v182
    v_or_b32 v181, s91, v14
    v_add_f32 v184, v184, v185
    v_add_f32 v186, v186, v187
    s_add_u32 s90, s70, 2
    s_cmp_lt_u32 s90, s69
    s_cselect_b32 s91, 0, 2130706432
    v_add_f32 v184, v184, v186
    v_or_b32 v185, s91, v14
    v_add_f32 v188, v188, v189
    v_add_f32 v190, v190, v191
    s_add_u32 s90, s70, 3
    s_cmp_lt_u32 s90, s69
    s_cselect_b32 s91, 0, 2130706432
    v_add_f32 v188, v188, v190
    v_or_b32 v189, s91, v14
    v_add_f32 v192, v192, v193
    v_add_f32 v194, v194, v195
    s_add_u32 s90, s70, 4
    s_cmp_lt_u32 s90, s69
    s_cselect_b32 s91, 0, 2130706432
    v_add_f32 v192, v192, v194
    v_or_b32 v193, s91, v14
    v_add_f32 v196, v196, v197
    v_add_f32 v198, v198, v199
    s_add_u32 s90, s70, 5
    s_cmp_lt_u32 s90, s69
    s_cselect_b32 s91, 0, 2130706432
    v_add_f32 v196, v196, v198
    v_or_b32 v197, s91, v14
    v_add_f32 v200, v200, v201
    v_add_f32 v202, v202, v203
    s_add_u32 s90, s70, 6
    s_cmp_lt_u32 s90, s69
    s_cselect_b32 s91, 0, 2130706432
    v_add_f32 v200, v200, v202
    v_or_b32 v201, s91, v14
    v_add_f32 v204, v204, v205
    v_add_f32 v206, v206, v207
    s_add_u32 s90, s70, 7
    s_cmp_lt_u32 s90, s69
    s_cselect_b32 s91, 0, 2130706432
    v_add_f32 v204, v204, v206
    v_or_b32 v205, s91, v14
    v_add_f32 v208, v208, v209
    v_add_f32 v210, v210, v211
    s_add_u32 s90, s70, 8
    s_cmp_lt_u32 s90, s69
    s_cselect_b32 s91, 0, 2130706432
    v_add_f32 v208, v208, v210
    v_or_b32 v209, s91, v14
    v_add_f32 v212, v212, v213
    v_add_f32 v214, v214, v215
    s_add_u32 s90, s70, 9
    s_cmp_lt_u32 s90, s69
    s_cselect_b32 s91, 0, 2130706432
    v_add_f32 v212, v212, v214
    v_or_b32 v213, s91, v14
    v_add_f32 v216, v216, v217
    v_add_f32 v218, v218, v219
    s_add_u32 s90, s70, 10
    s_cmp_lt_u32 s90, s69
    s_cselect_b32 s91, 0, 2130706432
    v_add_f32 v216, v216, v218
    v_or_b32 v217, s91, v14
    v_add_f32 v220, v220, v221
    v_add_f32 v222, v222, v223
    s_add_u32 s90, s70, 11
    s_cmp_lt_u32 s90, s69
    s_cselect_b32 s91, 0, 2130706432
    v_add_f32 v220, v220, v222
    v_or_b32 v221, s91, v14
    buffer_atomic_add_f32 v176, v177, s[52:55], s80 offen offset:0
    buffer_atomic_add_f32 v180, v181, s[52:55], s80 offen offset:256
    buffer_atomic_add_f32 v184, v185, s[52:55], s80 offen offset:512
    buffer_atomic_add_f32 v188, v189, s[52:55], s80 offen offset:768
    buffer_atomic_add_f32 v192, v193, s[52:55], s80 offen offset:1024
    buffer_atomic_add_f32 v196, v197, s[52:55], s80 offen offset:1280
    buffer_atomic_add_f32 v200, v201, s[52:55], s80 offen offset:1536
    buffer_atomic_add_f32 v204, v205, s[52:55], s80 offen offset:1792
    buffer_atomic_add_f32 v208, v209, s[52:55], s80 offen offset:2048
    buffer_atomic_add_f32 v212, v213, s[52:55], s80 offen offset:2304
    buffer_atomic_add_f32 v216, v217, s[52:55], s80 offen offset:2560
    buffer_atomic_add_f32 v220, v221, s[52:55], s80 offen offset:2816
    s_waitcnt lgkmcnt(0)
    s_add_u32 m0, s17, 12288
    s_mul_i32 s26, s33, 229376
    s_add_u32 s26, s26, s16
    s_add_u32 s26, s26, 114688
    buffer_load_dwordx4 v244, s[56:59], s26 offen offset:0 lds
    buffer_load_dwordx4 v245, s[56:59], s26 offen offset:1024 lds
    buffer_load_dwordx4 v246, s[56:59], s26 offen offset:2048 lds
    buffer_load_dwordx4 v247, s[56:59], s26 offen offset:3072 lds
    s_add_u32 m0, s17, 0
    s_mul_i32 s26, s36, 229376
    s_add_u32 s26, s26, s16
    s_add_u32 s26, s26, 114688
    buffer_load_dwordx4 v244, s[56:59], s26 offen offset:0 lds
    buffer_load_dwordx4 v245, s[56:59], s26 offen offset:1024 lds
    buffer_load_dwordx4 v246, s[56:59], s26 offen offset:2048 lds
    buffer_load_dwordx4 v247, s[56:59], s26 offen offset:3072 lds
    s_waitcnt vmcnt(20)
    s_add_u32 s67, s72, 147456
    s_sub_u32 s67, s67, s17
    v_add_u32 v12, s67, v252
    v_add_u32 v13, s67, v253
    ds_read_b64_tr_b16 a[0:1], v12 offset:0
    ds_read_b64_tr_b16 a[2:3], v12 offset:1024
    ds_read_b64_tr_b16 a[4:5], v13 offset:0
    ds_read_b64_tr_b16 a[6:7], v13 offset:1024
    ds_read_b64_tr_b16 a[8:9], v12 offset:2048
    ds_read_b64_tr_b16 a[10:11], v12 offset:3072
    ds_read_b64_tr_b16 a[12:13], v13 offset:2048
    ds_read_b64_tr_b16 a[14:15], v13 offset:3072
    s_add_u32 s67, s72, 32768
    s_sub_u32 s67, s67, s17
    v_add_u32 v10, s67, v252
    v_add_u32 v11, s67, v253
    ds_read_b64_tr_b16 a[16:17], v10 offset:0
    ds_read_b64_tr_b16 a[18:19], v10 offset:1024
    ds_read_b64_tr_b16 a[20:21], v11 offset:0
    ds_read_b64_tr_b16 a[22:23], v11 offset:1024
    ds_read_b64_tr_b16 a[24:25], v10 offset:2048
    ds_read_b64_tr_b16 a[26:27], v10 offset:3072
    ds_read_b64_tr_b16 a[28:29], v11 offset:2048
    ds_read_b64_tr_b16 a[30:31], v11 offset:3072
    s_add_u32 s67, s72, 114688
    s_sub_u32 s67, s67, s17
    v_add_u32 v12, s67, v252
    v_add_u32 v13, s67, v253
    ds_read_b64_tr_b16 a[32:33], v12 offset:0
    ds_read_b64_tr_b16 a[34:35], v12 offset:1024
    ds_read_b64_tr_b16 a[36:37], v13 offset:0
    ds_read_b64_tr_b16 a[38:39], v13 offset:1024
    ds_read_b64_tr_b16 a[40:41], v12 offset:2048
    ds_read_b64_tr_b16 a[42:43], v12 offset:3072
    ds_read_b64_tr_b16 a[44:45], v13 offset:2048
    ds_read_b64_tr_b16 a[46:47], v13 offset:3072
    s_add_u32 s67, s72, 131072
    s_sub_u32 s67, s67, s17
    v_add_u32 v10, s67, v252
    v_add_u32 v11, s67, v253
    ds_read_b64_tr_b16 a[48:49], v10 offset:0
    ds_read_b64_tr_b16 a[50:51], v10 offset:1024
    ds_read_b64_tr_b16 a[52:53], v11 offset:0
    ds_read_b64_tr_b16 a[54:55], v11 offset:1024
    ds_read_b64_tr_b16 a[56:57], v10 offset:2048
    ds_read_b64_tr_b16 a[58:59], v10 offset:3072
    ds_read_b64_tr_b16 a[60:61], v11 offset:2048
    ds_read_b64_tr_b16 a[62:63], v11 offset:3072
    v_mov_b32 v15, 2130706432
    buffer_store_dword v15, v15, s[52:55], 0 offen
    buffer_store_dword v15, v15, s[52:55], 0 offen
    buffer_store_dword v15, v15, s[52:55], 0 offen
    buffer_store_dword v15, v15, s[52:55], 0 offen
    v_mov_b32 v240, v244
    v_mov_b32 v241, v245
    v_mov_b32 v242, v246
    v_mov_b32 v243, v247
    v_mov_b32 v4, v252
    v_mov_b32 v5, v253
    s_branch L_p2
L_Q:
    s_add_u32 s70, s77, 0
    s_lshl_b32 s67, s70, 2
    s_lshr_b32 s78, 0xDB9630, s67
    s_and_b32 s78, s78, 15
    s_lshr_b32 s79, 0x322333, s67
    s_and_b32 s79, s79, 15
    s_lshl_b32 s68, s70, 7
    s_mul_i32 s92, s78, 56
    s_sub_u32 s92, s92, s68
    s_add_u32 s90, s92, 56
    s_lshl_b32 s67, s65, 2
    s_add_u32 s67, s67, s64
    s_lshl_b32 s67, s67, 15
    s_lshl_b32 s68, s78, 11
    s_add_u32 s67, s67, s68
    s_add_u32 s80, s67, 7340032
    s_add_u32 s91, s92, 112
    s_cmp_eq_u32 s79, 3
    s_cselect_b32 s91, s91, s92
    s_cselect_b32 s67, 0, 2130706432
    v_or_b32 v222, s67, v9
    v_bfe_u32 v10, v1, 2, 2
    v_and_b32 v11, 3, v1
    v_bfe_u32 v12, v1, 4, 1
    v_lshrrev_b32 v13, 5, v1
    v_lshlrev_b32 v11, 3, v11
    v_lshl_add_u32 v11, v12, 5, v11
    v_lshlrev_b32 v14, 8, v10
    v_lshl_add_u32 v14, v13, 11, v14
    v_lshlrev_b32 v10, 6, v10
    v_add_u32 v15, s92, v11
    v_xor_b32 v15, v15, v10
    v_add_u32 v176, v15, v14
    v_add_u32 v177, 0x10000, v176
    v_add_u32 v178, 0x20000, v176
    v_add_u32 v15, s90, v11
    v_xor_b32 v15, v15, v10
    v_add_u32 v179, v15, v14
    v_add_u32 v180, 0x10000, v179
    v_add_u32 v181, 0x20000, v179
    v_add_u32 v15, s91, v11
    v_xor_b32 v15, v15, v10
    v_add_u32 v182, v15, v14
    v_add_u32 v183, 0x10000, v182
    v_add_u32 v184, 0x20000, v182
    v_lshrrev_b32 v220, 5, v1
    v_lshlrev_b32 v220, 4, v220
    v_add_u32 v220, 147456, v220
    s_lshl_b32 s93, s65, 2
    s_add_u32 s93, s93, s64
    s_lshl_b32 s93, s93, 7
    s_add_u32 s93, s93, 9437184
    s_cmp_eq_u32 s77, 0
    s_cselect_b32 s94, 0, 2130706432
    s_add_u32 s20, s3, 0
    s_cmp_ge_u32 s20, 7
    s_cselect_b32 s7, 7, 0
    s_sub_u32 s20, s20, s7
    s_mul_i32 s20, s20, 172032
    s_add_u32 s29, s19, 0
    s_cmp_ge_u32 s29, 7
    s_cselect_b32 s7, 7, 0
    s_sub_u32 s29, s29, s7
    s_add_u32 s21, s3, 1
    s_cmp_ge_u32 s21, 7
    s_cselect_b32 s7, 7, 0
    s_sub_u32 s21, s21, s7
    s_mul_i32 s21, s21, 172032
    s_add_u32 s30, s19, 1
    s_cmp_ge_u32 s30, 7
    s_cselect_b32 s7, 7, 0
    s_sub_u32 s30, s30, s7
    s_add_u32 s22, s3, 2
    s_cmp_ge_u32 s22, 7
    s_cselect_b32 s7, 7, 0
    s_sub_u32 s22, s22, s7
    s_mul_i32 s22, s22, 172032
    s_add_u32 s31, s19, 2
    s_cmp_ge_u32 s31, 7
    s_cselect_b32 s7, 7, 0
    s_sub_u32 s31, s31, s7
    s_add_u32 s23, s3, 3
    s_cmp_ge_u32 s23, 7
    s_cselect_b32 s7, 7, 0
    s_sub_u32 s23, s23, s7
    s_mul_i32 s23, s23, 172032
    s_add_u32 s32, s19, 3
    s_cmp_ge_u32 s32, 7
    s_cselect_b32 s7, 7, 0
    s_sub_u32 s32, s32, s7
    s_add_u32 s24, s3, 4
    s_cmp_ge_u32 s24, 7
    s_cselect_b32 s7, 7, 0
    s_sub_u32 s24, s24, s7
    s_mul_i32 s24, s24, 172032
    s_add_u32 s33, s19, 4
    s_cmp_ge_u32 s33, 7
    s_cselect_b32 s7, 7, 0
    s_sub_u32 s33, s33, s7
    s_add_u32 s25, s3, 5
    s_cmp_ge_u32 s25, 7
    s_cselect_b32 s7, 7, 0
    s_sub_u32 s25, s25, s7
    s_mul_i32 s25, s25, 172032
    s_add_u32 s36, s19, 5
    s_cmp_ge_u32 s36, 7
    s_cselect_b32 s7, 7, 0
    s_sub_u32 s36, s36, s7
    s_add_u32 s28, s3, 6
    s_cmp_ge_u32 s28, 7
    s_cselect_b32 s7, 7, 0
    s_sub_u32 s28, s28, s7
    s_mul_i32 s28, s28, 172032
    s_add_u32 s37, s19, 6
    s_cmp_ge_u32 s37, 7
    s_cselect_b32 s7, 7, 0
    s_sub_u32 s37, s37, s7
    v_lshrrev_b32 v10, 3, v1
    v_mul_u32_u24 v10, 896, v10
    v_bfe_u32 v11, v1, 4, 1
    v_lshlrev_b32 v11, 2, v11
    v_and_b32 v12, 7, v1
    v_xor_b32 v12, v12, v11
    v_lshl_add_u32 v232, v12, 4, v10
    v_add_u32 v233, 6144, v232
    v_add_u32 v234, 12288, v232
    v_add_u32 v235, 18432, v232
    v_bfe_u32 v10, v1, 2, 2
    v_lshrrev_b32 v11, 5, v1
    v_lshl_add_u32 v11, v11, 2, v10
    v_lshlrev_b32 v11, 7, v11
    v_and_b32 v12, 3, v1
    v_lshlrev_b32 v12, 3, v12
    v_bfe_u32 v13, v1, 4, 1
    v_lshl_add_u32 v12, v13, 5, v12
    v_add_u32 v11, v11, v12
    v_add_u32 v11, s17, v11
    v_lshrrev_b32 v10, 1, v10
    s_and_b32 s67, s64, 1
    v_xor_b32 v10, s67, v10
    v_lshlrev_b32 v10, 6, v10
    v_add_u32 v236, v11, v10
    v_xor_b32 v10, 64, v10
    v_add_u32 v237, v11, v10
    s_waitcnt vmcnt(13)
    ds_read_b128 a[0:3], v5 offset:0
    ds_read_b128 a[4:7], v6 offset:0
    ds_read_b128 a[8:11], v7 offset:0
    ds_read_b128 a[12:15], v8 offset:0
    s_waitcnt vmcnt(8)
    s_waitcnt lgkmcnt(0)
    s_barrier
    ds_read_b64_tr_b16 v[16:17], v177 offset:49152
    ds_read_b64_tr_b16 v[18:19], v177 offset:50176
    ds_read_b64_tr_b16 v[20:21], v180 offset:49152
    ds_read_b64_tr_b16 v[22:23], v180 offset:50176
    ds_read_b64_tr_b16 v[24:25], v183 offset:49152
    ds_read_b64_tr_b16 v[26:27], v183 offset:50176
    s_add_u32 s69, s3, 0
    s_cmp_ge_u32 s69, 7
    s_cselect_b32 s7, 7, 0
    s_sub_u32 s69, s69, s7
    s_lshl_b32 s69, s69, 7
    v_add_u32 v221, s69, v220
    ds_read_b128 v[212:215], v221 offset:0
    s_waitcnt lgkmcnt(0)
    v_mfma_f32_32x32x16_bf16 v[48:63], v[16:19], a[0:3], 0
    ds_read_b64_tr_b16 v[32:33], v177 offset:53248
    ds_read_b64_tr_b16 v[34:35], v177 offset:54272
    ds_read_b64_tr_b16 v[36:37], v180 offset:53248
    ds_read_b64_tr_b16 v[38:39], v180 offset:54272
    v_mfma_f32_32x32x16_bf16 v[64:79], v[20:23], a[0:3], 0
    ds_read_b64_tr_b16 v[40:41], v183 offset:53248
    ds_read_b64_tr_b16 v[42:43], v183 offset:54272
    ds_read_b128 v[216:219], v221 offset:32
    v_mfma_f32_32x32x16_bf16 v[80:95], v[24:27], a[0:3], 0
    s_add_u32 m0, s72, 32768
    s_add_u32 s100, s3, 2
    s_cmp_ge_u32 s100, 7
    s_cselect_b32 s7, 7, 0
    s_sub_u32 s100, s100, s7
    s_lshl_b32 s100, s100, 7
    s_add_u32 s100, s100, s73
    buffer_load_dwordx4 v188, s[44:47], s100 offen offset:0 lds
    v_mfma_f32_32x32x16_bf16 v[96:111], v[212:215], a[0:3], 0
    buffer_load_dwordx4 v189, s[44:47], s100 offen offset:1024 lds
    s_waitcnt lgkmcnt(0)
    v_mfma_f32_32x32x16_bf16 v[48:63], v[32:35], a[4:7], v[48:63]
    ds_read_b64_tr_b16 v[16:17], v177 offset:57344
    ds_read_b64_tr_b16 v[18:19], v177 offset:58368
    ds_read_b64_tr_b16 v[20:21], v180 offset:57344
    ds_read_b64_tr_b16 v[22:23], v180 offset:58368
    v_mfma_f32_32x32x16_bf16 v[64:79], v[36:39], a[4:7], v[64:79]
    ds_read_b64_tr_b16 v[24:25], v183 offset:57344
    ds_read_b64_tr_b16 v[26:27], v183 offset:58368
    ds_read_b128 v[212:215], v221 offset:64
    buffer_load_dwordx4 v190, s[44:47], s100 offen offset:2048 lds
    v_mfma_f32_32x32x16_bf16 v[80:95], v[40:43], a[4:7], v[80:95]
    buffer_load_dwordx4 v191, s[44:47], s100 offen offset:3072 lds
    v_mfma_f32_32x32x16_bf16 v[96:111], v[216:219], a[4:7], v[96:111]
    s_add_u32 m0, s72, 0
    s_add_u32 s101, s22, s74
    buffer_load_dwordx4 v208, s[48:51], s101 offen offset:0 lds
    s_waitcnt lgkmcnt(0)
    v_mfma_f32_32x32x16_bf16 v[48:63], v[16:19], a[8:11], v[48:63]
    ds_read_b64_tr_b16 v[32:33], v177 offset:61440
    ds_read_b64_tr_b16 v[34:35], v177 offset:62464
    ds_read_b64_tr_b16 v[36:37], v180 offset:61440
    ds_read_b64_tr_b16 v[38:39], v180 offset:62464
    buffer_load_dwordx4 v209, s[48:51], s101 offen offset:1024 lds
    s_waitcnt vmcnt(10)
    ds_read_b128 a[16:19], v5 offset:16384
    v_mfma_f32_32x32x16_bf16 v[64:79], v[20:23], a[8:11], v[64:79]
    ds_read_b64_tr_b16 v[40:41], v183 offset:61440
    ds_read_b64_tr_b16 v[42:43], v183 offset:62464
    ds_read_b128 v[216:219], v221 offset:96
    buffer_load_dwordx4 v210, s[48:51], s101 offen offset:2048 lds
    ds_read_b128 a[20:23], v6 offset:16384
    v_mfma_f32_32x32x16_bf16 v[80:95], v[24:27], a[8:11], v[80:95]
    buffer_load_dwordx4 v211, s[48:51], s101 offen offset:3072 lds
    ds_read_b128 a[24:27], v7 offset:16384
    v_mfma_f32_32x32x16_bf16 v[96:111], v[212:215], a[8:11], v[96:111]
    ds_read_b128 a[28:31], v8 offset:16384
    s_sub_u32 s68, s66, 7
    s_lshl_b32 s68, s68, 4
    s_add_u32 s68, s68, s65
    s_lshl_b32 s68, s68, 2
    s_add_u32 s68, s68, s64
    v_lshlrev_b32 v2, 7, v1
    s_mul_i32 s69, s68, 2816
    s_mov_b64 exec, 4194303
    buffer_load_dword v3, v2, s[56:59], s69 offen
    s_mul_i32 s69, s68, 768
    s_mov_b64 exec, 63
    buffer_load_dword v4, v2, s[60:63], s69 offen
    s_mov_b64 exec, -1
    s_waitcnt lgkmcnt(3)
    v_mfma_f32_32x32x16_bf16 v[48:63], v[32:35], a[12:15], v[48:63]
    s_waitcnt vmcnt(10)
    s_waitcnt lgkmcnt(0)
    s_barrier
    ds_read_b64_tr_b16 v[16:17], v178 offset:0
    ds_read_b64_tr_b16 v[18:19], v178 offset:1024
    ds_read_b64_tr_b16 v[20:21], v181 offset:0
    ds_read_b64_tr_b16 v[22:23], v181 offset:1024
    v_mfma_f32_32x32x16_bf16 v[64:79], v[36:39], a[12:15], v[64:79]
    ds_read_b64_tr_b16 v[24:25], v184 offset:0
    ds_read_b64_tr_b16 v[26:27], v184 offset:1024
    s_add_u32 s69, s3, 1
    s_cmp_ge_u32 s69, 7
    s_cselect_b32 s7, 7, 0
    s_sub_u32 s69, s69, s7
    s_lshl_b32 s69, s69, 7
    v_add_u32 v221, s69, v220
    ds_read_b128 v[212:215], v221 offset:0
    v_mfma_f32_32x32x16_bf16 v[80:95], v[40:43], a[12:15], v[80:95]
    s_add_u32 m0, s72, 16384
    s_add_u32 s101, s23, s74
    buffer_load_dwordx4 v208, s[48:51], s101 offen offset:0 lds
    v_mfma_f32_32x32x16_bf16 v[96:111], v[216:219], a[12:15], v[96:111]
    buffer_load_dwordx4 v209, s[48:51], s101 offen offset:1024 lds
    s_waitcnt lgkmcnt(0)
    v_mfma_f32_32x32x16_bf16 v[48:63], v[16:19], a[16:19], v[48:63]
    ds_read_b64_tr_b16 v[32:33], v178 offset:4096
    ds_read_b64_tr_b16 v[34:35], v178 offset:5120
    ds_read_b64_tr_b16 v[36:37], v181 offset:4096
    ds_read_b64_tr_b16 v[38:39], v181 offset:5120
    v_mfma_f32_32x32x16_bf16 v[64:79], v[20:23], a[16:19], v[64:79]
    ds_read_b64_tr_b16 v[40:41], v184 offset:4096
    ds_read_b64_tr_b16 v[42:43], v184 offset:5120
    ds_read_b128 v[216:219], v221 offset:32
    v_mfma_f32_32x32x16_bf16 v[80:95], v[24:27], a[16:19], v[80:95]
    buffer_load_dwordx4 v210, s[48:51], s101 offen offset:2048 lds
    v_mfma_f32_32x32x16_bf16 v[96:111], v[212:215], a[16:19], v[96:111]
    buffer_load_dwordx4 v211, s[48:51], s101 offen offset:3072 lds
    s_waitcnt lgkmcnt(0)
    v_mfma_f32_32x32x16_bf16 v[48:63], v[32:35], a[20:23], v[48:63]
    ds_read_b64_tr_b16 v[16:17], v178 offset:8192
    ds_read_b64_tr_b16 v[18:19], v178 offset:9216
    ds_read_b64_tr_b16 v[20:21], v181 offset:8192
    ds_read_b64_tr_b16 v[22:23], v181 offset:9216
    v_mfma_f32_32x32x16_bf16 v[64:79], v[36:39], a[20:23], v[64:79]
    ds_read_b64_tr_b16 v[24:25], v184 offset:8192
    ds_read_b64_tr_b16 v[26:27], v184 offset:9216
    ds_read_b128 v[212:215], v221 offset:64
    v_mfma_f32_32x32x16_bf16 v[80:95], v[40:43], a[20:23], v[80:95]
    s_add_u32 m0, s72, 49152
    s_add_u32 s100, s3, 3
    s_cmp_ge_u32 s100, 7
    s_cselect_b32 s7, 7, 0
    s_sub_u32 s100, s100, s7
    s_lshl_b32 s100, s100, 7
    s_add_u32 s100, s100, s73
    buffer_load_dwordx4 v188, s[44:47], s100 offen offset:0 lds
    v_mfma_f32_32x32x16_bf16 v[96:111], v[216:219], a[20:23], v[96:111]
    buffer_load_dwordx4 v189, s[44:47], s100 offen offset:1024 lds
    s_waitcnt lgkmcnt(0)
    v_mfma_f32_32x32x16_bf16 v[48:63], v[16:19], a[24:27], v[48:63]
    ds_read_b64_tr_b16 v[32:33], v178 offset:12288
    ds_read_b64_tr_b16 v[34:35], v178 offset:13312
    ds_read_b64_tr_b16 v[36:37], v181 offset:12288
    ds_read_b64_tr_b16 v[38:39], v181 offset:13312
    s_waitcnt vmcnt(12)
    ds_read_b128 a[32:35], v5 offset:32768
    v_mfma_f32_32x32x16_bf16 v[64:79], v[20:23], a[24:27], v[64:79]
    ds_read_b64_tr_b16 v[40:41], v184 offset:12288
    ds_read_b64_tr_b16 v[42:43], v184 offset:13312
    ds_read_b128 v[216:219], v221 offset:96
    buffer_load_dwordx4 v190, s[44:47], s100 offen offset:2048 lds
    ds_read_b128 a[36:39], v6 offset:32768
    v_mfma_f32_32x32x16_bf16 v[80:95], v[24:27], a[24:27], v[80:95]
    buffer_load_dwordx4 v191, s[44:47], s100 offen offset:3072 lds
    ds_read_b128 a[40:43], v7 offset:32768
    v_mfma_f32_32x32x16_bf16 v[96:111], v[212:215], a[24:27], v[96:111]
    ds_read_b128 a[44:47], v8 offset:32768
    s_waitcnt lgkmcnt(3)
    v_mfma_f32_32x32x16_bf16 v[48:63], v[32:35], a[28:31], v[48:63]
    s_waitcnt vmcnt(10)
    s_waitcnt lgkmcnt(0)
    s_barrier
    s_add_u32 m0, s72, 32768
    s_add_u32 s101, s24, s74
    ds_read_b64_tr_b16 v[16:17], v176 offset:0
    ds_read_b64_tr_b16 v[18:19], v176 offset:1024
    ds_read_b64_tr_b16 v[20:21], v179 offset:0
    ds_read_b64_tr_b16 v[22:23], v179 offset:1024
    buffer_load_dwordx4 v208, s[48:51], s101 offen offset:0 lds
    v_mfma_f32_32x32x16_bf16 v[64:79], v[36:39], a[28:31], v[64:79]
    ds_read_b64_tr_b16 v[24:25], v182 offset:0
    ds_read_b64_tr_b16 v[26:27], v182 offset:1024
    s_add_u32 s69, s3, 2
    s_cmp_ge_u32 s69, 7
    s_cselect_b32 s7, 7, 0
    s_sub_u32 s69, s69, s7
    s_lshl_b32 s69, s69, 7
    v_add_u32 v221, s69, v220
    ds_read_b128 v[212:215], v221 offset:0
    buffer_load_dwordx4 v209, s[48:51], s101 offen offset:1024 lds
    v_mfma_f32_32x32x16_bf16 v[80:95], v[40:43], a[28:31], v[80:95]
    buffer_load_dwordx4 v210, s[48:51], s101 offen offset:2048 lds
    v_mfma_f32_32x32x16_bf16 v[96:111], v[216:219], a[28:31], v[96:111]
    buffer_load_dwordx4 v211, s[48:51], s101 offen offset:3072 lds
    s_waitcnt lgkmcnt(0)
    v_mfma_f32_32x32x16_bf16 v[48:63], v[16:19], a[32:35], v[48:63]
    s_add_u32 m0, s72, 65536
    s_add_u32 s100, s3, 4
    s_cmp_ge_u32 s100, 7
    s_cselect_b32 s7, 7, 0
    s_sub_u32 s100, s100, s7
    s_lshl_b32 s100, s100, 7
    s_add_u32 s100, s100, s73
    ds_read_b64_tr_b16 v[32:33], v176 offset:4096
    ds_read_b64_tr_b16 v[34:35], v176 offset:5120
    ds_read_b64_tr_b16 v[36:37], v179 offset:4096
    ds_read_b64_tr_b16 v[38:39], v179 offset:5120
    buffer_load_dwordx4 v188, s[44:47], s100 offen offset:0 lds
    v_mfma_f32_32x32x16_bf16 v[64:79], v[20:23], a[32:35], v[64:79]
    ds_read_b64_tr_b16 v[40:41], v182 offset:4096
    ds_read_b64_tr_b16 v[42:43], v182 offset:5120
    ds_read_b128 v[216:219], v221 offset:32
    buffer_load_dwordx4 v189, s[44:47], s100 offen offset:1024 lds
    v_mfma_f32_32x32x16_bf16 v[80:95], v[24:27], a[32:35], v[80:95]
    buffer_load_dwordx4 v190, s[44:47], s100 offen offset:2048 lds
    v_mfma_f32_32x32x16_bf16 v[96:111], v[212:215], a[32:35], v[96:111]
    buffer_load_dwordx4 v191, s[44:47], s100 offen offset:3072 lds
    s_waitcnt lgkmcnt(0)
    v_mfma_f32_32x32x16_bf16 v[48:63], v[32:35], a[36:39], v[48:63]
    s_add_u32 m0, s72, 114688
    s_add_u32 s101, s25, s74
    ds_read_b64_tr_b16 v[16:17], v176 offset:8192
    ds_read_b64_tr_b16 v[18:19], v176 offset:9216
    ds_read_b64_tr_b16 v[20:21], v179 offset:8192
    ds_read_b64_tr_b16 v[22:23], v179 offset:9216
    buffer_load_dwordx4 v208, s[48:51], s101 offen offset:0 lds
    v_mfma_f32_32x32x16_bf16 v[64:79], v[36:39], a[36:39], v[64:79]
    ds_read_b64_tr_b16 v[24:25], v182 offset:8192
    ds_read_b64_tr_b16 v[26:27], v182 offset:9216
    ds_read_b128 v[212:215], v221 offset:64
    buffer_load_dwordx4 v209, s[48:51], s101 offen offset:1024 lds
    v_mfma_f32_32x32x16_bf16 v[80:95], v[40:43], a[36:39], v[80:95]
    buffer_load_dwordx4 v210, s[48:51], s101 offen offset:2048 lds
    v_mfma_f32_32x32x16_bf16 v[96:111], v[216:219], a[36:39], v[96:111]
    buffer_load_dwordx4 v211, s[48:51], s101 offen offset:3072 lds
    s_waitcnt lgkmcnt(0)
    v_mfma_f32_32x32x16_bf16 v[48:63], v[16:19], a[40:43], v[48:63]
    s_add_u32 m0, s72, 81920
    s_add_u32 s100, s3, 5
    s_cmp_ge_u32 s100, 7
    s_cselect_b32 s7, 7, 0
    s_sub_u32 s100, s100, s7
    s_lshl_b32 s100, s100, 7
    s_add_u32 s100, s100, s73
    ds_read_b64_tr_b16 v[32:33], v176 offset:12288
    ds_read_b64_tr_b16 v[34:35], v176 offset:13312
    ds_read_b64_tr_b16 v[36:37], v179 offset:12288
    ds_read_b64_tr_b16 v[38:39], v179 offset:13312
    buffer_load_dwordx4 v188, s[44:47], s100 offen offset:0 lds
    s_waitcnt vmcnt(13)
    ds_read_b128 a[48:51], v5 offset:49152
    v_mfma_f32_32x32x16_bf16 v[64:79], v[20:23], a[40:43], v[64:79]
    ds_read_b64_tr_b16 v[40:41], v182 offset:12288
    ds_read_b64_tr_b16 v[42:43], v182 offset:13312
    ds_read_b128 v[216:219], v221 offset:96
    buffer_load_dwordx4 v189, s[44:47], s100 offen offset:1024 lds
    ds_read_b128 a[52:55], v6 offset:49152
    v_mfma_f32_32x32x16_bf16 v[80:95], v[24:27], a[40:43], v[80:95]
    buffer_load_dwordx4 v190, s[44:47], s100 offen offset:2048 lds
    ds_read_b128 a[56:59], v7 offset:49152
    v_mfma_f32_32x32x16_bf16 v[96:111], v[212:215], a[40:43], v[96:111]
    buffer_load_dwordx4 v191, s[44:47], s100 offen offset:3072 lds
    ds_read_b128 a[60:63], v8 offset:49152
    s_waitcnt lgkmcnt(3)
    v_mfma_f32_32x32x16_bf16 v[48:63], v[32:35], a[44:47], v[48:63]
    s_barrier
    ds_read_b64_tr_b16 v[16:17], v176 offset:16384
    ds_read_b64_tr_b16 v[18:19], v176 offset:17408
    ds_read_b64_tr_b16 v[20:21], v179 offset:16384
    ds_read_b64_tr_b16 v[22:23], v179 offset:17408
    v_mfma_f32_32x32x16_bf16 v[64:79], v[36:39], a[44:47], v[64:79]
    ds_read_b64_tr_b16 v[24:25], v182 offset:16384
    ds_read_b64_tr_b16 v[26:27], v182 offset:17408
    s_add_u32 s69, s3, 3
    s_cmp_ge_u32 s69, 7
    s_cselect_b32 s7, 7, 0
    s_sub_u32 s69, s69, s7
    s_lshl_b32 s69, s69, 7
    v_add_u32 v221, s69, v220
    ds_read_b128 v[212:215], v221 offset:0
    v_mfma_f32_32x32x16_bf16 v[80:95], v[40:43], a[44:47], v[80:95]
    s_add_u32 m0, s72, 131072
    s_add_u32 s101, s28, s74
    buffer_load_dwordx4 v208, s[48:51], s101 offen offset:0 lds
    v_mfma_f32_32x32x16_bf16 v[96:111], v[216:219], a[44:47], v[96:111]
    buffer_load_dwordx4 v209, s[48:51], s101 offen offset:1024 lds
    s_waitcnt lgkmcnt(0)
    v_mfma_f32_32x32x16_bf16 v[48:63], v[16:19], a[48:51], v[48:63]
    ds_read_b64_tr_b16 v[32:33], v176 offset:20480
    ds_read_b64_tr_b16 v[34:35], v176 offset:21504
    ds_read_b64_tr_b16 v[36:37], v179 offset:20480
    ds_read_b64_tr_b16 v[38:39], v179 offset:21504
    v_mfma_f32_32x32x16_bf16 v[64:79], v[20:23], a[48:51], v[64:79]
    ds_read_b64_tr_b16 v[40:41], v182 offset:20480
    ds_read_b64_tr_b16 v[42:43], v182 offset:21504
    ds_read_b128 v[216:219], v221 offset:32
    v_mfma_f32_32x32x16_bf16 v[80:95], v[24:27], a[48:51], v[80:95]
    buffer_load_dwordx4 v210, s[48:51], s101 offen offset:2048 lds
    v_mfma_f32_32x32x16_bf16 v[96:111], v[212:215], a[48:51], v[96:111]
    buffer_load_dwordx4 v211, s[48:51], s101 offen offset:3072 lds
    s_waitcnt lgkmcnt(0)
    v_mfma_f32_32x32x16_bf16 v[48:63], v[32:35], a[52:55], v[48:63]
    ds_read_b64_tr_b16 v[16:17], v176 offset:24576
    ds_read_b64_tr_b16 v[18:19], v176 offset:25600
    ds_read_b64_tr_b16 v[20:21], v179 offset:24576
    ds_read_b64_tr_b16 v[22:23], v179 offset:25600
    v_mfma_f32_32x32x16_bf16 v[64:79], v[36:39], a[52:55], v[64:79]
    ds_read_b64_tr_b16 v[24:25], v182 offset:24576
    ds_read_b64_tr_b16 v[26:27], v182 offset:25600
    ds_read_b128 v[212:215], v221 offset:64
    v_mfma_f32_32x32x16_bf16 v[80:95], v[40:43], a[52:55], v[80:95]
    s_add_u32 m0, s72, 98304
    s_add_u32 s100, s3, 6
    s_cmp_ge_u32 s100, 7
    s_cselect_b32 s7, 7, 0
    s_sub_u32 s100, s100, s7
    s_lshl_b32 s100, s100, 7
    s_add_u32 s100, s100, s73
    buffer_load_dwordx4 v188, s[44:47], s100 offen offset:0 lds
    v_mfma_f32_32x32x16_bf16 v[96:111], v[216:219], a[52:55], v[96:111]
    buffer_load_dwordx4 v189, s[44:47], s100 offen offset:1024 lds
    s_waitcnt lgkmcnt(0)
    v_mfma_f32_32x32x16_bf16 v[48:63], v[16:19], a[56:59], v[48:63]
    ds_read_b64_tr_b16 v[32:33], v176 offset:28672
    ds_read_b64_tr_b16 v[34:35], v176 offset:29696
    ds_read_b64_tr_b16 v[36:37], v179 offset:28672
    ds_read_b64_tr_b16 v[38:39], v179 offset:29696
    s_waitcnt vmcnt(14)
    v_add_u32 v5, 0x10000, v5
    v_add_u32 v6, 0x10000, v6
    v_add_u32 v7, 0x10000, v7
    v_add_u32 v8, 0x10000, v8
    ds_read_b128 a[64:67], v5 offset:0
    v_mfma_f32_32x32x16_bf16 v[64:79], v[20:23], a[56:59], v[64:79]
    ds_read_b64_tr_b16 v[40:41], v182 offset:28672
    ds_read_b64_tr_b16 v[42:43], v182 offset:29696
    ds_read_b128 v[216:219], v221 offset:96
    buffer_load_dwordx4 v190, s[44:47], s100 offen offset:2048 lds
    ds_read_b128 a[68:71], v6 offset:0
    v_mfma_f32_32x32x16_bf16 v[80:95], v[24:27], a[56:59], v[80:95]
    buffer_load_dwordx4 v191, s[44:47], s100 offen offset:3072 lds
    ds_read_b128 a[72:75], v7 offset:0
    v_mfma_f32_32x32x16_bf16 v[96:111], v[212:215], a[56:59], v[96:111]
    ds_read_b128 a[76:79], v8 offset:0
    s_waitcnt lgkmcnt(3)
    v_mfma_f32_32x32x16_bf16 v[48:63], v[32:35], a[60:63], v[48:63]
    s_barrier
    ds_read_b64_tr_b16 v[16:17], v176 offset:32768
    ds_read_b64_tr_b16 v[18:19], v176 offset:33792
    ds_read_b64_tr_b16 v[20:21], v179 offset:32768
    ds_read_b64_tr_b16 v[22:23], v179 offset:33792
    v_mfma_f32_32x32x16_bf16 v[64:79], v[36:39], a[60:63], v[64:79]
    ds_read_b64_tr_b16 v[24:25], v182 offset:32768
    ds_read_b64_tr_b16 v[26:27], v182 offset:33792
    s_add_u32 s69, s3, 4
    s_cmp_ge_u32 s69, 7
    s_cselect_b32 s7, 7, 0
    s_sub_u32 s69, s69, s7
    s_lshl_b32 s69, s69, 7
    v_add_u32 v221, s69, v220
    ds_read_b128 v[212:215], v221 offset:0
    v_mfma_f32_32x32x16_bf16 v[80:95], v[40:43], a[60:63], v[80:95]
    v_mfma_f32_32x32x16_bf16 v[96:111], v[216:219], a[60:63], v[96:111]
    s_waitcnt lgkmcnt(0)
    v_mfma_f32_32x32x16_bf16 v[48:63], v[16:19], a[64:67], v[48:63]
    ds_read_b64_tr_b16 v[32:33], v176 offset:36864
    ds_read_b64_tr_b16 v[34:35], v176 offset:37888
    ds_read_b64_tr_b16 v[36:37], v179 offset:36864
    ds_read_b64_tr_b16 v[38:39], v179 offset:37888
    v_mfma_f32_32x32x16_bf16 v[64:79], v[20:23], a[64:67], v[64:79]
    ds_read_b64_tr_b16 v[40:41], v182 offset:36864
    ds_read_b64_tr_b16 v[42:43], v182 offset:37888
    ds_read_b128 v[216:219], v221 offset:32
    v_mfma_f32_32x32x16_bf16 v[80:95], v[24:27], a[64:67], v[80:95]
    v_mfma_f32_32x32x16_bf16 v[96:111], v[212:215], a[64:67], v[96:111]
    s_add_u32 m0, s72, 0
    s_add_u32 s101, s20, s75
    buffer_load_dwordx4 v208, s[48:51], s101 offen offset:0 lds
    s_waitcnt lgkmcnt(0)
    v_mfma_f32_32x32x16_bf16 v[48:63], v[32:35], a[68:71], v[48:63]
    ds_read_b64_tr_b16 v[16:17], v176 offset:40960
    ds_read_b64_tr_b16 v[18:19], v176 offset:41984
    ds_read_b64_tr_b16 v[20:21], v179 offset:40960
    ds_read_b64_tr_b16 v[22:23], v179 offset:41984
    v_mfma_f32_32x32x16_bf16 v[64:79], v[36:39], a[68:71], v[64:79]
    ds_read_b64_tr_b16 v[24:25], v182 offset:40960
    ds_read_b64_tr_b16 v[26:27], v182 offset:41984
    ds_read_b128 v[212:215], v221 offset:64
    v_mfma_f32_32x32x16_bf16 v[80:95], v[40:43], a[68:71], v[80:95]
    buffer_load_dwordx4 v209, s[48:51], s101 offen offset:1024 lds
    v_mfma_f32_32x32x16_bf16 v[96:111], v[216:219], a[68:71], v[96:111]
    s_waitcnt lgkmcnt(0)
    v_mfma_f32_32x32x16_bf16 v[48:63], v[16:19], a[72:75], v[48:63]
    ds_read_b64_tr_b16 v[32:33], v176 offset:45056
    ds_read_b64_tr_b16 v[34:35], v176 offset:46080
    ds_read_b64_tr_b16 v[36:37], v179 offset:45056
    ds_read_b64_tr_b16 v[38:39], v179 offset:46080
    s_waitcnt vmcnt(10)
    ds_read_b128 a[80:83], v5 offset:16384
    v_mfma_f32_32x32x16_bf16 v[64:79], v[20:23], a[72:75], v[64:79]
    ds_read_b64_tr_b16 v[40:41], v182 offset:45056
    ds_read_b64_tr_b16 v[42:43], v182 offset:46080
    ds_read_b128 v[216:219], v221 offset:96
    buffer_load_dwordx4 v210, s[48:51], s101 offen offset:2048 lds
    ds_read_b128 a[84:87], v6 offset:16384
    v_mfma_f32_32x32x16_bf16 v[80:95], v[24:27], a[72:75], v[80:95]
    buffer_load_dwordx4 v211, s[48:51], s101 offen offset:3072 lds
    ds_read_b128 a[88:91], v7 offset:16384
    v_mfma_f32_32x32x16_bf16 v[96:111], v[212:215], a[72:75], v[96:111]
    ds_read_b128 a[92:95], v8 offset:16384
    s_waitcnt lgkmcnt(3)
    v_mfma_f32_32x32x16_bf16 v[48:63], v[32:35], a[76:79], v[48:63]
    s_barrier
    ds_read_b64_tr_b16 v[16:17], v177 offset:49152
    ds_read_b64_tr_b16 v[18:19], v177 offset:50176
    ds_read_b64_tr_b16 v[20:21], v180 offset:49152
    ds_read_b64_tr_b16 v[22:23], v180 offset:50176
    v_mfma_f32_32x32x16_bf16 v[64:79], v[36:39], a[76:79], v[64:79]
    ds_read_b64_tr_b16 v[24:25], v183 offset:49152
    ds_read_b64_tr_b16 v[26:27], v183 offset:50176
    s_add_u32 s69, s3, 5
    s_cmp_ge_u32 s69, 7
    s_cselect_b32 s7, 7, 0
    s_sub_u32 s69, s69, s7
    s_lshl_b32 s69, s69, 7
    v_add_u32 v221, s69, v220
    ds_read_b128 v[212:215], v221 offset:0
    v_mfma_f32_32x32x16_bf16 v[80:95], v[40:43], a[76:79], v[80:95]
    v_mfma_f32_32x32x16_bf16 v[96:111], v[216:219], a[76:79], v[96:111]
    s_waitcnt lgkmcnt(0)
    v_mfma_f32_32x32x16_bf16 v[48:63], v[16:19], a[80:83], v[48:63]
    ds_read_b64_tr_b16 v[32:33], v177 offset:53248
    ds_read_b64_tr_b16 v[34:35], v177 offset:54272
    ds_read_b64_tr_b16 v[36:37], v180 offset:53248
    ds_read_b64_tr_b16 v[38:39], v180 offset:54272
    v_mfma_f32_32x32x16_bf16 v[64:79], v[20:23], a[80:83], v[64:79]
    ds_read_b64_tr_b16 v[40:41], v183 offset:53248
    ds_read_b64_tr_b16 v[42:43], v183 offset:54272
    ds_read_b128 v[216:219], v221 offset:32
    v_mfma_f32_32x32x16_bf16 v[80:95], v[24:27], a[80:83], v[80:95]
    v_mfma_f32_32x32x16_bf16 v[96:111], v[212:215], a[80:83], v[96:111]
    s_add_u32 m0, s72, 16384
    s_add_u32 s101, s21, s75
    buffer_load_dwordx4 v208, s[48:51], s101 offen offset:0 lds
    v_mov_b32 v243, 0
    buffer_load_dword v243, v243, s[8:11], 0 offen sc1
    s_waitcnt lgkmcnt(0)
    v_mfma_f32_32x32x16_bf16 v[48:63], v[32:35], a[84:87], v[48:63]
    ds_read_b64_tr_b16 v[16:17], v177 offset:57344
    ds_read_b64_tr_b16 v[18:19], v177 offset:58368
    ds_read_b64_tr_b16 v[20:21], v180 offset:57344
    ds_read_b64_tr_b16 v[22:23], v180 offset:58368
    v_mfma_f32_32x32x16_bf16 v[64:79], v[36:39], a[84:87], v[64:79]
    ds_read_b64_tr_b16 v[24:25], v183 offset:57344
    ds_read_b64_tr_b16 v[26:27], v183 offset:58368
    ds_read_b128 v[212:215], v221 offset:64
    v_mfma_f32_32x32x16_bf16 v[80:95], v[40:43], a[84:87], v[80:95]
    buffer_load_dwordx4 v209, s[48:51], s101 offen offset:1024 lds
    v_mfma_f32_32x32x16_bf16 v[96:111], v[216:219], a[84:87], v[96:111]
    s_waitcnt lgkmcnt(0)
    v_mfma_f32_32x32x16_bf16 v[48:63], v[16:19], a[88:91], v[48:63]
    ds_read_b64_tr_b16 v[32:33], v177 offset:61440
    ds_read_b64_tr_b16 v[34:35], v177 offset:62464
    ds_read_b64_tr_b16 v[36:37], v180 offset:61440
    ds_read_b64_tr_b16 v[38:39], v180 offset:62464
    s_waitcnt vmcnt(7)
    ds_read_b128 a[96:99], v5 offset:32768
    v_mfma_f32_32x32x16_bf16 v[64:79], v[20:23], a[88:91], v[64:79]
    ds_read_b64_tr_b16 v[40:41], v183 offset:61440
    ds_read_b64_tr_b16 v[42:43], v183 offset:62464
    ds_read_b128 v[216:219], v221 offset:96
    buffer_load_dwordx4 v210, s[48:51], s101 offen offset:2048 lds
    ds_read_b128 a[100:103], v6 offset:32768
    v_mfma_f32_32x32x16_bf16 v[80:95], v[24:27], a[88:91], v[80:95]
    buffer_load_dwordx4 v211, s[48:51], s101 offen offset:3072 lds
    ds_read_b128 a[104:107], v7 offset:32768
    v_mfma_f32_32x32x16_bf16 v[96:111], v[212:215], a[88:91], v[96:111]
    ds_read_b128 a[108:111], v8 offset:32768
    s_waitcnt lgkmcnt(3)
    v_mfma_f32_32x32x16_bf16 v[48:63], v[32:35], a[92:95], v[48:63]
    s_barrier
    ds_read_b64_tr_b16 v[16:17], v178 offset:0
    ds_read_b64_tr_b16 v[18:19], v178 offset:1024
    ds_read_b64_tr_b16 v[20:21], v181 offset:0
    ds_read_b64_tr_b16 v[22:23], v181 offset:1024
    v_mfma_f32_32x32x16_bf16 v[64:79], v[36:39], a[92:95], v[64:79]
    ds_read_b64_tr_b16 v[24:25], v184 offset:0
    ds_read_b64_tr_b16 v[26:27], v184 offset:1024
    s_add_u32 s69, s3, 6
    s_cmp_ge_u32 s69, 7
    s_cselect_b32 s7, 7, 0
    s_sub_u32 s69, s69, s7
    s_lshl_b32 s69, s69, 7
    v_add_u32 v221, s69, v220
    ds_read_b128 v[212:215], v221 offset:0
    v_mfma_f32_32x32x16_bf16 v[80:95], v[40:43], a[92:95], v[80:95]
    v_mfma_f32_32x32x16_bf16 v[96:111], v[216:219], a[92:95], v[96:111]
    s_waitcnt lgkmcnt(0)
    v_mfma_f32_32x32x16_bf16 v[48:63], v[16:19], a[96:99], v[48:63]
    ds_read_b64_tr_b16 v[32:33], v178 offset:4096
    ds_read_b64_tr_b16 v[34:35], v178 offset:5120
    ds_read_b64_tr_b16 v[36:37], v181 offset:4096
    ds_read_b64_tr_b16 v[38:39], v181 offset:5120
    v_mfma_f32_32x32x16_bf16 v[64:79], v[20:23], a[96:99], v[64:79]
    s_add_u32 m0, s17, 0
    s_mul_i32 s26, s29, 229376
    s_add_u32 s26, s26, s16
    ds_read_b64_tr_b16 v[40:41], v184 offset:4096
    ds_read_b64_tr_b16 v[42:43], v184 offset:5120
    ds_read_b128 v[216:219], v221 offset:32
    buffer_load_dwordx4 v232, s[56:59], s26 offen offset:0 lds
    v_mfma_f32_32x32x16_bf16 v[80:95], v[24:27], a[96:99], v[80:95]
    v_mfma_f32_32x32x16_bf16 v[96:111], v[212:215], a[96:99], v[96:111]
    s_add_u32 m0, s72, 32768
    s_add_u32 s101, s22, s75
    buffer_load_dwordx4 v208, s[48:51], s101 offen offset:0 lds
    s_waitcnt lgkmcnt(0)
    v_mfma_f32_32x32x16_bf16 v[48:63], v[32:35], a[100:103], v[48:63]
    ds_read_b64_tr_b16 v[16:17], v178 offset:8192
    ds_read_b64_tr_b16 v[18:19], v178 offset:9216
    ds_read_b64_tr_b16 v[20:21], v181 offset:8192
    ds_read_b64_tr_b16 v[22:23], v181 offset:9216
    v_mfma_f32_32x32x16_bf16 v[64:79], v[36:39], a[100:103], v[64:79]
    s_add_u32 m0, s17, 0
    ds_read_b64_tr_b16 v[24:25], v184 offset:8192
    ds_read_b64_tr_b16 v[26:27], v184 offset:9216
    ds_read_b128 v[212:215], v221 offset:64
    buffer_load_dwordx4 v233, s[56:59], s26 offen offset:1024 lds
    v_mfma_f32_32x32x16_bf16 v[80:95], v[40:43], a[100:103], v[80:95]
    s_add_u32 m0, s72, 32768
    s_nop 0
    buffer_load_dwordx4 v209, s[48:51], s101 offen offset:1024 lds
    v_mfma_f32_32x32x16_bf16 v[96:111], v[216:219], a[100:103], v[96:111]
    s_waitcnt lgkmcnt(0)
    v_mfma_f32_32x32x16_bf16 v[48:63], v[16:19], a[104:107], v[48:63]
    ds_read_b64_tr_b16 v[32:33], v178 offset:12288
    ds_read_b64_tr_b16 v[34:35], v178 offset:13312
    ds_read_b64_tr_b16 v[36:37], v181 offset:12288
    ds_read_b64_tr_b16 v[38:39], v181 offset:13312
    v_mfma_f32_32x32x16_bf16 v[64:79], v[20:23], a[104:107], v[64:79]
    ds_read_b64_tr_b16 v[40:41], v184 offset:12288
    ds_read_b64_tr_b16 v[42:43], v184 offset:13312
    ds_read_b128 v[216:219], v221 offset:96
    buffer_load_dwordx4 v210, s[48:51], s101 offen offset:2048 lds
    v_mfma_f32_32x32x16_bf16 v[80:95], v[24:27], a[104:107], v[80:95]
    buffer_load_dwordx4 v211, s[48:51], s101 offen offset:3072 lds
    v_mfma_f32_32x32x16_bf16 v[96:111], v[212:215], a[104:107], v[96:111]
    s_add_u32 m0, s17, 0
    s_nop 0
    buffer_load_dwordx4 v234, s[56:59], s26 offen offset:2048 lds
    s_waitcnt lgkmcnt(0)
    v_mfma_f32_32x32x16_bf16 v[48:63], v[32:35], a[108:111], v[48:63]
    s_waitcnt vmcnt(12)
    s_barrier
    s_add_u32 s70, s77, 1
    s_lshl_b32 s67, s70, 2
    s_lshr_b32 s78, 0xDB9630, s67
    s_and_b32 s78, s78, 15
    s_lshr_b32 s79, 0x322333, s67
    s_and_b32 s79, s79, 15
    s_lshl_b32 s68, s70, 7
    s_mul_i32 s92, s78, 56
    s_sub_u32 s92, s92, s68
    s_add_u32 s90, s92, 56
    s_lshl_b32 s67, s65, 2
    s_add_u32 s67, s67, s64
    s_lshl_b32 s67, s67, 15
    s_lshl_b32 s68, s78, 11
    s_add_u32 s67, s67, s68
    s_add_u32 s81, s67, 7340032
    s_add_u32 s91, s92, 112
    s_cmp_eq_u32 s79, 3
    s_cselect_b32 s91, s91, s92
    s_cselect_b32 s67, 0, 2130706432
    v_or_b32 v223, s67, v9
    v_bfe_u32 v10, v1, 2, 2
    v_and_b32 v11, 3, v1
    v_bfe_u32 v12, v1, 4, 1
    v_lshrrev_b32 v13, 5, v1
    v_lshlrev_b32 v11, 3, v11
    v_lshl_add_u32 v11, v12, 5, v11
    v_lshlrev_b32 v14, 8, v10
    v_lshl_add_u32 v14, v13, 11, v14
    v_lshlrev_b32 v10, 6, v10
    v_add_u32 v15, s92, v11
    v_xor_b32 v15, v15, v10
    v_add_u32 v176, v15, v14
    v_add_u32 v177, 0x10000, v176
    v_add_u32 v178, 0x20000, v176
    v_add_u32 v15, s90, v11
    v_xor_b32 v15, v15, v10
    v_add_u32 v179, v15, v14
    v_add_u32 v180, 0x10000, v179
    v_add_u32 v181, 0x20000, v179
    v_add_u32 v15, s91, v11
    v_xor_b32 v15, v15, v10
    v_add_u32 v182, v15, v14
    v_add_u32 v183, 0x10000, v182
    v_add_u32 v184, 0x20000, v182
    ds_read_b64_tr_b16 v[16:17], v176 offset:0
    ds_read_b64_tr_b16 v[18:19], v176 offset:1024
    ds_read_b64_tr_b16 v[20:21], v179 offset:0
    ds_read_b64_tr_b16 v[22:23], v179 offset:1024
    v_mfma_f32_32x32x16_bf16 v[64:79], v[36:39], a[108:111], v[64:79]
    ds_read_b64_tr_b16 v[24:25], v182 offset:0
    ds_read_b64_tr_b16 v[26:27], v182 offset:1024
    buffer_load_dwordx4 v235, s[56:59], s26 offen offset:3072 lds
    v_mfma_f32_32x32x16_bf16 v[80:95], v[40:43], a[108:111], v[80:95]
    v_mfma_f32_32x32x16_bf16 v[96:111], v[216:219], a[108:111], v[96:111]
    s_waitcnt lgkmcnt(0)
    v_mfma_f32_32x32x16_bf16 v[112:127], v[16:19], a[0:3], 0
    ds_read_b64_tr_b16 v[32:33], v176 offset:4096
    ds_read_b64_tr_b16 v[34:35], v176 offset:5120
    ds_read_b64_tr_b16 v[36:37], v179 offset:4096
    ds_read_b64_tr_b16 v[38:39], v179 offset:5120
    v_mul_f32 v204, s88, v48
    v_mfma_f32_32x32x16_bf16 v[128:143], v[20:23], a[0:3], 0
    s_add_u32 m0, s17, 4096
    s_mul_i32 s26, s30, 229376
    s_add_u32 s26, s26, s16
    ds_read_b64_tr_b16 v[40:41], v182 offset:4096
    ds_read_b64_tr_b16 v[42:43], v182 offset:5120
    buffer_load_dwordx4 v232, s[56:59], s26 offen offset:0 lds
    v_mfma_f32_32x32x16_bf16 v[144:159], v[24:27], a[0:3], 0
    s_add_u32 m0, s72, 114688
    s_add_u32 s101, s23, s75
    buffer_load_dwordx4 v208, s[48:51], s101 offen offset:0 lds
    v_mul_f32 v205, s88, v49
    v_exp_f32_e64 v204, v204 clamp
    v_exp_f32_e64 v205, v205 clamp
    v_max_f32 v48, 0, v48
    s_waitcnt lgkmcnt(0)
    v_mfma_f32_32x32x16_bf16 v[112:127], v[32:35], a[4:7], v[112:127]
    ds_read_b64_tr_b16 v[16:17], v176 offset:8192
    ds_read_b64_tr_b16 v[18:19], v176 offset:9216
    ds_read_b64_tr_b16 v[20:21], v179 offset:8192
    ds_read_b64_tr_b16 v[22:23], v179 offset:9216
    v_max_f32 v49, 0, v49
    v_mfma_f32_32x32x16_bf16 v[128:143], v[36:39], a[4:7], v[128:143]
    s_add_u32 m0, s17, 4096
    ds_read_b64_tr_b16 v[24:25], v182 offset:8192
    ds_read_b64_tr_b16 v[26:27], v182 offset:9216
    buffer_load_dwordx4 v233, s[56:59], s26 offen offset:1024 lds
    v_mfma_f32_32x32x16_bf16 v[144:159], v[40:43], a[4:7], v[144:159]
    s_add_u32 m0, s72, 114688
    s_nop 0
    buffer_load_dwordx4 v209, s[48:51], s101 offen offset:1024 lds
    v_add_f32 v204, s89, v204
    v_add_f32 v205, s89, v205
    v_add_f32 v48, v48, v204
    v_add_f32 v49, v49, v205
    s_waitcnt lgkmcnt(0)
    v_mfma_f32_32x32x16_bf16 v[112:127], v[16:19], a[8:11], v[112:127]
    ds_read_b64_tr_b16 v[32:33], v176 offset:12288
    ds_read_b64_tr_b16 v[34:35], v176 offset:13312
    ds_read_b64_tr_b16 v[36:37], v179 offset:12288
    ds_read_b64_tr_b16 v[38:39], v179 offset:13312
    buffer_load_dwordx4 v210, s[48:51], s101 offen offset:2048 lds
    v_mfma_f32_32x32x16_bf16 v[128:143], v[20:23], a[8:11], v[128:143]
    ds_read_b64_tr_b16 v[40:41], v182 offset:12288
    ds_read_b64_tr_b16 v[42:43], v182 offset:13312
    buffer_load_dwordx4 v211, s[48:51], s101 offen offset:3072 lds
    v_mfma_f32_32x32x16_bf16 v[144:159], v[24:27], a[8:11], v[144:159]
    s_add_u32 m0, s17, 4096
    s_nop 0
    buffer_load_dwordx4 v234, s[56:59], s26 offen offset:2048 lds
    v_cvt_pk_bf16_f32 v188, v48, v49
    v_mul_f32 v204, s88, v50
    v_mul_f32 v205, s88, v51
    v_exp_f32_e64 v204, v204 clamp
    s_waitcnt lgkmcnt(0)
    v_mfma_f32_32x32x16_bf16 v[112:127], v[32:35], a[12:15], v[112:127]
    s_waitcnt vmcnt(15)
    s_barrier
    ds_read_b64_tr_b16 v[16:17], v176 offset:16384
    ds_read_b64_tr_b16 v[18:19], v176 offset:17408
    ds_read_b64_tr_b16 v[20:21], v179 offset:16384
    ds_read_b64_tr_b16 v[22:23], v179 offset:17408
    v_exp_f32_e64 v205, v205 clamp
    v_mfma_f32_32x32x16_bf16 v[128:143], v[36:39], a[12:15], v[128:143]
    ds_read_b64_tr_b16 v[24:25], v182 offset:16384
    ds_read_b64_tr_b16 v[26:27], v182 offset:17408
    buffer_load_dwordx4 v235, s[56:59], s26 offen offset:3072 lds
    v_mfma_f32_32x32x16_bf16 v[144:159], v[40:43], a[12:15], v[144:159]
    v_max_f32 v50, 0, v50
    v_max_f32 v51, 0, v51
    v_add_f32 v204, s89, v204
    v_add_f32 v205, s89, v205
    v_add_f32 v50, v50, v204
    s_waitcnt lgkmcnt(0)
    v_mfma_f32_32x32x16_bf16 v[112:127], v[16:19], a[16:19], v[112:127]
    ds_read_b64_tr_b16 v[32:33], v176 offset:20480
    ds_read_b64_tr_b16 v[34:35], v176 offset:21504
    ds_read_b64_tr_b16 v[36:37], v179 offset:20480
    ds_read_b64_tr_b16 v[38:39], v179 offset:21504
    v_add_f32 v51, v51, v205
    v_mfma_f32_32x32x16_bf16 v[128:143], v[20:23], a[16:19], v[128:143]
    s_add_u32 m0, s17, 8192
    s_mul_i32 s26, s31, 229376
    s_add_u32 s26, s26, s16
    ds_read_b64_tr_b16 v[40:41], v182 offset:20480
    ds_read_b64_tr_b16 v[42:43], v182 offset:21504
    buffer_load_dwordx4 v232, s[56:59], s26 offen offset:0 lds
    v_mfma_f32_32x32x16_bf16 v[144:159], v[24:27], a[16:19], v[144:159]
    s_add_u32 m0, s72, 131072
    s_add_u32 s101, s24, s75
    buffer_load_dwordx4 v208, s[48:51], s101 offen offset:0 lds
    v_cvt_pk_bf16_f32 v189, v50, v51
    v_mul_f32 v204, s88, v52
    v_mul_f32 v205, s88, v53
    v_exp_f32_e64 v204, v204 clamp
    s_waitcnt lgkmcnt(0)
    v_mfma_f32_32x32x16_bf16 v[112:127], v[32:35], a[20:23], v[112:127]
    ds_read_b64_tr_b16 v[16:17], v176 offset:24576
    ds_read_b64_tr_b16 v[18:19], v176 offset:25600
    ds_read_b64_tr_b16 v[20:21], v179 offset:24576
    ds_read_b64_tr_b16 v[22:23], v179 offset:25600
    v_exp_f32_e64 v205, v205 clamp
    v_mfma_f32_32x32x16_bf16 v[128:143], v[36:39], a[20:23], v[128:143]
    s_add_u32 m0, s17, 8192
    ds_read_b64_tr_b16 v[24:25], v182 offset:24576
    ds_read_b64_tr_b16 v[26:27], v182 offset:25600
    buffer_load_dwordx4 v233, s[56:59], s26 offen offset:1024 lds
    v_mfma_f32_32x32x16_bf16 v[144:159], v[40:43], a[20:23], v[144:159]
    s_add_u32 m0, s72, 131072
    s_nop 0
    buffer_load_dwordx4 v209, s[48:51], s101 offen offset:1024 lds
    v_max_f32 v52, 0, v52
    v_max_f32 v53, 0, v53
    v_add_f32 v204, s89, v204
    v_add_f32 v205, s89, v205
    s_waitcnt lgkmcnt(0)
    v_mfma_f32_32x32x16_bf16 v[112:127], v[16:19], a[24:27], v[112:127]
    ds_read_b64_tr_b16 v[32:33], v176 offset:28672
    ds_read_b64_tr_b16 v[34:35], v176 offset:29696
    ds_read_b64_tr_b16 v[36:37], v179 offset:28672
    ds_read_b64_tr_b16 v[38:39], v179 offset:29696
    buffer_load_dwordx4 v210, s[48:51], s101 offen offset:2048 lds
    v_mfma_f32_32x32x16_bf16 v[128:143], v[20:23], a[24:27], v[128:143]
    ds_read_b64_tr_b16 v[40:41], v182 offset:28672
    ds_read_b64_tr_b16 v[42:43], v182 offset:29696
    buffer_load_dwordx4 v211, s[48:51], s101 offen offset:3072 lds
    v_mfma_f32_32x32x16_bf16 v[144:159], v[24:27], a[24:27], v[144:159]
    s_add_u32 m0, s17, 8192
    s_nop 0
    buffer_load_dwordx4 v234, s[56:59], s26 offen offset:2048 lds
    v_add_f32 v52, v52, v204
    v_add_f32 v53, v53, v205
    v_cvt_pk_bf16_f32 v190, v52, v53
    v_mul_f32 v204, s88, v54
    s_waitcnt lgkmcnt(0)
    v_mfma_f32_32x32x16_bf16 v[112:127], v[32:35], a[28:31], v[112:127]
    s_waitcnt vmcnt(17)
    s_barrier
    ds_read_b64_tr_b16 v[16:17], v176 offset:32768
    ds_read_b64_tr_b16 v[18:19], v176 offset:33792
    ds_read_b64_tr_b16 v[20:21], v179 offset:32768
    ds_read_b64_tr_b16 v[22:23], v179 offset:33792
    v_mul_f32 v205, s88, v55
    v_mfma_f32_32x32x16_bf16 v[128:143], v[36:39], a[28:31], v[128:143]
    ds_read_b64_tr_b16 v[24:25], v182 offset:32768
    ds_read_b64_tr_b16 v[26:27], v182 offset:33792
    buffer_load_dwordx4 v235, s[56:59], s26 offen offset:3072 lds
    v_mfma_f32_32x32x16_bf16 v[144:159], v[40:43], a[28:31], v[144:159]
    v_exp_f32_e64 v204, v204 clamp
    v_exp_f32_e64 v205, v205 clamp
    v_max_f32 v54, 0, v54
    v_max_f32 v55, 0, v55
    v_add_f32 v204, s89, v204
    s_waitcnt lgkmcnt(0)
    v_mfma_f32_32x32x16_bf16 v[112:127], v[16:19], a[32:35], v[112:127]
    ds_read_b64_tr_b16 v[32:33], v176 offset:36864
    ds_read_b64_tr_b16 v[34:35], v176 offset:37888
    ds_read_b64_tr_b16 v[36:37], v179 offset:36864
    ds_read_b64_tr_b16 v[38:39], v179 offset:37888
    v_add_f32 v205, s89, v205
    v_mfma_f32_32x32x16_bf16 v[128:143], v[20:23], a[32:35], v[128:143]
    ds_read_b64_tr_b16 v[40:41], v182 offset:36864
    ds_read_b64_tr_b16 v[42:43], v182 offset:37888
    s_waitcnt vmcnt(16)
    ds_read_b64_tr_b16 a[112:113], v236 offset:0
    ds_read_b64_tr_b16 a[114:115], v236 offset:1024
    v_mfma_f32_32x32x16_bf16 v[144:159], v[24:27], a[32:35], v[144:159]
    s_add_u32 m0, s72, 0
    s_add_u32 s101, s25, s75
    buffer_load_dwordx4 v208, s[48:51], s101 offen offset:0 lds
    v_add_f32 v54, v54, v204
    v_add_f32 v55, v55, v205
    v_cvt_pk_bf16_f32 v191, v54, v55
    v_mul_f32 v204, s88, v56
    s_waitcnt lgkmcnt(2)
    v_mfma_f32_32x32x16_bf16 v[112:127], v[32:35], a[36:39], v[112:127]
    ds_read_b64_tr_b16 v[16:17], v176 offset:40960
    ds_read_b64_tr_b16 v[18:19], v176 offset:41984
    ds_read_b64_tr_b16 v[20:21], v179 offset:40960
    ds_read_b64_tr_b16 v[22:23], v179 offset:41984
    v_mul_f32 v205, s88, v57
    v_mfma_f32_32x32x16_bf16 v[128:143], v[36:39], a[36:39], v[128:143]
    s_add_u32 m0, s17, 12288
    s_mul_i32 s26, s32, 229376
    s_add_u32 s26, s26, s16
    ds_read_b64_tr_b16 v[24:25], v182 offset:40960
    ds_read_b64_tr_b16 v[26:27], v182 offset:41984
    buffer_load_dwordx4 v232, s[56:59], s26 offen offset:0 lds
    v_mfma_f32_32x32x16_bf16 v[144:159], v[40:43], a[36:39], v[144:159]
    s_add_u32 m0, s72, 0
    s_nop 0
    buffer_load_dwordx4 v209, s[48:51], s101 offen offset:1024 lds
    v_exp_f32_e64 v204, v204 clamp
    v_exp_f32_e64 v205, v205 clamp
    v_max_f32 v56, 0, v56
    v_max_f32 v57, 0, v57
    s_waitcnt lgkmcnt(0)
    v_mfma_f32_32x32x16_bf16 v[112:127], v[16:19], a[40:43], v[112:127]
    ds_read_b64_tr_b16 v[32:33], v176 offset:45056
    ds_read_b64_tr_b16 v[34:35], v176 offset:46080
    ds_read_b64_tr_b16 v[36:37], v179 offset:45056
    ds_read_b64_tr_b16 v[38:39], v179 offset:46080
    buffer_load_dwordx4 v210, s[48:51], s101 offen offset:2048 lds
    v_mfma_f32_32x32x16_bf16 v[128:143], v[20:23], a[40:43], v[128:143]
    ds_read_b64_tr_b16 v[40:41], v182 offset:45056
    ds_read_b64_tr_b16 v[42:43], v182 offset:46080
    buffer_load_dwordx4 v211, s[48:51], s101 offen offset:3072 lds
    v_mfma_f32_32x32x16_bf16 v[144:159], v[24:27], a[40:43], v[144:159]
    s_add_u32 m0, s72, 147456
    s_mul_i32 s95, s29, 229376
    s_add_u32 s95, s95, s16
    s_add_u32 s95, s95, 114688
    buffer_load_dwordx4 v232, s[56:59], s95 offen offset:0 lds
    v_add_f32 v204, s89, v204
    v_add_f32 v205, s89, v205
    v_add_f32 v56, v56, v204
    v_add_f32 v57, v57, v205
    s_waitcnt lgkmcnt(0)
    v_mfma_f32_32x32x16_bf16 v[112:127], v[32:35], a[44:47], v[112:127]
    s_waitcnt vmcnt(16)
    s_barrier
    ds_read_b64_tr_b16 v[16:17], v177 offset:49152
    ds_read_b64_tr_b16 v[18:19], v177 offset:50176
    ds_read_b64_tr_b16 v[20:21], v180 offset:49152
    ds_read_b64_tr_b16 v[22:23], v180 offset:50176
    v_cvt_pk_bf16_f32 v192, v56, v57
    v_mfma_f32_32x32x16_bf16 v[128:143], v[36:39], a[44:47], v[128:143]
    ds_read_b64_tr_b16 v[24:25], v183 offset:49152
    ds_read_b64_tr_b16 v[26:27], v183 offset:50176
    ds_read_b64_tr_b16 a[116:117], v237 offset:0
    ds_read_b64_tr_b16 a[118:119], v237 offset:1024
    v_mfma_f32_32x32x16_bf16 v[144:159], v[40:43], a[44:47], v[144:159]
    s_add_u32 m0, s17, 12288
    s_nop 0
    buffer_load_dwordx4 v233, s[56:59], s26 offen offset:1024 lds
    v_mul_f32 v204, s88, v58
    v_mul_f32 v205, s88, v59
    v_exp_f32_e64 v204, v204 clamp
    v_exp_f32_e64 v205, v205 clamp
    s_waitcnt lgkmcnt(2)
    v_mfma_f32_32x32x16_bf16 v[112:127], v[16:19], a[48:51], v[112:127]
    ds_read_b64_tr_b16 v[32:33], v177 offset:53248
    ds_read_b64_tr_b16 v[34:35], v177 offset:54272
    ds_read_b64_tr_b16 v[36:37], v180 offset:53248
    ds_read_b64_tr_b16 v[38:39], v180 offset:54272
    v_max_f32 v58, 0, v58
    v_mfma_f32_32x32x16_bf16 v[128:143], v[20:23], a[48:51], v[128:143]
    s_add_u32 m0, s72, 147456
    ds_read_b64_tr_b16 v[40:41], v183 offset:53248
    ds_read_b64_tr_b16 v[42:43], v183 offset:54272
    buffer_load_dwordx4 v233, s[56:59], s95 offen offset:1024 lds
    v_mfma_f32_32x32x16_bf16 v[144:159], v[24:27], a[48:51], v[144:159]
    s_add_u32 m0, s72, 16384
    s_add_u32 s101, s28, s75
    buffer_load_dwordx4 v208, s[48:51], s101 offen offset:0 lds
    v_max_f32 v59, 0, v59
    v_add_f32 v204, s89, v204
    v_add_f32 v205, s89, v205
    v_add_f32 v58, v58, v204
    v_readfirstlane_b32 s76, v243
    s_nop 1
    s_cmp_lg_u32 s76, 0
    s_cbranch_scc1 nz_done_11
    s_mov_b32 s96, 0x8000
nz_12:
    v_mov_b32 v243, 0
    buffer_load_dword v243, v243, s[8:11], 0 offen sc1
    s_waitcnt vmcnt(0)
    v_readfirstlane_b32 s76, v243
    s_nop 1
    s_cmp_lg_u32 s76, 0
    s_cbranch_scc1 nz_done_11
    s_sleep 2
    s_sub_u32 s96, s96, 1
    s_cbranch_scc0 nz_12
nz_done_11:
    s_waitcnt lgkmcnt(0)
    v_mfma_f32_32x32x16_bf16 v[112:127], v[32:35], a[52:55], v[112:127]
    ds_read_b64_tr_b16 v[16:17], v177 offset:57344
    ds_read_b64_tr_b16 v[18:19], v177 offset:58368
    ds_read_b64_tr_b16 v[20:21], v180 offset:57344
    ds_read_b64_tr_b16 v[22:23], v180 offset:58368
    v_add_f32 v59, v59, v205
    v_mfma_f32_32x32x16_bf16 v[128:143], v[36:39], a[52:55], v[128:143]
    ds_read_b64_tr_b16 v[24:25], v183 offset:57344
    ds_read_b64_tr_b16 v[26:27], v183 offset:58368
    ds_read_b64_tr_b16 a[120:121], v236 offset:2048
    ds_read_b64_tr_b16 a[122:123], v236 offset:3072
    v_mfma_f32_32x32x16_bf16 v[144:159], v[40:43], a[52:55], v[144:159]
    buffer_load_dwordx4 v209, s[48:51], s101 offen offset:1024 lds
    v_cvt_pk_bf16_f32 v193, v58, v59
    v_mul_f32 v204, s88, v60
    v_mul_f32 v205, s88, v61
    v_exp_f32_e64 v204, v204 clamp
    s_waitcnt lgkmcnt(2)
    v_mfma_f32_32x32x16_bf16 v[112:127], v[16:19], a[56:59], v[112:127]
    ds_read_b64_tr_b16 v[32:33], v177 offset:61440
    ds_read_b64_tr_b16 v[34:35], v177 offset:62464
    ds_read_b64_tr_b16 v[36:37], v180 offset:61440
    ds_read_b64_tr_b16 v[38:39], v180 offset:62464
    buffer_load_dwordx4 v210, s[48:51], s101 offen offset:2048 lds
    v_mfma_f32_32x32x16_bf16 v[128:143], v[20:23], a[56:59], v[128:143]
    ds_read_b64_tr_b16 v[40:41], v183 offset:61440
    ds_read_b64_tr_b16 v[42:43], v183 offset:62464
    buffer_load_dwordx4 v211, s[48:51], s101 offen offset:3072 lds
    v_mfma_f32_32x32x16_bf16 v[144:159], v[24:27], a[56:59], v[144:159]
    s_add_u32 m0, s17, 12288
    s_nop 0
    buffer_load_dwordx4 v234, s[56:59], s26 offen offset:2048 lds
    v_exp_f32_e64 v205, v205 clamp
    v_max_f32 v60, 0, v60
    v_max_f32 v61, 0, v61
    v_add_f32 v204, s89, v204
    s_waitcnt lgkmcnt(0)
    v_mfma_f32_32x32x16_bf16 v[112:127], v[32:35], a[60:63], v[112:127]
    s_waitcnt vmcnt(15)
    s_barrier
    ds_read_b64_tr_b16 v[16:17], v178 offset:0
    ds_read_b64_tr_b16 v[18:19], v178 offset:1024
    ds_read_b64_tr_b16 v[20:21], v181 offset:0
    ds_read_b64_tr_b16 v[22:23], v181 offset:1024
    v_add_f32 v205, s89, v205
    v_mfma_f32_32x32x16_bf16 v[128:143], v[36:39], a[60:63], v[128:143]
    s_add_u32 m0, s72, 147456
    ds_read_b64_tr_b16 v[24:25], v184 offset:0
    ds_read_b64_tr_b16 v[26:27], v184 offset:1024
    buffer_load_dwordx4 v234, s[56:59], s95 offen offset:2048 lds
    v_mfma_f32_32x32x16_bf16 v[144:159], v[40:43], a[60:63], v[144:159]
    ds_read_b64_tr_b16 a[124:125], v237 offset:2048
    ds_read_b64_tr_b16 a[126:127], v237 offset:3072
    v_add_f32 v60, v60, v204
    v_add_f32 v61, v61, v205
    v_cvt_pk_bf16_f32 v194, v60, v61
    v_mul_f32 v204, s88, v62
    s_waitcnt lgkmcnt(2)
    v_mfma_f32_32x32x16_bf16 v[112:127], v[16:19], a[64:67], v[112:127]
    ds_read_b64_tr_b16 v[32:33], v178 offset:4096
    ds_read_b64_tr_b16 v[34:35], v178 offset:5120
    ds_read_b64_tr_b16 v[36:37], v181 offset:4096
    ds_read_b64_tr_b16 v[38:39], v181 offset:5120
    v_mul_f32 v205, s88, v63
    v_mfma_f32_32x32x16_bf16 v[128:143], v[20:23], a[64:67], v[128:143]
    s_add_u32 m0, s17, 12288
    ds_read_b64_tr_b16 v[40:41], v184 offset:4096
    ds_read_b64_tr_b16 v[42:43], v184 offset:5120
    buffer_load_dwordx4 v235, s[56:59], s26 offen offset:3072 lds
    v_mfma_f32_32x32x16_bf16 v[144:159], v[24:27], a[64:67], v[144:159]
    s_add_u32 m0, s72, 147456
    s_nop 0
    buffer_load_dwordx4 v235, s[56:59], s95 offen offset:3072 lds
    v_exp_f32_e64 v204, v204 clamp
    v_exp_f32_e64 v205, v205 clamp
    v_max_f32 v62, 0, v62
    v_max_f32 v63, 0, v63
    s_waitcnt lgkmcnt(0)
    v_mfma_f32_32x32x16_bf16 v[112:127], v[32:35], a[68:71], v[112:127]
    ds_read_b64_tr_b16 v[16:17], v178 offset:8192
    ds_read_b64_tr_b16 v[18:19], v178 offset:9216
    ds_read_b64_tr_b16 v[20:21], v181 offset:8192
    ds_read_b64_tr_b16 v[22:23], v181 offset:9216
    v_add_f32 v204, s89, v204
    v_mfma_f32_32x32x16_bf16 v[128:143], v[36:39], a[68:71], v[128:143]
    ds_read_b64_tr_b16 v[24:25], v184 offset:8192
    ds_read_b64_tr_b16 v[26:27], v184 offset:9216
    ds_read_b64_tr_b16 a[128:129], v236 offset:4096
    ds_read_b64_tr_b16 a[130:131], v236 offset:5120
    v_mfma_f32_32x32x16_bf16 v[144:159], v[40:43], a[68:71], v[144:159]
    s_waitcnt lgkmcnt(14)
    s_add_u32 m0, s17, 0
    s_mul_i32 s26, s33, 229376
    s_add_u32 s26, s26, s16
    buffer_load_dwordx4 v232, s[56:59], s26 offen offset:0 lds
    v_add_f32 v205, s89, v205
    v_add_f32 v62, v62, v204
    v_add_f32 v63, v63, v205
    v_cvt_pk_bf16_f32 v195, v62, v63
    s_waitcnt lgkmcnt(2)
    v_mfma_f32_32x32x16_bf16 v[112:127], v[16:19], a[72:75], v[112:127]
    ds_read_b64_tr_b16 v[32:33], v178 offset:12288
    ds_read_b64_tr_b16 v[34:35], v178 offset:13312
    ds_read_b64_tr_b16 v[36:37], v181 offset:12288
    ds_read_b64_tr_b16 v[38:39], v181 offset:13312
    v_mfma_f32_32x32x16_bf16 v[128:143], v[20:23], a[72:75], v[128:143]
    ds_read_b64_tr_b16 v[40:41], v184 offset:12288
    ds_read_b64_tr_b16 v[42:43], v184 offset:13312
    ds_read_b64_tr_b16 a[132:133], v237 offset:4096
    ds_read_b64_tr_b16 a[134:135], v237 offset:5120
    v_mfma_f32_32x32x16_bf16 v[144:159], v[24:27], a[72:75], v[144:159]
    buffer_load_dwordx4 v233, s[56:59], s26 offen offset:1024 lds
    v_cndmask_b32 v194, v194, 0, s[84:85]
    v_cndmask_b32 v195, v195, 0, s[84:85]
    s_add_u32 s68, s80, 0
    buffer_store_dwordx4 v[188:191], v9, s[52:55], s68 offen sc1
    buffer_store_dwordx4 v[192:195], v9, s[52:55], s68 offen offset:1024 sc1
    s_waitcnt lgkmcnt(2)
    v_mfma_f32_32x32x16_bf16 v[112:127], v[32:35], a[76:79], v[112:127]
    s_waitcnt vmcnt(15)
    s_barrier
    ds_read_b64_tr_b16 v[16:17], v176 offset:0
    ds_read_b64_tr_b16 v[18:19], v176 offset:1024
    ds_read_b64_tr_b16 v[20:21], v179 offset:0
    ds_read_b64_tr_b16 v[22:23], v179 offset:1024
    v_mfma_f32_32x32x16_bf16 v[128:143], v[36:39], a[76:79], v[128:143]
    ds_read_b64_tr_b16 v[24:25], v182 offset:0
    ds_read_b64_tr_b16 v[26:27], v182 offset:1024
    ds_read_b64_tr_b16 a[136:137], v236 offset:6144
    ds_read_b64_tr_b16 a[138:139], v236 offset:7168
    v_mfma_f32_32x32x16_bf16 v[144:159], v[40:43], a[76:79], v[144:159]
    buffer_load_dwordx4 v234, s[56:59], s26 offen offset:2048 lds
    v_mul_f32 v204, s88, v64
    v_mul_f32 v205, s88, v65
    v_exp_f32_e64 v204, v204 clamp
    s_waitcnt lgkmcnt(2)
    v_mfma_f32_32x32x16_bf16 v[112:127], v[16:19], a[80:83], v[112:127]
    ds_read_b64_tr_b16 v[32:33], v176 offset:4096
    ds_read_b64_tr_b16 v[34:35], v176 offset:5120
    ds_read_b64_tr_b16 v[36:37], v179 offset:4096
    ds_read_b64_tr_b16 v[38:39], v179 offset:5120
    v_mfma_f32_32x32x16_bf16 v[128:143], v[20:23], a[80:83], v[128:143]
    ds_read_b64_tr_b16 v[40:41], v182 offset:4096
    ds_read_b64_tr_b16 v[42:43], v182 offset:5120
    ds_read_b64_tr_b16 a[140:141], v237 offset:6144
    ds_read_b64_tr_b16 a[142:143], v237 offset:7168
    v_mfma_f32_32x32x16_bf16 v[144:159], v[24:27], a[80:83], v[144:159]
    buffer_load_dwordx4 v235, s[56:59], s26 offen offset:3072 lds
    v_exp_f32_e64 v205, v205 clamp
    v_max_f32 v64, 0, v64
    v_max_f32 v65, 0, v65
    s_waitcnt lgkmcnt(2)
    v_mfma_f32_32x32x16_bf16 v[112:127], v[32:35], a[84:87], v[112:127]
    ds_read_b64_tr_b16 v[16:17], v176 offset:8192
    ds_read_b64_tr_b16 v[18:19], v176 offset:9216
    ds_read_b64_tr_b16 v[20:21], v179 offset:8192
    ds_read_b64_tr_b16 v[22:23], v179 offset:9216
    v_mfma_f32_32x32x16_bf16 v[128:143], v[36:39], a[84:87], v[128:143]
    ds_read_b64_tr_b16 v[24:25], v182 offset:8192
    ds_read_b64_tr_b16 v[26:27], v182 offset:9216
    ds_read_b64_tr_b16 a[144:145], v236 offset:8192
    ds_read_b64_tr_b16 a[146:147], v236 offset:9216
    v_mfma_f32_32x32x16_bf16 v[144:159], v[40:43], a[84:87], v[144:159]
    s_waitcnt lgkmcnt(8)
    s_add_u32 m0, s17, 4096
    s_mul_i32 s26, s36, 229376
    s_add_u32 s26, s26, s16
    buffer_load_dwordx4 v232, s[56:59], s26 offen offset:0 lds
    v_add_f32 v204, s89, v204
    v_add_f32 v205, s89, v205
    v_add_f32 v64, v64, v204
    s_waitcnt lgkmcnt(2)
    v_mfma_f32_32x32x16_bf16 v[112:127], v[16:19], a[88:91], v[112:127]
    ds_read_b64_tr_b16 v[32:33], v176 offset:12288
    ds_read_b64_tr_b16 v[34:35], v176 offset:13312
    ds_read_b64_tr_b16 v[36:37], v179 offset:12288
    ds_read_b64_tr_b16 v[38:39], v179 offset:13312
    v_mfma_f32_32x32x16_bf16 v[128:143], v[20:23], a[88:91], v[128:143]
    s_add_u32 m0, s72, 32768
    s_mul_i32 s95, s30, 229376
    s_add_u32 s95, s95, s16
    s_add_u32 s95, s95, 114688
    ds_read_b64_tr_b16 v[40:41], v182 offset:12288
    ds_read_b64_tr_b16 v[42:43], v182 offset:13312
    buffer_load_dwordx4 v232, s[56:59], s95 offen offset:0 lds
    v_mfma_f32_32x32x16_bf16 v[144:159], v[24:27], a[88:91], v[144:159]
    ds_read_b64_tr_b16 a[148:149], v237 offset:8192
    ds_read_b64_tr_b16 a[150:151], v237 offset:9216
    v_add_f32 v65, v65, v205
    v_cvt_pk_bf16_f32 v196, v64, v65
    v_mul_f32 v204, s88, v66
    s_waitcnt lgkmcnt(2)
    v_mfma_f32_32x32x16_bf16 v[112:127], v[32:35], a[92:95], v[112:127]
    s_waitcnt vmcnt(12)
    s_barrier
    ds_read_b64_tr_b16 v[16:17], v176 offset:16384
    ds_read_b64_tr_b16 v[18:19], v176 offset:17408
    ds_read_b64_tr_b16 v[20:21], v179 offset:16384
    ds_read_b64_tr_b16 v[22:23], v179 offset:17408
    v_mfma_f32_32x32x16_bf16 v[128:143], v[36:39], a[92:95], v[128:143]
    s_add_u32 m0, s17, 4096
    ds_read_b64_tr_b16 v[24:25], v182 offset:16384
    ds_read_b64_tr_b16 v[26:27], v182 offset:17408
    buffer_load_dwordx4 v233, s[56:59], s26 offen offset:1024 lds
    v_mfma_f32_32x32x16_bf16 v[144:159], v[40:43], a[92:95], v[144:159]
    s_add_u32 m0, s72, 32768
    s_nop 0
    buffer_load_dwordx4 v233, s[56:59], s95 offen offset:1024 lds
    v_mul_f32 v205, s88, v67
    v_exp_f32_e64 v204, v204 clamp
    v_exp_f32_e64 v205, v205 clamp
    s_waitcnt lgkmcnt(0)
    v_mfma_f32_32x32x16_bf16 v[112:127], v[16:19], a[96:99], v[112:127]
    ds_read_b64_tr_b16 v[32:33], v176 offset:20480
    ds_read_b64_tr_b16 v[34:35], v176 offset:21504
    ds_read_b64_tr_b16 v[36:37], v179 offset:20480
    ds_read_b64_tr_b16 v[38:39], v179 offset:21504
    v_mfma_f32_32x32x16_bf16 v[128:143], v[20:23], a[96:99], v[128:143]
    ds_read_b64_tr_b16 v[40:41], v182 offset:20480
    ds_read_b64_tr_b16 v[42:43], v182 offset:21504
    ds_read_b64_tr_b16 a[152:153], v236 offset:10240
    ds_read_b64_tr_b16 a[154:155], v236 offset:11264
    v_mfma_f32_32x32x16_bf16 v[144:159], v[24:27], a[96:99], v[144:159]
    s_add_u32 m0, s17, 4096
    s_nop 0
    buffer_load_dwordx4 v234, s[56:59], s26 offen offset:2048 lds
    v_max_f32 v66, 0, v66
    v_max_f32 v67, 0, v67
    v_add_f32 v204, s89, v204
    s_waitcnt lgkmcnt(2)
    v_mfma_f32_32x32x16_bf16 v[112:127], v[32:35], a[100:103], v[112:127]
    ds_read_b64_tr_b16 v[16:17], v176 offset:24576
    ds_read_b64_tr_b16 v[18:19], v176 offset:25600
    ds_read_b64_tr_b16 v[20:21], v179 offset:24576
    ds_read_b64_tr_b16 v[22:23], v179 offset:25600
    v_mfma_f32_32x32x16_bf16 v[128:143], v[36:39], a[100:103], v[128:143]
    s_add_u32 m0, s72, 32768
    ds_read_b64_tr_b16 v[24:25], v182 offset:24576
    ds_read_b64_tr_b16 v[26:27], v182 offset:25600
    buffer_load_dwordx4 v234, s[56:59], s95 offen offset:2048 lds
    v_mfma_f32_32x32x16_bf16 v[144:159], v[40:43], a[100:103], v[144:159]
    ds_read_b64_tr_b16 a[156:157], v237 offset:10240
    ds_read_b64_tr_b16 a[158:159], v237 offset:11264
    v_add_f32 v205, s89, v205
    v_add_f32 v66, v66, v204
    v_add_f32 v67, v67, v205
    s_waitcnt lgkmcnt(2)
    v_mfma_f32_32x32x16_bf16 v[112:127], v[16:19], a[104:107], v[112:127]
    ds_read_b64_tr_b16 v[32:33], v176 offset:28672
    ds_read_b64_tr_b16 v[34:35], v176 offset:29696
    ds_read_b64_tr_b16 v[36:37], v179 offset:28672
    ds_read_b64_tr_b16 v[38:39], v179 offset:29696
    v_mfma_f32_32x32x16_bf16 v[128:143], v[20:23], a[104:107], v[128:143]
    s_add_u32 m0, s17, 4096
    ds_read_b64_tr_b16 v[40:41], v182 offset:28672
    ds_read_b64_tr_b16 v[42:43], v182 offset:29696
    buffer_load_dwordx4 v235, s[56:59], s26 offen offset:3072 lds
    v_mfma_f32_32x32x16_bf16 v[144:159], v[24:27], a[104:107], v[144:159]
    s_add_u32 m0, s72, 32768
    s_nop 0
    buffer_load_dwordx4 v235, s[56:59], s95 offen offset:3072 lds
    v_cvt_pk_bf16_f32 v197, v66, v67
    v_mul_f32 v204, s88, v68
    v_mul_f32 v205, s88, v69
    s_waitcnt lgkmcnt(0)
    v_mfma_f32_32x32x16_bf16 v[112:127], v[32:35], a[108:111], v[112:127]
    v_mfma_f32_32x32x16_bf16 v[128:143], v[36:39], a[108:111], v[128:143]
    s_waitcnt vmcnt(15)
    ds_read_b64_tr_b16 a[160:161], v236 offset:12288
    ds_read_b64_tr_b16 a[162:163], v236 offset:13312
    v_mfma_f32_32x32x16_bf16 v[144:159], v[40:43], a[108:111], v[144:159]
    s_waitcnt lgkmcnt(8)
    s_add_u32 m0, s17, 8192
    s_mul_i32 s26, s37, 229376
    s_add_u32 s26, s26, s16
    buffer_load_dwordx4 v232, s[56:59], s26 offen offset:0 lds
    v_exp_f32_e64 v204, v204 clamp
    v_exp_f32_e64 v205, v205 clamp
    v_max_f32 v68, 0, v68
    v_max_f32 v69, 0, v69
    v_add_f32 v204, s89, v204
    v_add_f32 v205, s89, v205
    v_add_f32 v68, v68, v204
    v_add_f32 v69, v69, v205
    v_cvt_pk_bf16_f32 v198, v68, v69
    v_mul_f32 v204, s88, v70
    v_mul_f32 v205, s88, v71
    v_exp_f32_e64 v204, v204 clamp
    v_exp_f32_e64 v205, v205 clamp
    v_max_f32 v70, 0, v70
    v_max_f32 v71, 0, v71
    v_add_f32 v204, s89, v204
    v_add_f32 v205, s89, v205
    v_add_f32 v70, v70, v204
    v_add_f32 v71, v71, v205
    v_cvt_pk_bf16_f32 v199, v70, v71
    v_mul_f32 v204, s88, v72
    v_mul_f32 v205, s88, v73
    v_exp_f32_e64 v204, v204 clamp
    v_exp_f32_e64 v205, v205 clamp
    v_max_f32 v72, 0, v72
    v_max_f32 v73, 0, v73
    v_add_f32 v204, s89, v204
    v_add_f32 v205, s89, v205
    v_add_f32 v72, v72, v204
    v_add_f32 v73, v73, v205
    v_cvt_pk_bf16_f32 v200, v72, v73
    v_mul_f32 v204, s88, v74
    v_mul_f32 v205, s88, v75
    v_exp_f32_e64 v204, v204 clamp
    v_exp_f32_e64 v205, v205 clamp
    v_max_f32 v74, 0, v74
    v_max_f32 v75, 0, v75
    v_add_f32 v204, s89, v204
    v_add_f32 v205, s89, v205
    v_add_f32 v74, v74, v204
    v_add_f32 v75, v75, v205
    v_cvt_pk_bf16_f32 v201, v74, v75
    v_mul_f32 v204, s88, v76
    v_mul_f32 v205, s88, v77
    v_exp_f32_e64 v204, v204 clamp
    v_exp_f32_e64 v205, v205 clamp
    v_max_f32 v76, 0, v76
    v_max_f32 v77, 0, v77
    v_add_f32 v204, s89, v204
    v_add_f32 v205, s89, v205
    v_add_f32 v76, v76, v204
    v_add_f32 v77, v77, v205
    v_cvt_pk_bf16_f32 v202, v76, v77
    v_mul_f32 v204, s88, v78
    v_mul_f32 v205, s88, v79
    v_exp_f32_e64 v204, v204 clamp
    v_exp_f32_e64 v205, v205 clamp
    v_max_f32 v78, 0, v78
    v_max_f32 v79, 0, v79
    v_add_f32 v204, s89, v204
    v_add_f32 v205, s89, v205
    v_add_f32 v78, v78, v204
    v_add_f32 v79, v79, v205
    v_cvt_pk_bf16_f32 v203, v78, v79
    v_cndmask_b32 v202, v202, 0, s[84:85]
    v_cndmask_b32 v203, v203, 0, s[84:85]
    s_add_u32 s68, s80, 2048
    buffer_store_dwordx4 v[196:199], v9, s[52:55], s68 offen sc1
    buffer_store_dwordx4 v[200:203], v9, s[52:55], s68 offen offset:1024 sc1
    v_mul_f32 v204, s88, v80
    v_mul_f32 v205, s88, v81
    v_exp_f32_e64 v204, v204 clamp
    v_exp_f32_e64 v205, v205 clamp
    v_max_f32 v80, 0, v80
    v_max_f32 v81, 0, v81
    v_add_f32 v204, s89, v204
    v_add_f32 v205, s89, v205
    v_add_f32 v80, v80, v204
    v_add_f32 v81, v81, v205
    v_cvt_pk_bf16_f32 v188, v80, v81
    v_mul_f32 v204, s88, v82
    v_mul_f32 v205, s88, v83
    v_exp_f32_e64 v204, v204 clamp
    v_exp_f32_e64 v205, v205 clamp
    v_max_f32 v82, 0, v82
    v_max_f32 v83, 0, v83
    v_add_f32 v204, s89, v204
    v_add_f32 v205, s89, v205
    v_add_f32 v82, v82, v204
    v_add_f32 v83, v83, v205
    v_cvt_pk_bf16_f32 v189, v82, v83
    v_mul_f32 v204, s88, v84
    v_mul_f32 v205, s88, v85
    v_exp_f32_e64 v204, v204 clamp
    v_exp_f32_e64 v205, v205 clamp
    v_max_f32 v84, 0, v84
    v_max_f32 v85, 0, v85
    v_add_f32 v204, s89, v204
    v_add_f32 v205, s89, v205
    v_add_f32 v84, v84, v204
    v_add_f32 v85, v85, v205
    v_cvt_pk_bf16_f32 v190, v84, v85
    v_mul_f32 v204, s88, v86
    v_mul_f32 v205, s88, v87
    v_exp_f32_e64 v204, v204 clamp
    v_exp_f32_e64 v205, v205 clamp
    v_max_f32 v86, 0, v86
    v_max_f32 v87, 0, v87
    v_add_f32 v204, s89, v204
    v_add_f32 v205, s89, v205
    v_add_f32 v86, v86, v204
    v_add_f32 v87, v87, v205
    v_cvt_pk_bf16_f32 v191, v86, v87
    v_mul_f32 v204, s88, v88
    v_mul_f32 v205, s88, v89
    v_exp_f32_e64 v204, v204 clamp
    v_exp_f32_e64 v205, v205 clamp
    v_max_f32 v88, 0, v88
    v_max_f32 v89, 0, v89
    v_add_f32 v204, s89, v204
    v_add_f32 v205, s89, v205
    v_add_f32 v88, v88, v204
    v_add_f32 v89, v89, v205
    v_cvt_pk_bf16_f32 v192, v88, v89
    v_mul_f32 v204, s88, v90
    v_mul_f32 v205, s88, v91
    v_exp_f32_e64 v204, v204 clamp
    v_exp_f32_e64 v205, v205 clamp
    v_max_f32 v90, 0, v90
    v_max_f32 v91, 0, v91
    v_add_f32 v204, s89, v204
    v_add_f32 v205, s89, v205
    v_add_f32 v90, v90, v204
    v_add_f32 v91, v91, v205
    v_cvt_pk_bf16_f32 v193, v90, v91
    v_mul_f32 v204, s88, v92
    v_mul_f32 v205, s88, v93
    v_exp_f32_e64 v204, v204 clamp
    v_exp_f32_e64 v205, v205 clamp
    v_max_f32 v92, 0, v92
    v_max_f32 v93, 0, v93
    v_add_f32 v204, s89, v204
    v_add_f32 v205, s89, v205
    v_add_f32 v92, v92, v204
    v_add_f32 v93, v93, v205
    v_cvt_pk_bf16_f32 v194, v92, v93
    v_mul_f32 v204, s88, v94
    v_mul_f32 v205, s88, v95
    v_exp_f32_e64 v204, v204 clamp
    v_exp_f32_e64 v205, v205 clamp
    v_max_f32 v94, 0, v94
    v_max_f32 v95, 0, v95
    v_add_f32 v204, s89, v204
    v_add_f32 v205, s89, v205
    v_add_f32 v94, v94, v204
    v_add_f32 v95, v95, v205
    v_cvt_pk_bf16_f32 v195, v94, v95
    v_cndmask_b32 v194, v194, 0, s[84:85]
    v_cndmask_b32 v195, v195, 0, s[84:85]
    s_add_u32 s68, s80, 4096
    buffer_store_dwordx4 v[188:191], v222, s[52:55], s68 offen sc1
    buffer_store_dwordx4 v[192:195], v222, s[52:55], s68 offen offset:1024 sc1
    v_mul_f32 v206, s88, v96
    v_exp_f32_e64 v206, -v206
    v_and_b32 v207, 31, v1
    v_add_f32 v206, 1.0, v206
    v_rcp_f32 v206, v206
    v_lshlrev_b32 v207, 2, v207
    v_or_b32 v207, s94, v207
    buffer_store_dword v206, v207, s[52:55], s93 offen sc1
    s_add_u32 m0, s72, 114688
    s_mul_i32 s95, s31, 229376
    s_add_u32 s95, s95, s16
    s_add_u32 s95, s95, 114688
    buffer_load_dwordx4 v232, s[56:59], s95 offen offset:0 lds
    s_add_u32 m0, s17, 8192
    s_nop 0
    buffer_load_dwordx4 v233, s[56:59], s26 offen offset:1024 lds
    s_add_u32 m0, s72, 114688
    s_nop 0
    buffer_load_dwordx4 v233, s[56:59], s95 offen offset:1024 lds
    s_add_u32 m0, s17, 8192
    s_nop 0
    buffer_load_dwordx4 v234, s[56:59], s26 offen offset:2048 lds
    s_add_u32 m0, s72, 114688
    s_nop 0
    buffer_load_dwordx4 v234, s[56:59], s95 offen offset:2048 lds
    s_add_u32 m0, s17, 8192
    s_nop 0
    buffer_load_dwordx4 v235, s[56:59], s26 offen offset:3072 lds
    s_add_u32 m0, s72, 114688
    s_nop 0
    buffer_load_dwordx4 v235, s[56:59], s95 offen offset:3072 lds
    s_add_u32 m0, s72, 131072
    s_mul_i32 s95, s32, 229376
    s_add_u32 s95, s95, s16
    s_add_u32 s95, s95, 114688
    buffer_load_dwordx4 v232, s[56:59], s95 offen offset:0 lds
    buffer_load_dwordx4 v233, s[56:59], s95 offen offset:1024 lds
    buffer_load_dwordx4 v234, s[56:59], s95 offen offset:2048 lds
    buffer_load_dwordx4 v235, s[56:59], s95 offen offset:3072 lds
    v_lshlrev_b32 v2, 2, v1
    v_pk_mul_f32 v[16:17], v[112:113], s[88:89] op_sel_hi:[1,0]
    v_pk_mul_f32 v[18:19], v[114:115], s[88:89] op_sel_hi:[1,0]
    v_pk_mul_f32 v[20:21], v[116:117], s[88:89] op_sel_hi:[1,0]
    v_pk_mul_f32 v[22:23], v[118:119], s[88:89] op_sel_hi:[1,0]
    v_pk_mul_f32 v[24:25], v[120:121], s[88:89] op_sel_hi:[1,0]
    v_pk_mul_f32 v[26:27], v[122:123], s[88:89] op_sel_hi:[1,0]
    v_pk_mul_f32 v[28:29], v[124:125], s[88:89] op_sel_hi:[1,0]
    v_pk_mul_f32 v[30:31], v[126:127], s[88:89] op_sel_hi:[1,0]
    v_exp_f32_e64 v16, v16 clamp
    v_exp_f32_e64 v17, v17 clamp
    v_exp_f32_e64 v18, v18 clamp
    v_exp_f32_e64 v19, v19 clamp
    v_exp_f32_e64 v20, v20 clamp
    v_exp_f32_e64 v21, v21 clamp
    v_exp_f32_e64 v22, v22 clamp
    v_exp_f32_e64 v23, v23 clamp
    v_exp_f32_e64 v24, v24 clamp
    v_exp_f32_e64 v25, v25 clamp
    v_exp_f32_e64 v26, v26 clamp
    v_exp_f32_e64 v27, v27 clamp
    v_exp_f32_e64 v28, v28 clamp
    v_exp_f32_e64 v29, v29 clamp
    v_exp_f32_e64 v30, v30 clamp
    v_exp_f32_e64 v31, v31 clamp
    v_max_f32 v112, 0, v112
    v_max_f32 v113, 0, v113
    v_max_f32 v114, 0, v114
    v_max_f32 v115, 0, v115
    v_max_f32 v116, 0, v116
    v_max_f32 v117, 0, v117
    v_max_f32 v118, 0, v118
    v_max_f32 v119, 0, v119
    v_max_f32 v120, 0, v120
    v_max_f32 v121, 0, v121
    v_max_f32 v122, 0, v122
    v_max_f32 v123, 0, v123
    v_max_f32 v124, 0, v124
    v_max_f32 v125, 0, v125
    v_max_f32 v126, 0, v126
    v_max_f32 v127, 0, v127
    v_add_f32 v16, s89, v16
    v_add_f32 v17, s89, v17
    v_add_f32 v18, s89, v18
    v_add_f32 v19, s89, v19
    v_add_f32 v20, s89, v20
    v_add_f32 v21, s89, v21
    v_add_f32 v22, s89, v22
    v_add_f32 v23, s89, v23
    v_add_f32 v24, s89, v24
    v_add_f32 v25, s89, v25
    v_add_f32 v26, s89, v26
    v_add_f32 v27, s89, v27
    v_add_f32 v28, s89, v28
    v_add_f32 v29, s89, v29
    v_add_f32 v30, s89, v30
    v_add_f32 v31, s89, v31
    v_pk_add_f32 v[112:113], v[112:113], v[16:17]
    v_pk_add_f32 v[114:115], v[114:115], v[18:19]
    v_pk_add_f32 v[116:117], v[116:117], v[20:21]
    v_pk_add_f32 v[118:119], v[118:119], v[22:23]
    v_pk_add_f32 v[120:121], v[120:121], v[24:25]
    v_pk_add_f32 v[122:123], v[122:123], v[26:27]
    v_pk_add_f32 v[124:125], v[124:125], v[28:29]
    v_pk_add_f32 v[126:127], v[126:127], v[30:31]
    v_cvt_pk_bf16_f32 v188, v112, v113
    v_cvt_pk_bf16_f32 v189, v114, v115
    v_cvt_pk_bf16_f32 v190, v116, v117
    v_cvt_pk_bf16_f32 v191, v118, v119
    v_cvt_pk_bf16_f32 v192, v120, v121
    v_cvt_pk_bf16_f32 v193, v122, v123
    v_cvt_pk_bf16_f32 v194, v124, v125
    v_cvt_pk_bf16_f32 v195, v126, v127
    v_cndmask_b32 v194, v194, 0, s[84:85]
    v_cndmask_b32 v195, v195, 0, s[84:85]
    s_add_u32 s68, s81, 0
    buffer_store_dwordx4 v[188:191], v9, s[52:55], s68 offen sc1
    buffer_store_dwordx4 v[192:195], v9, s[52:55], s68 offen offset:1024 sc1
    v_pk_mul_f32 v[16:17], v[128:129], s[88:89] op_sel_hi:[1,0]
    v_pk_mul_f32 v[18:19], v[130:131], s[88:89] op_sel_hi:[1,0]
    v_pk_mul_f32 v[20:21], v[132:133], s[88:89] op_sel_hi:[1,0]
    v_pk_mul_f32 v[22:23], v[134:135], s[88:89] op_sel_hi:[1,0]
    v_pk_mul_f32 v[24:25], v[136:137], s[88:89] op_sel_hi:[1,0]
    v_pk_mul_f32 v[26:27], v[138:139], s[88:89] op_sel_hi:[1,0]
    v_pk_mul_f32 v[28:29], v[140:141], s[88:89] op_sel_hi:[1,0]
    v_pk_mul_f32 v[30:31], v[142:143], s[88:89] op_sel_hi:[1,0]
    v_exp_f32_e64 v16, v16 clamp
    v_exp_f32_e64 v17, v17 clamp
    v_exp_f32_e64 v18, v18 clamp
    v_exp_f32_e64 v19, v19 clamp
    v_exp_f32_e64 v20, v20 clamp
    v_exp_f32_e64 v21, v21 clamp
    v_exp_f32_e64 v22, v22 clamp
    v_exp_f32_e64 v23, v23 clamp
    v_exp_f32_e64 v24, v24 clamp
    v_exp_f32_e64 v25, v25 clamp
    v_exp_f32_e64 v26, v26 clamp
    v_exp_f32_e64 v27, v27 clamp
    v_exp_f32_e64 v28, v28 clamp
    v_exp_f32_e64 v29, v29 clamp
    v_exp_f32_e64 v30, v30 clamp
    v_exp_f32_e64 v31, v31 clamp
    v_max_f32 v128, 0, v128
    v_max_f32 v129, 0, v129
    v_max_f32 v130, 0, v130
    v_max_f32 v131, 0, v131
    v_max_f32 v132, 0, v132
    v_max_f32 v133, 0, v133
    v_max_f32 v134, 0, v134
    v_max_f32 v135, 0, v135
    v_max_f32 v136, 0, v136
    v_max_f32 v137, 0, v137
    v_max_f32 v138, 0, v138
    v_max_f32 v139, 0, v139
    v_max_f32 v140, 0, v140
    v_max_f32 v141, 0, v141
    v_max_f32 v142, 0, v142
    v_max_f32 v143, 0, v143
    v_add_f32 v16, s89, v16
    v_add_f32 v17, s89, v17
    v_add_f32 v18, s89, v18
    v_add_f32 v19, s89, v19
    v_add_f32 v20, s89, v20
    v_add_f32 v21, s89, v21
    v_add_f32 v22, s89, v22
    v_add_f32 v23, s89, v23
    v_add_f32 v24, s89, v24
    v_add_f32 v25, s89, v25
    v_add_f32 v26, s89, v26
    v_add_f32 v27, s89, v27
    v_add_f32 v28, s89, v28
    v_add_f32 v29, s89, v29
    v_add_f32 v30, s89, v30
    v_add_f32 v31, s89, v31
    v_pk_add_f32 v[128:129], v[128:129], v[16:17]
    v_pk_add_f32 v[130:131], v[130:131], v[18:19]
    v_pk_add_f32 v[132:133], v[132:133], v[20:21]
    v_pk_add_f32 v[134:135], v[134:135], v[22:23]
    v_pk_add_f32 v[136:137], v[136:137], v[24:25]
    v_pk_add_f32 v[138:139], v[138:139], v[26:27]
    v_pk_add_f32 v[140:141], v[140:141], v[28:29]
    v_pk_add_f32 v[142:143], v[142:143], v[30:31]
    v_cvt_pk_bf16_f32 v196, v128, v129
    v_cvt_pk_bf16_f32 v197, v130, v131
    v_cvt_pk_bf16_f32 v198, v132, v133
    v_cvt_pk_bf16_f32 v199, v134, v135
    v_cvt_pk_bf16_f32 v200, v136, v137
    v_cvt_pk_bf16_f32 v201, v138, v139
    v_cvt_pk_bf16_f32 v202, v140, v141
    v_cvt_pk_bf16_f32 v203, v142, v143
    v_cndmask_b32 v202, v202, 0, s[84:85]
    v_cndmask_b32 v203, v203, 0, s[84:85]
    s_add_u32 s68, s81, 2048
    buffer_store_dwordx4 v[196:199], v9, s[52:55], s68 offen sc1
    buffer_store_dwordx4 v[200:203], v9, s[52:55], s68 offen offset:1024 sc1
    v_pk_mul_f32 v[16:17], v[144:145], s[88:89] op_sel_hi:[1,0]
    v_pk_mul_f32 v[18:19], v[146:147], s[88:89] op_sel_hi:[1,0]
    v_pk_mul_f32 v[20:21], v[148:149], s[88:89] op_sel_hi:[1,0]
    v_pk_mul_f32 v[22:23], v[150:151], s[88:89] op_sel_hi:[1,0]
    v_pk_mul_f32 v[24:25], v[152:153], s[88:89] op_sel_hi:[1,0]
    v_pk_mul_f32 v[26:27], v[154:155], s[88:89] op_sel_hi:[1,0]
    v_pk_mul_f32 v[28:29], v[156:157], s[88:89] op_sel_hi:[1,0]
    v_pk_mul_f32 v[30:31], v[158:159], s[88:89] op_sel_hi:[1,0]
    v_exp_f32_e64 v16, v16 clamp
    v_exp_f32_e64 v17, v17 clamp
    v_exp_f32_e64 v18, v18 clamp
    v_exp_f32_e64 v19, v19 clamp
    v_exp_f32_e64 v20, v20 clamp
    v_exp_f32_e64 v21, v21 clamp
    v_exp_f32_e64 v22, v22 clamp
    v_exp_f32_e64 v23, v23 clamp
    v_exp_f32_e64 v24, v24 clamp
    v_exp_f32_e64 v25, v25 clamp
    v_exp_f32_e64 v26, v26 clamp
    v_exp_f32_e64 v27, v27 clamp
    v_exp_f32_e64 v28, v28 clamp
    v_exp_f32_e64 v29, v29 clamp
    v_exp_f32_e64 v30, v30 clamp
    v_exp_f32_e64 v31, v31 clamp
    v_max_f32 v144, 0, v144
    v_max_f32 v145, 0, v145
    v_max_f32 v146, 0, v146
    v_max_f32 v147, 0, v147
    v_max_f32 v148, 0, v148
    v_max_f32 v149, 0, v149
    v_max_f32 v150, 0, v150
    v_max_f32 v151, 0, v151
    v_max_f32 v152, 0, v152
    v_max_f32 v153, 0, v153
    v_max_f32 v154, 0, v154
    v_max_f32 v155, 0, v155
    v_max_f32 v156, 0, v156
    v_max_f32 v157, 0, v157
    v_max_f32 v158, 0, v158
    v_max_f32 v159, 0, v159
    v_add_f32 v16, s89, v16
    v_add_f32 v17, s89, v17
    v_add_f32 v18, s89, v18
    v_add_f32 v19, s89, v19
    v_add_f32 v20, s89, v20
    v_add_f32 v21, s89, v21
    v_add_f32 v22, s89, v22
    v_add_f32 v23, s89, v23
    v_add_f32 v24, s89, v24
    v_add_f32 v25, s89, v25
    v_add_f32 v26, s89, v26
    v_add_f32 v27, s89, v27
    v_add_f32 v28, s89, v28
    v_add_f32 v29, s89, v29
    v_add_f32 v30, s89, v30
    v_add_f32 v31, s89, v31
    v_pk_add_f32 v[144:145], v[144:145], v[16:17]
    v_pk_add_f32 v[146:147], v[146:147], v[18:19]
    v_pk_add_f32 v[148:149], v[148:149], v[20:21]
    v_pk_add_f32 v[150:151], v[150:151], v[22:23]
    v_pk_add_f32 v[152:153], v[152:153], v[24:25]
    v_pk_add_f32 v[154:155], v[154:155], v[26:27]
    v_pk_add_f32 v[156:157], v[156:157], v[28:29]
    v_pk_add_f32 v[158:159], v[158:159], v[30:31]
    v_cvt_pk_bf16_f32 v204, v144, v145
    v_cvt_pk_bf16_f32 v205, v146, v147
    v_cvt_pk_bf16_f32 v206, v148, v149
    v_cvt_pk_bf16_f32 v207, v150, v151
    v_cvt_pk_bf16_f32 v208, v152, v153
    v_cvt_pk_bf16_f32 v209, v154, v155
    v_cvt_pk_bf16_f32 v210, v156, v157
    v_cvt_pk_bf16_f32 v211, v158, v159
    v_cndmask_b32 v210, v210, 0, s[84:85]
    v_cndmask_b32 v211, v211, 0, s[84:85]
    s_add_u32 s68, s81, 4096
    buffer_store_dwordx4 v[204:207], v223, s[52:55], s68 offen sc1
    buffer_store_dwordx4 v[208:211], v223, s[52:55], s68 offen offset:1024 sc1
    ds_read_b64_tr_b16 a[164:165], v237 offset:12288
    ds_read_b64_tr_b16 a[166:167], v237 offset:13312
    ds_read_b64_tr_b16 a[168:169], v236 offset:14336
    ds_read_b64_tr_b16 a[170:171], v236 offset:15360
    ds_read_b64_tr_b16 a[172:173], v237 offset:14336
    ds_read_b64_tr_b16 a[174:175], v237 offset:15360
    s_waitcnt vmcnt(31)
    ds_read_b64_tr_b16 a[176:177], v236 offset:0
    ds_read_b64_tr_b16 a[178:179], v236 offset:1024
    ds_read_b64_tr_b16 a[180:181], v237 offset:0
    ds_read_b64_tr_b16 a[182:183], v237 offset:1024
    ds_read_b64_tr_b16 a[184:185], v236 offset:2048
    ds_read_b64_tr_b16 a[186:187], v236 offset:3072
    ds_read_b64_tr_b16 a[188:189], v237 offset:2048
    ds_read_b64_tr_b16 a[190:191], v237 offset:3072
    s_waitcnt vmcnt(24)
    ds_read_b64_tr_b16 a[192:193], v236 offset:4096
    ds_read_b64_tr_b16 a[194:195], v236 offset:5120
    ds_read_b64_tr_b16 a[196:197], v237 offset:4096
    ds_read_b64_tr_b16 a[198:199], v237 offset:5120
    ds_read_b64_tr_b16 a[200:201], v236 offset:6144
    ds_read_b64_tr_b16 a[202:203], v236 offset:7168
    ds_read_b64_tr_b16 a[204:205], v237 offset:6144
    ds_read_b64_tr_b16 a[206:207], v237 offset:7168
    s_waitcnt vmcnt(11)
    ds_read_b64_tr_b16 a[208:209], v236 offset:8192
    ds_read_b64_tr_b16 a[210:211], v236 offset:9216
    ds_read_b64_tr_b16 a[212:213], v237 offset:8192
    ds_read_b64_tr_b16 a[214:215], v237 offset:9216
    ds_read_b64_tr_b16 a[216:217], v236 offset:10240
    ds_read_b64_tr_b16 a[218:219], v236 offset:11264
    ds_read_b64_tr_b16 a[220:221], v237 offset:10240
    ds_read_b64_tr_b16 a[222:223], v237 offset:11264
    s_waitcnt lgkmcnt(0)
    s_add_u32 m0, s17, 12288
    s_mul_i32 s26, s33, 229376
    s_add_u32 s26, s26, s16
    s_add_u32 s26, s26, 114688
    buffer_load_dwordx4 v232, s[56:59], s26 offen offset:0 lds
    buffer_load_dwordx4 v233, s[56:59], s26 offen offset:1024 lds
    buffer_load_dwordx4 v234, s[56:59], s26 offen offset:2048 lds
    buffer_load_dwordx4 v235, s[56:59], s26 offen offset:3072 lds
    s_add_u32 m0, s17, 0
    s_mul_i32 s26, s36, 229376
    s_add_u32 s26, s26, s16
    s_add_u32 s26, s26, 114688
    buffer_load_dwordx4 v232, s[56:59], s26 offen offset:0 lds
    buffer_load_dwordx4 v233, s[56:59], s26 offen offset:1024 lds
    buffer_load_dwordx4 v234, s[56:59], s26 offen offset:2048 lds
    buffer_load_dwordx4 v235, s[56:59], s26 offen offset:3072 lds
    s_waitcnt vmcnt(14)
    s_add_u32 s67, s72, 147456
    s_sub_u32 s67, s67, s17
    v_add_u32 v12, s67, v236
    v_add_u32 v13, s67, v237
    ds_read_b64_tr_b16 a[0:1], v12 offset:0
    ds_read_b64_tr_b16 a[2:3], v12 offset:1024
    ds_read_b64_tr_b16 a[4:5], v13 offset:0
    ds_read_b64_tr_b16 a[6:7], v13 offset:1024
    ds_read_b64_tr_b16 a[8:9], v12 offset:2048
    ds_read_b64_tr_b16 a[10:11], v12 offset:3072
    ds_read_b64_tr_b16 a[12:13], v13 offset:2048
    ds_read_b64_tr_b16 a[14:15], v13 offset:3072
    s_add_u32 s67, s72, 32768
    s_sub_u32 s67, s67, s17
    v_add_u32 v10, s67, v236
    v_add_u32 v11, s67, v237
    ds_read_b64_tr_b16 a[16:17], v10 offset:0
    ds_read_b64_tr_b16 a[18:19], v10 offset:1024
    ds_read_b64_tr_b16 a[20:21], v11 offset:0
    ds_read_b64_tr_b16 a[22:23], v11 offset:1024
    ds_read_b64_tr_b16 a[24:25], v10 offset:2048
    ds_read_b64_tr_b16 a[26:27], v10 offset:3072
    ds_read_b64_tr_b16 a[28:29], v11 offset:2048
    ds_read_b64_tr_b16 a[30:31], v11 offset:3072
    s_add_u32 s67, s72, 114688
    s_sub_u32 s67, s67, s17
    v_add_u32 v12, s67, v236
    v_add_u32 v13, s67, v237
    ds_read_b64_tr_b16 a[32:33], v12 offset:0
    ds_read_b64_tr_b16 a[34:35], v12 offset:1024
    ds_read_b64_tr_b16 a[36:37], v13 offset:0
    ds_read_b64_tr_b16 a[38:39], v13 offset:1024
    ds_read_b64_tr_b16 a[40:41], v12 offset:2048
    ds_read_b64_tr_b16 a[42:43], v12 offset:3072
    ds_read_b64_tr_b16 a[44:45], v13 offset:2048
    ds_read_b64_tr_b16 a[46:47], v13 offset:3072
    s_add_u32 s67, s72, 131072
    s_sub_u32 s67, s67, s17
    v_add_u32 v10, s67, v236
    v_add_u32 v11, s67, v237
    ds_read_b64_tr_b16 a[48:49], v10 offset:0
    ds_read_b64_tr_b16 a[50:51], v10 offset:1024
    ds_read_b64_tr_b16 a[52:53], v11 offset:0
    ds_read_b64_tr_b16 a[54:55], v11 offset:1024
    ds_read_b64_tr_b16 a[56:57], v10 offset:2048
    ds_read_b64_tr_b16 a[58:59], v10 offset:3072
    ds_read_b64_tr_b16 a[60:61], v11 offset:2048
    ds_read_b64_tr_b16 a[62:63], v11 offset:3072
    v_mov_b32 v15, 2130706432
    buffer_store_dword v15, v15, s[52:55], 0 offen
    buffer_store_dword v15, v15, s[52:55], 0 offen
    buffer_store_dword v15, v15, s[52:55], 0 offen
    buffer_store_dword v15, v15, s[52:55], 0 offen
    buffer_store_dword v15, v15, s[52:55], 0 offen
    buffer_store_dword v15, v15, s[52:55], 0 offen
    v_mov_b32 v240, v232
    v_mov_b32 v241, v233
    v_mov_b32 v242, v234
    v_mov_b32 v243, v235
    v_mov_b32 v4, v236
    v_mov_b32 v5, v237
L_p2:
    s_cmp_eq_u32 s97, 0
    s_cbranch_scc0 L_tile
L_pubonly:
    s_waitcnt vmcnt(0)
    s_sub_u32 s67, s66, 7
    s_cmp_lt_u32 s67, 6
    s_cbranch_scc1 pubk_13
    s_lshl_b32 s68, s65, 9
    s_lshl_b32 s69, s66, 4
    s_add_u32 s68, s68, s69
    s_lshl_b32 s69, s64, 2
    s_add_u32 s68, s68, s69
    s_add_u32 s68, s68, 9511168
    v_mov_b32 v14, s76
    v_mov_b32 v15, 0
    s_mov_b64 exec, 1
    buffer_store_dword v14, v15, s[52:55], s68 offen sc1
    s_mov_b64 exec, -1
    s_branch pubd_14
pubk_13:
    s_barrier
    s_mov_b32 s67, 2130706432
    s_cmp_eq_u32 s64, 0
    s_cselect_b32 s67, 128, s67
    v_mov_b32 v14, 1
    v_mov_b32 v15, s67
    s_mov_b64 exec, 1
    buffer_atomic_add v14, v15, s[8:11], 0 offen sc1
    s_mov_b64 exec, -1
pubd_14:
    s_branch L_end
L_tile:
    s_mov_b32 s44, s38
    s_mov_b32 s45, s39
    s_mov_b32 s46, 1835008
    s_mov_b32 s47, 0x00020000
    s_mov_b32 s12, s34
    s_mov_b32 s13, s35
    s_mov_b32 s14, 896
    s_mov_b32 s15, 0x00020000
    v_and_b32 v10, 31, v1
    v_lshlrev_b32 v11, 2, v10
    v_lshlrev_b32 v10, 1, v10
    s_lshl_b32 s67, s87, 7
    s_and_b32 s68, s64, 1
    s_lshl_b32 s68, s68, 6
    s_add_u32 s69, s67, s68
    s_xor_b32 s68, s68, 64
    s_add_u32 s70, s67, s68
    buffer_load_ushort v12, v10, s[12:15], s69 offen
    buffer_load_ushort v13, v10, s[12:15], s70 offen
    s_lshl_b32 s92, s64, 14
    s_add_u32 s92, s92, 9445376
    s_lshl_b32 s67, s86, 1
    s_add_u32 s67, s67, s71
    s_lshl_b32 s90, s67, 15
    s_lshl_b32 s93, s67, 7
    s_xor_b32 s67, s67, 1
    s_lshl_b32 s91, s67, 15
    s_lshl_b32 s94, s67, 7
    s_lshl_b32 s68, s64, 13
    s_add_u32 s68, s68, 7340032
    s_add_u32 s90, s90, s68
    s_add_u32 s91, s91, s68
    s_add_u32 s93, s93, 9437184
    s_add_u32 s94, s94, 9437184
    s_mul_i32 s80, s64, 100352
    s_lshl_b32 s67, s87, 7
    s_add_u32 s80, s80, s67
    s_waitcnt vmcnt(10)
    ds_read_b64_tr_b16 a[64:65], v4 offset:12288
    ds_read_b64_tr_b16 a[66:67], v4 offset:13312
    ds_read_b64_tr_b16 a[68:69], v5 offset:12288
    ds_read_b64_tr_b16 a[70:71], v5 offset:13312
    ds_read_b64_tr_b16 a[72:73], v4 offset:14336
    ds_read_b64_tr_b16 a[74:75], v4 offset:15360
    ds_read_b64_tr_b16 a[76:77], v5 offset:14336
    ds_read_b64_tr_b16 a[78:79], v5 offset:15360
    s_waitcnt vmcnt(6)
    ds_read_b64_tr_b16 a[80:81], v4 offset:0
    ds_read_b64_tr_b16 a[82:83], v4 offset:1024
    ds_read_b64_tr_b16 a[84:85], v5 offset:0
    ds_read_b64_tr_b16 a[86:87], v5 offset:1024
    ds_read_b64_tr_b16 a[88:89], v4 offset:2048
    ds_read_b64_tr_b16 a[90:91], v4 offset:3072
    ds_read_b64_tr_b16 a[92:93], v5 offset:2048
    ds_read_b64_tr_b16 a[94:95], v5 offset:3072
    s_add_u32 m0, s17, 4096
    s_mul_i32 s100, s37, 229376
    s_add_u32 s100, s100, s16
    s_add_u32 s100, s100, 114688
    buffer_load_dwordx4 v240, s[56:59], s100 offen offset:0 lds
    buffer_load_dwordx4 v241, s[56:59], s100 offen offset:1024 lds
    buffer_load_dwordx4 v242, s[56:59], s100 offen offset:2048 lds
    buffer_load_dwordx4 v243, s[56:59], s100 offen offset:3072 lds
    s_waitcnt vmcnt(22)
    s_lshr_b32 s68, s86, 1
    s_lshl_b32 s68, s68, 9
    s_add_u32 s68, s68, 9510912
    buffer_load_dword v3, v2, s[52:55], s68 offen sc1
    s_waitcnt vmcnt(7)
    s_sub_u32 s67, s66, 7
    s_cmp_lt_u32 s67, 6
    s_cbranch_scc1 pubk_15
    s_lshl_b32 s68, s65, 9
    s_lshl_b32 s69, s66, 4
    s_add_u32 s68, s68, s69
    s_lshl_b32 s69, s64, 2
    s_add_u32 s68, s68, s69
    s_add_u32 s68, s68, 9511168
    v_mov_b32 v14, s76
    v_mov_b32 v15, 0
    s_mov_b64 exec, 1
    buffer_store_dword v14, v15, s[52:55], s68 offen sc1
    s_mov_b64 exec, -1
    s_branch pubd_16
pubk_15:
    s_barrier
    s_mov_b32 s67, 2130706432
    s_cmp_eq_u32 s64, 0
    s_cselect_b32 s67, 128, s67
    v_mov_b32 v14, 1
    v_mov_b32 v15, s67
    s_mov_b64 exec, 1
    buffer_atomic_add v14, v15, s[8:11], 0 offen sc1
    s_mov_b64 exec, -1
pubd_16:
    s_waitcnt vmcnt(1)
    s_and_b32 s68, s86, 1
    s_cmp_eq_u32 s68, 0
    s_mov_b32 s6, 0xccccccc
    s_cselect_b32 s6, 0x3333333, s6
    s_mov_b32 s7, 0
    v_cmp_ne_u32 vcc, s76, v3
    s_nop 1
    s_and_b64 vcc, vcc, s[6:7]
    s_nop 1
    s_cbranch_vccz f0_ok_17
    s_lshr_b32 s67, s86, 1
    s_lshl_b32 s67, s67, 9
    s_add_u32 s67, s67, 9510912
    s_mov_b32 s96, 0x8000
f0_18:
    buffer_load_dword v3, v2, s[52:55], s67 offen sc1
    s_waitcnt vmcnt(0)
    v_cmp_ne_u32 vcc, s76, v3
    s_nop 1
    s_and_b64 vcc, vcc, s[6:7]
    s_nop 1
    s_cbranch_vccz f0_done_19
    s_sleep 2
    s_sub_u32 s96, s96, 1
    s_cbranch_scc0 f0_18
f0_done_19:
f0_ok_17:
    v_mov_b32 v148, 0x3f80
    v_cndmask_b32 v148, v148, 0, s[84:85]
    v_mov_b32 v149, 0
    v_mov_b32 v145, 0
    v_mov_b32 v150, 0
    v_mov_b32 v146, 0
    v_mov_b32 v151, 0
    v_mov_b32 v147, 0
    s_cmp_eq_u32 s64, 0
    s_cselect_b32 s68, 0xffff, 0
    v_and_b32 v144, s68, v12
    s_nop 1
    v_mfma_f32_32x32x16_bf16 v[16:31], v[144:147], v[148:151], 0
    v_mfma_f32_32x32x16_bf16 v[32:47], v[144:147], v[148:151], 0
    v_and_b32 v144, s68, v13
    s_nop 1
    v_mfma_f32_32x32x16_bf16 v[48:63], v[144:147], v[148:151], 0
    v_mfma_f32_32x32x16_bf16 v[64:79], v[144:147], v[148:151], 0
    s_lshl_b32 s101, s29, 14
    s_add_u32 s67, s101, s18
    buffer_load_dwordx4 v[80:83], v9, s[52:55], s67 offen offset:0 sc1
    s_add_u32 s67, s101, s27
    buffer_load_dwordx4 v[84:87], v9, s[52:55], s67 offen offset:0 sc1
    s_add_u32 s67, s101, s18
    buffer_load_dwordx4 v[88:91], v9, s[52:55], s67 offen offset:1024 sc1
    s_add_u32 s67, s101, s27
    buffer_load_dwordx4 v[92:95], v9, s[52:55], s67 offen offset:1024 sc1
    s_lshl_b32 s101, s30, 14
    s_add_u32 s67, s101, s18
    buffer_load_dwordx4 v[96:99], v9, s[52:55], s67 offen offset:0 sc1
    s_add_u32 s67, s101, s27
    buffer_load_dwordx4 v[100:103], v9, s[52:55], s67 offen offset:0 sc1
    s_add_u32 s67, s101, s18
    buffer_load_dwordx4 v[104:107], v9, s[52:55], s67 offen offset:1024 sc1
    s_add_u32 s67, s101, s27
    buffer_load_dwordx4 v[108:111], v9, s[52:55], s67 offen offset:1024 sc1
    s_lshl_b32 s101, s31, 14
    s_add_u32 s67, s101, s18
    buffer_load_dwordx4 v[112:115], v9, s[52:55], s67 offen offset:0 sc1
    s_add_u32 s67, s101, s27
    buffer_load_dwordx4 v[116:119], v9, s[52:55], s67 offen offset:0 sc1
    s_add_u32 s67, s101, s18
    buffer_load_dwordx4 v[120:123], v9, s[52:55], s67 offen offset:1024 sc1
    s_waitcnt vmcnt(9)
    v_mfma_f32_32x32x16_bf16 v[16:31], a[112:115], v[80:83], v[16:31]
    s_add_u32 s67, s101, s27
    buffer_load_dwordx4 v[124:127], v9, s[52:55], s67 offen offset:1024 sc1
    v_mfma_f32_32x32x16_bf16 v[32:47], a[112:115], v[84:87], v[32:47]
    v_mfma_f32_32x32x16_bf16 v[48:63], a[116:119], v[80:83], v[48:63]
    s_lshl_b32 s101, s32, 14
    s_add_u32 s67, s101, s18
    buffer_load_dwordx4 v[128:131], v9, s[52:55], s67 offen offset:0 sc1
    v_mfma_f32_32x32x16_bf16 v[64:79], a[116:119], v[84:87], v[64:79]
    s_waitcnt vmcnt(9)
    v_mfma_f32_32x32x16_bf16 v[16:31], a[120:123], v[88:91], v[16:31]
    s_add_u32 s67, s101, s27
    buffer_load_dwordx4 v[132:135], v9, s[52:55], s67 offen offset:0 sc1
    v_mfma_f32_32x32x16_bf16 v[32:47], a[120:123], v[92:95], v[32:47]
    v_mfma_f32_32x32x16_bf16 v[48:63], a[124:127], v[88:91], v[48:63]
    v_mfma_f32_32x32x16_bf16 v[64:79], a[124:127], v[92:95], v[64:79]
    s_add_u32 s67, s101, s18
    buffer_load_dwordx4 v[136:139], v9, s[52:55], s67 offen offset:1024 sc1
    ds_read_b64_tr_b16 a[96:97], v4 offset:4096
    ds_read_b64_tr_b16 a[98:99], v4 offset:5120
    ds_read_b64_tr_b16 a[100:101], v5 offset:4096
    ds_read_b64_tr_b16 a[102:103], v5 offset:5120
    ds_read_b64_tr_b16 a[104:105], v4 offset:6144
    ds_read_b64_tr_b16 a[106:107], v4 offset:7168
    ds_read_b64_tr_b16 a[108:109], v5 offset:6144
    ds_read_b64_tr_b16 a[110:111], v5 offset:7168
    s_add_u32 s67, s101, s27
    buffer_load_dwordx4 v[140:143], v9, s[52:55], s67 offen offset:1024 sc1
    s_waitcnt vmcnt(10)
    v_mfma_f32_32x32x16_bf16 v[16:31], a[128:131], v[96:99], v[16:31]
    v_mfma_f32_32x32x16_bf16 v[32:47], a[128:131], v[100:103], v[32:47]
    v_mfma_f32_32x32x16_bf16 v[48:63], a[132:135], v[96:99], v[48:63]
    s_lshl_b32 s101, s33, 14
    s_add_u32 s67, s101, s18
    buffer_load_dwordx4 a[224:227], v9, s[52:55], s67 offen offset:0 sc1
    v_mfma_f32_32x32x16_bf16 v[64:79], a[132:135], v[100:103], v[64:79]
    s_waitcnt vmcnt(9)
    v_mfma_f32_32x32x16_bf16 v[16:31], a[136:139], v[104:107], v[16:31]
    s_add_u32 s67, s101, s27
    buffer_load_dwordx4 a[228:231], v9, s[52:55], s67 offen offset:0 sc1
    v_mfma_f32_32x32x16_bf16 v[32:47], a[136:139], v[108:111], v[32:47]
    v_mfma_f32_32x32x16_bf16 v[48:63], a[140:143], v[104:107], v[48:63]
    s_add_u32 s67, s101, s18
    buffer_load_dwordx4 a[232:235], v9, s[52:55], s67 offen offset:1024 sc1
    v_mfma_f32_32x32x16_bf16 v[64:79], a[140:143], v[108:111], v[64:79]
    s_waitcnt vmcnt(9)
    v_mfma_f32_32x32x16_bf16 v[16:31], a[144:147], v[112:115], v[16:31]
    s_add_u32 s67, s101, s27
    buffer_load_dwordx4 a[236:239], v9, s[52:55], s67 offen offset:1024 sc1
    v_mfma_f32_32x32x16_bf16 v[32:47], a[144:147], v[116:119], v[32:47]
    v_mfma_f32_32x32x16_bf16 v[48:63], a[148:151], v[112:115], v[48:63]
    s_lshl_b32 s101, s36, 14
    s_add_u32 s67, s101, s18
    buffer_load_dwordx4 a[240:243], v9, s[52:55], s67 offen offset:0 sc1
    v_mfma_f32_32x32x16_bf16 v[64:79], a[148:151], v[116:119], v[64:79]
    s_waitcnt vmcnt(9)
    v_mfma_f32_32x32x16_bf16 v[16:31], a[152:155], v[120:123], v[16:31]
    s_add_u32 s67, s101, s27
    buffer_load_dwordx4 a[244:247], v9, s[52:55], s67 offen offset:0 sc1
    v_mfma_f32_32x32x16_bf16 v[32:47], a[152:155], v[124:127], v[32:47]
    v_mfma_f32_32x32x16_bf16 v[48:63], a[156:159], v[120:123], v[48:63]
    s_add_u32 s67, s101, s18
    buffer_load_dwordx4 a[248:251], v9, s[52:55], s67 offen offset:1024 sc1
    v_mfma_f32_32x32x16_bf16 v[64:79], a[156:159], v[124:127], v[64:79]
    s_waitcnt vmcnt(9)
    v_mfma_f32_32x32x16_bf16 v[16:31], a[160:163], v[128:131], v[16:31]
    s_add_u32 s67, s101, s27
    buffer_load_dwordx4 a[252:255], v9, s[52:55], s67 offen offset:1024 sc1
    v_mfma_f32_32x32x16_bf16 v[32:47], a[160:163], v[132:135], v[32:47]
    v_mfma_f32_32x32x16_bf16 v[48:63], a[164:167], v[128:131], v[48:63]
    v_mfma_f32_32x32x16_bf16 v[64:79], a[164:167], v[132:135], v[64:79]
    s_lshl_b32 s101, s37, 14
    s_add_u32 s67, s101, s18
    buffer_load_dwordx4 v[80:83], v9, s[52:55], s67 offen offset:0 sc1
    s_waitcnt vmcnt(9)
    v_mfma_f32_32x32x16_bf16 v[16:31], a[168:171], v[136:139], v[16:31]
    v_mfma_f32_32x32x16_bf16 v[32:47], a[168:171], v[140:143], v[32:47]
    s_add_u32 s67, s101, s27
    buffer_load_dwordx4 v[84:87], v9, s[52:55], s67 offen offset:0 sc1
    v_mfma_f32_32x32x16_bf16 v[48:63], a[172:175], v[136:139], v[48:63]
    v_mfma_f32_32x32x16_bf16 v[64:79], a[172:175], v[140:143], v[64:79]
    s_add_u32 s67, s101, s18
    buffer_load_dwordx4 v[88:91], v9, s[52:55], s67 offen offset:1024 sc1
    s_waitcnt vmcnt(9)
    v_mfma_f32_32x32x16_bf16 v[16:31], a[176:179], a[224:227], v[16:31]
    v_mfma_f32_32x32x16_bf16 v[32:47], a[176:179], a[228:231], v[32:47]
    s_add_u32 s67, s101, s27
    buffer_load_dwordx4 v[92:95], v9, s[52:55], s67 offen offset:1024 sc1
    v_mfma_f32_32x32x16_bf16 v[48:63], a[180:183], a[224:227], v[48:63]
    v_mfma_f32_32x32x16_bf16 v[64:79], a[180:183], a[228:231], v[64:79]
    s_lshr_b32 s68, s86, 1
    s_lshl_b32 s68, s68, 9
    s_add_u32 s68, s68, 9511168
    buffer_load_dword v3, v2, s[52:55], s68 offen sc1
    s_waitcnt vmcnt(9)
    v_mfma_f32_32x32x16_bf16 v[16:31], a[184:187], a[232:235], v[16:31]
    v_mfma_f32_32x32x16_bf16 v[32:47], a[184:187], a[236:239], v[32:47]
    s_waitcnt lgkmcnt(0)
    s_add_u32 m0, s17, 0
    s_add_u32 s100, s80, 0
    buffer_load_dwordx4 v240, s[60:63], s100 offen offset:0 lds
    v_mfma_f32_32x32x16_bf16 v[48:63], a[188:191], a[232:235], v[48:63]
    v_mfma_f32_32x32x16_bf16 v[64:79], a[188:191], a[236:239], v[64:79]
    buffer_load_dwordx4 v241, s[60:63], s100 offen offset:1024 lds
    s_waitcnt vmcnt(9)
    v_mfma_f32_32x32x16_bf16 v[16:31], a[192:195], a[240:243], v[16:31]
    v_mfma_f32_32x32x16_bf16 v[32:47], a[192:195], a[244:247], v[32:47]
    buffer_load_dwordx4 v242, s[60:63], s100 offen offset:2048 lds
    v_mfma_f32_32x32x16_bf16 v[48:63], a[196:199], a[240:243], v[48:63]
    v_mfma_f32_32x32x16_bf16 v[64:79], a[196:199], a[244:247], v[64:79]
    buffer_load_dwordx4 v243, s[60:63], s100 offen offset:3072 lds
    s_waitcnt vmcnt(9)
    v_mfma_f32_32x32x16_bf16 v[16:31], a[200:203], a[248:251], v[16:31]
    s_add_u32 m0, s17, 4096
    s_add_u32 s100, s80, 28672
    buffer_load_dwordx4 v240, s[60:63], s100 offen offset:0 lds
    v_mfma_f32_32x32x16_bf16 v[32:47], a[200:203], a[252:255], v[32:47]
    v_mfma_f32_32x32x16_bf16 v[48:63], a[204:207], a[248:251], v[48:63]
    buffer_load_dwordx4 v241, s[60:63], s100 offen offset:1024 lds
    v_mfma_f32_32x32x16_bf16 v[64:79], a[204:207], a[252:255], v[64:79]
    s_waitcnt vmcnt(9)
    v_mfma_f32_32x32x16_bf16 v[16:31], a[208:211], v[80:83], v[16:31]
    buffer_load_dwordx4 v242, s[60:63], s100 offen offset:2048 lds
    v_mfma_f32_32x32x16_bf16 v[32:47], a[208:211], v[84:87], v[32:47]
    v_mfma_f32_32x32x16_bf16 v[48:63], a[212:215], v[80:83], v[48:63]
    buffer_load_dwordx4 v243, s[60:63], s100 offen offset:3072 lds
    v_mfma_f32_32x32x16_bf16 v[64:79], a[212:215], v[84:87], v[64:79]
    s_waitcnt vmcnt(9)
    v_mfma_f32_32x32x16_bf16 v[16:31], a[216:219], v[88:91], v[16:31]
    s_add_u32 m0, s17, 8192
    s_add_u32 s100, s80, 57344
    buffer_load_dwordx4 v240, s[60:63], s100 offen offset:0 lds
    v_mfma_f32_32x32x16_bf16 v[32:47], a[216:219], v[92:95], v[32:47]
    v_mfma_f32_32x32x16_bf16 v[48:63], a[220:223], v[88:91], v[48:63]
    buffer_load_dwordx4 v241, s[60:63], s100 offen offset:1024 lds
    v_mfma_f32_32x32x16_bf16 v[64:79], a[220:223], v[92:95], v[64:79]
    buffer_load_dwordx4 v242, s[60:63], s100 offen offset:2048 lds
    buffer_load_dwordx4 v243, s[60:63], s100 offen offset:3072 lds
    s_add_u32 m0, s17, 12288
    s_add_u32 s100, s80, 86016
    buffer_load_dwordx4 v240, s[60:63], s100 offen offset:0 lds
    buffer_load_dwordx4 v241, s[60:63], s100 offen offset:1024 lds
    buffer_load_dwordx4 v242, s[60:63], s100 offen offset:2048 lds
    s_waitcnt vmcnt(15)
    s_and_b32 s68, s86, 1
    s_cmp_eq_u32 s68, 0
    s_mov_b32 s6, 0xccccccc
    s_cselect_b32 s6, 0x3333333, s6
    s_mov_b32 s7, 0
    v_cmp_ne_u32 vcc, s76, v3
    s_nop 1
    s_and_b64 vcc, vcc, s[6:7]
    s_nop 1
    s_cbranch_vccz f1_ok_20
    s_lshr_b32 s67, s86, 1
    s_lshl_b32 s67, s67, 9
    s_add_u32 s67, s67, 9511168
    s_mov_b32 s96, 0x8000
f1_21:
    buffer_load_dword v3, v2, s[52:55], s67 offen sc1
    s_waitcnt vmcnt(0)
    v_cmp_ne_u32 vcc, s76, v3
    s_nop 1
    s_and_b64 vcc, vcc, s[6:7]
    s_nop 1
    s_cbranch_vccz f1_done_22
    s_sleep 2
    s_sub_u32 s96, s96, 1
    s_cbranch_scc0 f1_21
f1_done_22:
f1_ok_20:
    s_lshl_b32 s101, s29, 14
    s_add_u32 s101, s101, 8192
    s_add_u32 s67, s101, s18
    buffer_load_dwordx4 a[112:115], v9, s[52:55], s67 offen offset:0 sc1
    s_add_u32 s67, s101, s27
    buffer_load_dwordx4 a[116:119], v9, s[52:55], s67 offen offset:0 sc1
    s_add_u32 s67, s101, s18
    buffer_load_dwordx4 a[120:123], v9, s[52:55], s67 offen offset:1024 sc1
    s_add_u32 s67, s101, s27
    buffer_load_dwordx4 a[124:127], v9, s[52:55], s67 offen offset:1024 sc1
    s_lshl_b32 s101, s30, 14
    s_add_u32 s101, s101, 8192
    s_add_u32 s67, s101, s18
    buffer_load_dwordx4 a[128:131], v9, s[52:55], s67 offen offset:0 sc1
    s_add_u32 s67, s101, s27
    buffer_load_dwordx4 a[132:135], v9, s[52:55], s67 offen offset:0 sc1
    s_add_u32 s67, s101, s18
    buffer_load_dwordx4 a[136:139], v9, s[52:55], s67 offen offset:1024 sc1
    s_add_u32 s67, s101, s27
    buffer_load_dwordx4 a[140:143], v9, s[52:55], s67 offen offset:1024 sc1
    s_lshl_b32 s101, s31, 14
    s_add_u32 s101, s101, 8192
    s_add_u32 s67, s101, s18
    buffer_load_dwordx4 a[144:147], v9, s[52:55], s67 offen offset:0 sc1
    s_add_u32 s67, s101, s27
    buffer_load_dwordx4 a[148:151], v9, s[52:55], s67 offen offset:0 sc1
    s_add_u32 s67, s101, s18
    buffer_load_dwordx4 a[152:155], v9, s[52:55], s67 offen offset:1024 sc1
    s_waitcnt vmcnt(9)
    v_mfma_f32_32x32x16_bf16 v[16:31], a[0:3], a[112:115], v[16:31]
    s_add_u32 s67, s101, s27
    buffer_load_dwordx4 a[156:159], v9, s[52:55], s67 offen offset:1024 sc1
    v_mfma_f32_32x32x16_bf16 v[32:47], a[0:3], a[116:119], v[32:47]
    v_mfma_f32_32x32x16_bf16 v[48:63], a[4:7], a[112:115], v[48:63]
    s_lshl_b32 s101, s32, 14
    s_add_u32 s101, s101, 8192
    s_add_u32 s67, s101, s18
    buffer_load_dwordx4 a[160:163], v9, s[52:55], s67 offen offset:0 sc1
    v_mfma_f32_32x32x16_bf16 v[64:79], a[4:7], a[116:119], v[64:79]
    s_waitcnt vmcnt(9)
    v_mfma_f32_32x32x16_bf16 v[16:31], a[8:11], a[120:123], v[16:31]
    v_mfma_f32_32x32x16_bf16 v[32:47], a[8:11], a[124:127], v[32:47]
    s_add_u32 s67, s101, s27
    buffer_load_dwordx4 a[164:167], v9, s[52:55], s67 offen offset:0 sc1
    v_mfma_f32_32x32x16_bf16 v[48:63], a[12:15], a[120:123], v[48:63]
    v_mfma_f32_32x32x16_bf16 v[64:79], a[12:15], a[124:127], v[64:79]
    s_add_u32 s67, s101, s18
    buffer_load_dwordx4 a[168:171], v9, s[52:55], s67 offen offset:1024 sc1
    s_waitcnt vmcnt(9)
    v_mfma_f32_32x32x16_bf16 v[16:31], a[16:19], a[128:131], v[16:31]
    v_mfma_f32_32x32x16_bf16 v[32:47], a[16:19], a[132:135], v[32:47]
    s_add_u32 s67, s101, s27
    buffer_load_dwordx4 a[172:175], v9, s[52:55], s67 offen offset:1024 sc1
    v_mfma_f32_32x32x16_bf16 v[48:63], a[20:23], a[128:131], v[48:63]
    v_mfma_f32_32x32x16_bf16 v[64:79], a[20:23], a[132:135], v[64:79]
    s_lshl_b32 s101, s33, 14
    s_add_u32 s101, s101, 8192
    s_add_u32 s67, s101, s18
    buffer_load_dwordx4 a[176:179], v9, s[52:55], s67 offen offset:0 sc1
    s_waitcnt vmcnt(9)
    v_mfma_f32_32x32x16_bf16 v[16:31], a[24:27], a[136:139], v[16:31]
    v_mfma_f32_32x32x16_bf16 v[32:47], a[24:27], a[140:143], v[32:47]
    s_add_u32 s67, s101, s27
    buffer_load_dwordx4 a[180:183], v9, s[52:55], s67 offen offset:0 sc1
    v_mfma_f32_32x32x16_bf16 v[48:63], a[28:31], a[136:139], v[48:63]
    v_mfma_f32_32x32x16_bf16 v[64:79], a[28:31], a[140:143], v[64:79]
    s_lshr_b32 s68, s86, 1
    s_lshl_b32 s68, s68, 9
    s_add_u32 s68, s68, 9511168
    buffer_load_dword v3, v2, s[52:55], s68 offen sc1
    v_mov_b32 v8, 128
    buffer_load_dword v8, v8, s[8:11], 0 offen sc1
    s_waitcnt vmcnt(10)
    v_mfma_f32_32x32x16_bf16 v[16:31], a[32:35], a[144:147], v[16:31]
    v_mfma_f32_32x32x16_bf16 v[32:47], a[32:35], a[148:151], v[32:47]
    s_add_u32 s67, s101, s18
    buffer_load_dwordx4 a[184:187], v9, s[52:55], s67 offen offset:1024 sc1
    v_mfma_f32_32x32x16_bf16 v[48:63], a[36:39], a[144:147], v[48:63]
    v_mfma_f32_32x32x16_bf16 v[64:79], a[36:39], a[148:151], v[64:79]
    s_add_u32 s67, s101, s27
    buffer_load_dwordx4 a[188:191], v9, s[52:55], s67 offen offset:1024 sc1
    s_waitcnt vmcnt(10)
    v_mfma_f32_32x32x16_bf16 v[16:31], a[40:43], a[152:155], v[16:31]
    v_mfma_f32_32x32x16_bf16 v[32:47], a[40:43], a[156:159], v[32:47]
    v_mfma_f32_32x32x16_bf16 v[48:63], a[44:47], a[152:155], v[48:63]
    s_lshl_b32 s101, s36, 14
    s_add_u32 s101, s101, 8192
    s_add_u32 s67, s101, s18
    buffer_load_dwordx4 a[192:195], v9, s[52:55], s67 offen offset:0 sc1
    v_mfma_f32_32x32x16_bf16 v[64:79], a[44:47], a[156:159], v[64:79]
    s_add_u32 s67, s101, s27
    buffer_load_dwordx4 a[196:199], v9, s[52:55], s67 offen offset:0 sc1
    s_waitcnt vmcnt(10)
    v_mfma_f32_32x32x16_bf16 v[16:31], a[48:51], a[160:163], v[16:31]
    s_add_u32 s67, s101, s18
    buffer_load_dwordx4 a[200:203], v9, s[52:55], s67 offen offset:1024 sc1
    v_mfma_f32_32x32x16_bf16 v[32:47], a[48:51], a[164:167], v[32:47]
    v_mfma_f32_32x32x16_bf16 v[48:63], a[52:55], a[160:163], v[48:63]
    s_add_u32 s67, s101, s27
    buffer_load_dwordx4 a[204:207], v9, s[52:55], s67 offen offset:1024 sc1
    v_mfma_f32_32x32x16_bf16 v[64:79], a[52:55], a[164:167], v[64:79]
    s_waitcnt vmcnt(10)
    v_mfma_f32_32x32x16_bf16 v[16:31], a[56:59], a[168:171], v[16:31]
    s_lshl_b32 s101, s37, 14
    s_add_u32 s101, s101, 8192
    s_add_u32 s67, s101, s18
    buffer_load_dwordx4 a[208:211], v9, s[52:55], s67 offen offset:0 sc1
    v_mfma_f32_32x32x16_bf16 v[32:47], a[56:59], a[172:175], v[32:47]
    v_mfma_f32_32x32x16_bf16 v[48:63], a[60:63], a[168:171], v[48:63]
    s_add_u32 s67, s101, s27
    buffer_load_dwordx4 a[212:215], v9, s[52:55], s67 offen offset:0 sc1
    v_mfma_f32_32x32x16_bf16 v[64:79], a[60:63], a[172:175], v[64:79]
    s_waitcnt lgkmcnt(15)
    s_waitcnt vmcnt(10)
    v_mfma_f32_32x32x16_bf16 v[16:31], a[64:67], a[176:179], v[16:31]
    s_add_u32 s67, s101, s18
    buffer_load_dwordx4 a[216:219], v9, s[52:55], s67 offen offset:1024 sc1
    v_mfma_f32_32x32x16_bf16 v[32:47], a[64:67], a[180:183], v[32:47]
    v_mfma_f32_32x32x16_bf16 v[48:63], a[68:71], a[176:179], v[48:63]
    s_add_u32 s67, s101, s27
    buffer_load_dwordx4 a[220:223], v9, s[52:55], s67 offen offset:1024 sc1
    v_mfma_f32_32x32x16_bf16 v[64:79], a[68:71], a[180:183], v[64:79]
    s_waitcnt vmcnt(10)
    s_and_b32 s68, s86, 1
    s_cmp_eq_u32 s68, 0
    s_mov_b32 s6, 0
    s_mov_b32 s7, 0xccc00000
    s_cselect_b32 s7, 0x33300000, s7
    v_cmp_ne_u32 vcc, s76, v3
    s_nop 1
    s_and_b64 vcc, vcc, s[6:7]
    s_nop 1
    s_cbranch_vccz fq_ok_23
    s_lshr_b32 s67, s86, 1
    s_lshl_b32 s67, s67, 9
    s_add_u32 s67, s67, 9511168
    s_mov_b32 s96, 0x8000
fq_24:
    buffer_load_dword v3, v2, s[52:55], s67 offen sc1
    s_waitcnt vmcnt(0)
    v_cmp_ne_u32 vcc, s76, v3
    s_nop 1
    s_and_b64 vcc, vcc, s[6:7]
    s_nop 1
    s_cbranch_vccz fq_done_25
    s_sleep 2
    s_sub_u32 s96, s96, 1
    s_cbranch_scc0 fq_24
fq_done_25:
fq_ok_23:
    v_readfirstlane_b32 s69, v8
    s_nop 1
    s_cmp_ge_u32 s69, 96
    s_cbranch_scc1 kc_ok_26
    v_mov_b32 v15, 128
    s_mov_b32 s96, 0x8000
kc_27:
    buffer_load_dword v8, v15, s[8:11], 0 offen sc1
    s_waitcnt vmcnt(0)
    v_readfirstlane_b32 s69, v8
    s_nop 1
    s_cmp_ge_u32 s69, 96
    s_cbranch_scc1 kc_done_28
    s_sleep 2
    s_sub_u32 s96, s96, 1
    s_cbranch_scc0 kc_27
kc_done_28:
kc_ok_26:
    s_waitcnt vmcnt(8)
    v_mfma_f32_32x32x16_bf16 v[16:31], a[72:75], a[184:187], v[16:31]
    buffer_load_dword v6, v11, s[52:55], s93 offen sc1
    v_mfma_f32_32x32x16_bf16 v[32:47], a[72:75], a[188:191], v[32:47]
    v_mfma_f32_32x32x16_bf16 v[48:63], a[76:79], a[184:187], v[48:63]
    v_mfma_f32_32x32x16_bf16 v[64:79], a[76:79], a[188:191], v[64:79]
    buffer_load_dword v7, v11, s[52:55], s94 offen sc1
    s_waitcnt lgkmcnt(8)
    s_waitcnt vmcnt(8)
    v_mfma_f32_32x32x16_bf16 v[16:31], a[80:83], a[192:195], v[16:31]
    v_mfma_f32_32x32x16_bf16 v[32:47], a[80:83], a[196:199], v[32:47]
    s_add_u32 s101, s92, 0
    buffer_load_dwordx4 v[112:115], v9, s[52:55], s101 offen offset:0 sc1
    v_mfma_f32_32x32x16_bf16 v[48:63], a[84:87], a[192:195], v[48:63]
    v_mfma_f32_32x32x16_bf16 v[64:79], a[84:87], a[196:199], v[64:79]
    buffer_load_dwordx4 v[116:119], v9, s[52:55], s101 offen offset:1024 sc1
    s_waitcnt vmcnt(8)
    v_mfma_f32_32x32x16_bf16 v[16:31], a[88:91], a[200:203], v[16:31]
    v_mfma_f32_32x32x16_bf16 v[32:47], a[88:91], a[204:207], v[32:47]
    buffer_load_dwordx4 v[120:123], v9, s[52:55], s101 offen offset:2048 sc1
    v_mfma_f32_32x32x16_bf16 v[48:63], a[92:95], a[200:203], v[48:63]
    v_mfma_f32_32x32x16_bf16 v[64:79], a[92:95], a[204:207], v[64:79]
    buffer_load_dwordx4 v[124:127], v9, s[52:55], s101 offen offset:3072 sc1
    s_waitcnt lgkmcnt(0)
    s_waitcnt vmcnt(8)
    v_mfma_f32_32x32x16_bf16 v[16:31], a[96:99], a[208:211], v[16:31]
    v_mfma_f32_32x32x16_bf16 v[32:47], a[96:99], a[212:215], v[32:47]
    s_add_u32 s100, s90, 0
    buffer_load_dwordx4 v[176:179], v9, s[52:55], s100 offen offset:0 sc1
    v_mfma_f32_32x32x16_bf16 v[48:63], a[100:103], a[208:211], v[48:63]
    v_mfma_f32_32x32x16_bf16 v[64:79], a[100:103], a[212:215], v[64:79]
    buffer_load_dwordx4 v[180:183], v9, s[52:55], s100 offen offset:1024 sc1
    s_waitcnt vmcnt(8)
    v_mfma_f32_32x32x16_bf16 v[16:31], a[104:107], a[216:219], v[16:31]
    v_mfma_f32_32x32x16_bf16 v[32:47], a[104:107], a[220:223], v[32:47]
    s_add_u32 s100, s91, 0
    buffer_load_dwordx4 v[184:187], v9, s[52:55], s100 offen offset:0 sc1
    v_mfma_f32_32x32x16_bf16 v[48:63], a[108:111], a[216:219], v[48:63]
    v_mfma_f32_32x32x16_bf16 v[64:79], a[108:111], a[220:223], v[64:79]
    buffer_load_dwordx4 v[188:191], v9, s[52:55], s100 offen offset:1024 sc1
    s_add_u32 s101, s92, 4096
    buffer_load_dwordx4 v[128:131], v9, s[52:55], s101 offen offset:0 sc1
    s_waitcnt vmcnt(9)
    v_sub_f32 v14, 1.0, v6
    v_sub_f32 v15, 1.0, v7
    s_nop 0
    v_pk_mul_f32 v[16:17], v[16:17], v[14:15] op_sel_hi:[1,0]
    v_pk_mul_f32 v[18:19], v[18:19], v[14:15] op_sel_hi:[1,0]
    v_pk_mul_f32 v[20:21], v[20:21], v[14:15] op_sel_hi:[1,0]
    v_pk_mul_f32 v[22:23], v[22:23], v[14:15] op_sel_hi:[1,0]
    v_pk_mul_f32 v[24:25], v[24:25], v[14:15] op_sel_hi:[1,0]
    v_pk_mul_f32 v[26:27], v[26:27], v[14:15] op_sel_hi:[1,0]
    v_pk_mul_f32 v[28:29], v[28:29], v[14:15] op_sel_hi:[1,0]
    v_pk_mul_f32 v[30:31], v[30:31], v[14:15] op_sel_hi:[1,0]
    v_pk_mul_f32 v[32:33], v[32:33], v[14:15] op_sel:[0,1] op_sel_hi:[1,1]
    v_pk_mul_f32 v[34:35], v[34:35], v[14:15] op_sel:[0,1] op_sel_hi:[1,1]
    v_pk_mul_f32 v[36:37], v[36:37], v[14:15] op_sel:[0,1] op_sel_hi:[1,1]
    v_pk_mul_f32 v[38:39], v[38:39], v[14:15] op_sel:[0,1] op_sel_hi:[1,1]
    v_pk_mul_f32 v[40:41], v[40:41], v[14:15] op_sel:[0,1] op_sel_hi:[1,1]
    v_pk_mul_f32 v[42:43], v[42:43], v[14:15] op_sel:[0,1] op_sel_hi:[1,1]
    v_pk_mul_f32 v[44:45], v[44:45], v[14:15] op_sel:[0,1] op_sel_hi:[1,1]
    v_pk_mul_f32 v[46:47], v[46:47], v[14:15] op_sel:[0,1] op_sel_hi:[1,1]
    v_pk_mul_f32 v[48:49], v[48:49], v[14:15] op_sel_hi:[1,0]
    v_pk_mul_f32 v[50:51], v[50:51], v[14:15] op_sel_hi:[1,0]
    v_pk_mul_f32 v[52:53], v[52:53], v[14:15] op_sel_hi:[1,0]
    v_pk_mul_f32 v[54:55], v[54:55], v[14:15] op_sel_hi:[1,0]
    v_pk_mul_f32 v[56:57], v[56:57], v[14:15] op_sel_hi:[1,0]
    v_pk_mul_f32 v[58:59], v[58:59], v[14:15] op_sel_hi:[1,0]
    v_pk_mul_f32 v[60:61], v[60:61], v[14:15] op_sel_hi:[1,0]
    v_pk_mul_f32 v[62:63], v[62:63], v[14:15] op_sel_hi:[1,0]
    v_pk_mul_f32 v[64:65], v[64:65], v[14:15] op_sel:[0,1] op_sel_hi:[1,1]
    v_pk_mul_f32 v[66:67], v[66:67], v[14:15] op_sel:[0,1] op_sel_hi:[1,1]
    v_pk_mul_f32 v[68:69], v[68:69], v[14:15] op_sel:[0,1] op_sel_hi:[1,1]
    v_pk_mul_f32 v[70:71], v[70:71], v[14:15] op_sel:[0,1] op_sel_hi:[1,1]
    v_pk_mul_f32 v[72:73], v[72:73], v[14:15] op_sel:[0,1] op_sel_hi:[1,1]
    v_pk_mul_f32 v[74:75], v[74:75], v[14:15] op_sel:[0,1] op_sel_hi:[1,1]
    v_pk_mul_f32 v[76:77], v[76:77], v[14:15] op_sel:[0,1] op_sel_hi:[1,1]
    v_pk_mul_f32 v[78:79], v[78:79], v[14:15] op_sel:[0,1] op_sel_hi:[1,1]
    buffer_load_dwordx4 v[132:135], v9, s[52:55], s101 offen offset:1024 sc1
    buffer_load_dwordx4 v[136:139], v9, s[52:55], s101 offen offset:2048 sc1
    buffer_load_dwordx4 v[140:143], v9, s[52:55], s101 offen offset:3072 sc1
    s_add_u32 s100, s90, 2048
    buffer_load_dwordx4 v[192:195], v9, s[52:55], s100 offen offset:0 sc1
    buffer_load_dwordx4 v[196:199], v9, s[52:55], s100 offen offset:1024 sc1
    ds_read_b64_tr_b16 a[0:1], v4 offset:0
    ds_read_b64_tr_b16 a[2:3], v4 offset:1024
    ds_read_b64_tr_b16 a[4:5], v5 offset:0
    ds_read_b64_tr_b16 a[6:7], v5 offset:1024
    ds_read_b64_tr_b16 a[8:9], v4 offset:2048
    ds_read_b64_tr_b16 a[10:11], v4 offset:3072
    ds_read_b64_tr_b16 a[12:13], v5 offset:2048
    ds_read_b64_tr_b16 a[14:15], v5 offset:3072
    ds_read_b64_tr_b16 a[16:17], v4 offset:3584
    ds_read_b64_tr_b16 a[18:19], v4 offset:4608
    ds_read_b64_tr_b16 a[20:21], v5 offset:3584
    ds_read_b64_tr_b16 a[22:23], v5 offset:4608
    ds_read_b64_tr_b16 a[24:25], v4 offset:5632
    ds_read_b64_tr_b16 a[26:27], v4 offset:6656
    ds_read_b64_tr_b16 a[28:29], v5 offset:5632
    ds_read_b64_tr_b16 a[30:31], v5 offset:6656
    s_add_u32 s100, s91, 2048
    buffer_load_dwordx4 v[200:203], v9, s[52:55], s100 offen offset:0 sc1
    ds_read_b64_tr_b16 a[32:33], v4 offset:7168
    ds_read_b64_tr_b16 a[34:35], v4 offset:8192
    ds_read_b64_tr_b16 a[36:37], v5 offset:7168
    ds_read_b64_tr_b16 a[38:39], v5 offset:8192
    ds_read_b64_tr_b16 a[40:41], v4 offset:9216
    ds_read_b64_tr_b16 a[42:43], v4 offset:10240
    ds_read_b64_tr_b16 a[44:45], v5 offset:9216
    ds_read_b64_tr_b16 a[46:47], v5 offset:10240
    buffer_load_dwordx4 v[204:207], v9, s[52:55], s100 offen offset:1024 sc1
    ds_read_b64_tr_b16 a[48:49], v4 offset:10752
    ds_read_b64_tr_b16 a[50:51], v4 offset:11776
    ds_read_b64_tr_b16 a[52:53], v5 offset:10752
    ds_read_b64_tr_b16 a[54:55], v5 offset:11776
    ds_read_b64_tr_b16 a[56:57], v4 offset:12800
    ds_read_b64_tr_b16 a[58:59], v4 offset:13824
    ds_read_b64_tr_b16 a[60:61], v5 offset:12800
    ds_read_b64_tr_b16 a[62:63], v5 offset:13824
    s_waitcnt vmcnt(12)
    v_cvt_pk_bf16_f32 v80, v112, v113
    v_cvt_pk_bf16_f32 v81, v114, v115
    v_cvt_pk_bf16_f32 v82, v116, v117
    v_cvt_pk_bf16_f32 v83, v118, v119
    v_cvt_pk_bf16_f32 v84, v120, v121
    v_cvt_pk_bf16_f32 v85, v122, v123
    v_cvt_pk_bf16_f32 v86, v124, v125
    v_cvt_pk_bf16_f32 v87, v126, v127
    s_add_u32 s101, s92, 8192
    buffer_load_dwordx4 v[144:147], v9, s[52:55], s101 offen offset:0 sc1
    s_waitcnt vmcnt(9)
    v_mfma_f32_32x32x16_bf16 v[112:127], v[80:83], v[176:179], 0
    v_mfma_f32_32x32x16_bf16 v[112:127], v[84:87], v[180:183], v[112:127]
    buffer_load_dwordx4 v[148:151], v9, s[52:55], s101 offen offset:1024 sc1
    v_mfma_f32_32x32x16_bf16 v[240:255], v[80:83], v[184:187], 0
    v_mfma_f32_32x32x16_bf16 v[240:255], v[84:87], v[188:191], v[240:255]
    buffer_load_dwordx4 v[152:155], v9, s[52:55], s101 offen offset:2048 sc1
    s_nop 7
    v_mov_b32 v12, v124
    v_mov_b32 v13, v124
    s_nop 1
    v_permlane32_swap_b32 v12, v13
    v_add_f32 v13, s89, v13
    v_rcp_f32 v13, v13
    s_nop 0
    v_mul_f32 v13, v13, v6
    v_mul_f32 v112, v112, v13
    v_mul_f32 v113, v113, v13
    v_mul_f32 v114, v114, v13
    v_mul_f32 v115, v115, v13
    v_mul_f32 v116, v116, v13
    v_mul_f32 v117, v117, v13
    v_mul_f32 v118, v118, v13
    v_mul_f32 v119, v119, v13
    buffer_load_dwordx4 v[156:159], v9, s[52:55], s101 offen offset:3072 sc1
    v_mul_f32 v120, v120, v13
    v_mul_f32 v121, v121, v13
    v_mul_f32 v122, v122, v13
    v_mul_f32 v123, v123, v13
    v_mul_f32 v124, v124, v13
    v_mul_f32 v125, v125, v13
    v_mul_f32 v126, v126, v13
    v_mul_f32 v127, v127, v13
    v_cvt_pk_bf16_f32 v176, v112, v113
    v_cvt_pk_bf16_f32 v177, v114, v115
    v_cvt_pk_bf16_f32 v178, v116, v117
    v_cvt_pk_bf16_f32 v179, v118, v119
    v_cvt_pk_bf16_f32 v180, v120, v121
    v_cvt_pk_bf16_f32 v181, v122, v123
    v_cvt_pk_bf16_f32 v182, v124, v125
    v_cvt_pk_bf16_f32 v183, v126, v127
    v_cndmask_b32 v182, v182, 0, s[84:85]
    s_add_u32 s100, s90, 4096
    buffer_load_dwordx4 v[208:211], v9, s[52:55], s100 offen offset:0 sc1
    v_cndmask_b32 v183, v183, 0, s[84:85]
    s_waitcnt vmcnt(9)
    v_cvt_pk_bf16_f32 v88, v128, v129
    v_cvt_pk_bf16_f32 v89, v130, v131
    v_cvt_pk_bf16_f32 v90, v132, v133
    v_cvt_pk_bf16_f32 v91, v134, v135
    v_cvt_pk_bf16_f32 v92, v136, v137
    v_cvt_pk_bf16_f32 v93, v138, v139
    v_cvt_pk_bf16_f32 v94, v140, v141
    v_cvt_pk_bf16_f32 v95, v142, v143
    buffer_load_dwordx4 v[212:215], v9, s[52:55], s100 offen offset:1024 sc1
    s_add_u32 s100, s91, 4096
    buffer_load_dwordx4 v[216:219], v9, s[52:55], s100 offen offset:0 sc1
    buffer_load_dwordx4 v[220:223], v9, s[52:55], s100 offen offset:1024 sc1
    s_add_u32 s101, s92, 12288
    buffer_load_dwordx4 v[160:163], v9, s[52:55], s101 offen offset:0 sc1
    s_waitcnt vmcnt(9)
    v_mfma_f32_32x32x16_bf16 v[128:143], v[88:91], v[192:195], 0
    v_mfma_f32_32x32x16_bf16 v[128:143], v[92:95], v[196:199], v[128:143]
    buffer_load_dwordx4 v[164:167], v9, s[52:55], s101 offen offset:1024 sc1
    v_mfma_f32_32x32x16_bf16 v[112:127], v[88:91], v[200:203], 0
    v_mfma_f32_32x32x16_bf16 v[112:127], v[92:95], v[204:207], v[112:127]
    buffer_load_dwordx4 v[168:171], v9, s[52:55], s101 offen offset:2048 sc1
    s_waitcnt lgkmcnt(15)
    v_mfma_f32_32x32x16_bf16 v[16:31], a[0:3], v[176:179], v[16:31]
    buffer_load_dwordx4 v[172:175], v9, s[52:55], s101 offen offset:3072 sc1
    v_mov_b32 v12, v252
    v_mov_b32 v13, v252
    s_nop 1
    v_permlane32_swap_b32 v12, v13
    v_add_f32 v13, s89, v13
    v_rcp_f32 v13, v13
    s_nop 0
    v_mul_f32 v13, v13, v7
    v_mfma_f32_32x32x16_bf16 v[48:63], a[4:7], v[176:179], v[48:63]
    v_mul_f32 v240, v240, v13
    v_mul_f32 v241, v241, v13
    v_mul_f32 v242, v242, v13
    v_mul_f32 v243, v243, v13
    v_mul_f32 v244, v244, v13
    v_mul_f32 v245, v245, v13
    v_mul_f32 v246, v246, v13
    s_add_u32 s100, s90, 6144
    buffer_load_dwordx4 v[224:227], v9, s[52:55], s100 offen offset:0 sc1
    v_mul_f32 v247, v247, v13
    v_mul_f32 v248, v248, v13
    v_mfma_f32_32x32x16_bf16 v[16:31], a[8:11], v[180:183], v[16:31]
    v_mul_f32 v249, v249, v13
    v_mul_f32 v250, v250, v13
    v_mul_f32 v251, v251, v13
    v_mul_f32 v252, v252, v13
    v_mul_f32 v253, v253, v13
    v_mul_f32 v254, v254, v13
    v_mul_f32 v255, v255, v13
    v_cvt_pk_bf16_f32 v184, v240, v241
    v_cvt_pk_bf16_f32 v185, v242, v243
    v_mfma_f32_32x32x16_bf16 v[48:63], a[12:15], v[180:183], v[48:63]
    buffer_load_dwordx4 v[228:231], v9, s[52:55], s100 offen offset:1024 sc1
    v_cvt_pk_bf16_f32 v186, v244, v245
    v_cvt_pk_bf16_f32 v187, v246, v247
    v_cvt_pk_bf16_f32 v188, v248, v249
    v_cvt_pk_bf16_f32 v189, v250, v251
    v_cvt_pk_bf16_f32 v190, v252, v253
    v_cvt_pk_bf16_f32 v191, v254, v255
    v_cndmask_b32 v190, v190, 0, s[84:85]
    v_cndmask_b32 v191, v191, 0, s[84:85]
    v_mfma_f32_32x32x16_bf16 v[32:47], a[0:3], v[184:187], v[32:47]
    s_add_u32 s100, s91, 6144
    buffer_load_dwordx4 v[232:235], v9, s[52:55], s100 offen offset:0 sc1
    v_mov_b32 v12, v140
    v_mov_b32 v13, v140
    s_nop 1
    v_permlane32_swap_b32 v12, v13
    v_add_f32 v13, s89, v13
    v_rcp_f32 v13, v13
    s_nop 0
    v_mul_f32 v13, v13, v6
    v_mfma_f32_32x32x16_bf16 v[64:79], a[4:7], v[184:187], v[64:79]
    v_mul_f32 v128, v128, v13
    v_mul_f32 v129, v129, v13
    v_mul_f32 v130, v130, v13
    v_mul_f32 v131, v131, v13
    v_mul_f32 v132, v132, v13
    v_mul_f32 v133, v133, v13
    buffer_load_dwordx4 v[236:239], v9, s[52:55], s100 offen offset:1024 sc1
    v_mul_f32 v134, v134, v13
    v_mul_f32 v135, v135, v13
    v_mul_f32 v136, v136, v13
    v_mfma_f32_32x32x16_bf16 v[32:47], a[8:11], v[188:191], v[32:47]
    v_mul_f32 v137, v137, v13
    v_mul_f32 v138, v138, v13
    v_mul_f32 v139, v139, v13
    v_mul_f32 v140, v140, v13
    v_mul_f32 v141, v141, v13
    v_mul_f32 v142, v142, v13
    v_mul_f32 v143, v143, v13
    v_cvt_pk_bf16_f32 v192, v128, v129
    v_cvt_pk_bf16_f32 v193, v130, v131
    v_mfma_f32_32x32x16_bf16 v[64:79], a[12:15], v[188:191], v[64:79]
    v_cvt_pk_bf16_f32 v194, v132, v133
    v_cvt_pk_bf16_f32 v195, v134, v135
    v_cvt_pk_bf16_f32 v196, v136, v137
    v_cvt_pk_bf16_f32 v197, v138, v139
    v_cvt_pk_bf16_f32 v198, v140, v141
    v_cvt_pk_bf16_f32 v199, v142, v143
    v_cndmask_b32 v198, v198, 0, s[84:85]
    v_cndmask_b32 v199, v199, 0, s[84:85]
    s_waitcnt vmcnt(12)
    v_cvt_pk_bf16_f32 v96, v144, v145
    v_cvt_pk_bf16_f32 v97, v146, v147
    v_cvt_pk_bf16_f32 v98, v148, v149
    v_cvt_pk_bf16_f32 v99, v150, v151
    v_cvt_pk_bf16_f32 v100, v152, v153
    v_cvt_pk_bf16_f32 v101, v154, v155
    v_cvt_pk_bf16_f32 v102, v156, v157
    v_cvt_pk_bf16_f32 v103, v158, v159
    s_waitcnt vmcnt(8)
    v_mfma_f32_32x32x16_bf16 v[144:159], v[96:99], v[208:211], 0
    v_mfma_f32_32x32x16_bf16 v[144:159], v[100:103], v[212:215], v[144:159]
    v_mfma_f32_32x32x16_bf16 v[128:143], v[96:99], v[216:219], 0
    v_mfma_f32_32x32x16_bf16 v[128:143], v[100:103], v[220:223], v[128:143]
    s_waitcnt lgkmcnt(15)
    v_mfma_f32_32x32x16_bf16 v[16:31], a[16:19], v[192:195], v[16:31]
    v_mov_b32 v12, v124
    v_mov_b32 v13, v124
    s_nop 1
    v_permlane32_swap_b32 v12, v13
    v_add_f32 v13, s89, v13
    v_rcp_f32 v13, v13
    s_nop 0
    v_mul_f32 v13, v13, v7
    v_mfma_f32_32x32x16_bf16 v[48:63], a[20:23], v[192:195], v[48:63]
    v_mul_f32 v112, v112, v13
    v_mul_f32 v113, v113, v13
    v_mul_f32 v114, v114, v13
    v_mul_f32 v115, v115, v13
    v_mul_f32 v116, v116, v13
    v_mul_f32 v117, v117, v13
    v_mul_f32 v118, v118, v13
    v_mul_f32 v119, v119, v13
    v_mul_f32 v120, v120, v13
    v_mfma_f32_32x32x16_bf16 v[16:31], a[24:27], v[196:199], v[16:31]
    v_mul_f32 v121, v121, v13
    v_mul_f32 v122, v122, v13
    v_mul_f32 v123, v123, v13
    v_mul_f32 v124, v124, v13
    v_mul_f32 v125, v125, v13
    v_mul_f32 v126, v126, v13
    v_mul_f32 v127, v127, v13
    v_cvt_pk_bf16_f32 v200, v112, v113
    v_cvt_pk_bf16_f32 v201, v114, v115
    v_mfma_f32_32x32x16_bf16 v[48:63], a[28:31], v[196:199], v[48:63]
    v_cvt_pk_bf16_f32 v202, v116, v117
    v_cvt_pk_bf16_f32 v203, v118, v119
    v_cvt_pk_bf16_f32 v204, v120, v121
    v_cvt_pk_bf16_f32 v205, v122, v123
    v_cvt_pk_bf16_f32 v206, v124, v125
    v_cvt_pk_bf16_f32 v207, v126, v127
    v_cndmask_b32 v206, v206, 0, s[84:85]
    v_cndmask_b32 v207, v207, 0, s[84:85]
    v_mfma_f32_32x32x16_bf16 v[32:47], a[16:19], v[200:203], v[32:47]
    v_mov_b32 v12, v156
    v_mov_b32 v13, v156
    s_nop 1
    v_permlane32_swap_b32 v12, v13
    v_add_f32 v13, s89, v13
    v_rcp_f32 v13, v13
    s_nop 0
    v_mul_f32 v13, v13, v6
    v_mfma_f32_32x32x16_bf16 v[64:79], a[20:23], v[200:203], v[64:79]
    v_mul_f32 v144, v144, v13
    v_mul_f32 v145, v145, v13
    v_mul_f32 v146, v146, v13
    v_mul_f32 v147, v147, v13
    v_mul_f32 v148, v148, v13
    v_mul_f32 v149, v149, v13
    v_mul_f32 v150, v150, v13
    v_mul_f32 v151, v151, v13
    v_mul_f32 v152, v152, v13
    v_mfma_f32_32x32x16_bf16 v[32:47], a[24:27], v[204:207], v[32:47]
    v_mul_f32 v153, v153, v13
    v_mul_f32 v154, v154, v13
    v_mul_f32 v155, v155, v13
    v_mul_f32 v156, v156, v13
    v_mul_f32 v157, v157, v13
    v_mul_f32 v158, v158, v13
    v_mul_f32 v159, v159, v13
    v_cvt_pk_bf16_f32 v208, v144, v145
    v_cvt_pk_bf16_f32 v209, v146, v147
    v_mfma_f32_32x32x16_bf16 v[64:79], a[28:31], v[204:207], v[64:79]
    v_cvt_pk_bf16_f32 v210, v148, v149
    v_cvt_pk_bf16_f32 v211, v150, v151
    v_cvt_pk_bf16_f32 v212, v152, v153
    v_cvt_pk_bf16_f32 v213, v154, v155
    v_cvt_pk_bf16_f32 v214, v156, v157
    v_cvt_pk_bf16_f32 v215, v158, v159
    v_cndmask_b32 v214, v214, 0, s[84:85]
    v_cndmask_b32 v215, v215, 0, s[84:85]
    s_waitcnt vmcnt(4)
    v_cvt_pk_bf16_f32 v104, v160, v161
    v_cvt_pk_bf16_f32 v105, v162, v163
    v_cvt_pk_bf16_f32 v106, v164, v165
    v_cvt_pk_bf16_f32 v107, v166, v167
    v_cvt_pk_bf16_f32 v108, v168, v169
    v_cvt_pk_bf16_f32 v109, v170, v171
    v_cvt_pk_bf16_f32 v110, v172, v173
    v_cvt_pk_bf16_f32 v111, v174, v175
    s_waitcnt vmcnt(0)
    v_mfma_f32_32x32x16_bf16 v[160:175], v[104:107], v[224:227], 0
    v_mfma_f32_32x32x16_bf16 v[160:175], v[108:111], v[228:231], v[160:175]
    v_mfma_f32_32x32x16_bf16 v[144:159], v[104:107], v[232:235], 0
    v_mfma_f32_32x32x16_bf16 v[144:159], v[108:111], v[236:239], v[144:159]
    s_waitcnt lgkmcnt(8)
    v_mfma_f32_32x32x16_bf16 v[16:31], a[32:35], v[208:211], v[16:31]
    v_mov_b32 v12, v140
    v_mov_b32 v13, v140
    s_nop 1
    v_permlane32_swap_b32 v12, v13
    v_add_f32 v13, s89, v13
    v_rcp_f32 v13, v13
    s_nop 0
    v_mul_f32 v13, v13, v7
    v_mfma_f32_32x32x16_bf16 v[48:63], a[36:39], v[208:211], v[48:63]
    v_mul_f32 v128, v128, v13
    v_mul_f32 v129, v129, v13
    v_mul_f32 v130, v130, v13
    v_mul_f32 v131, v131, v13
    v_mul_f32 v132, v132, v13
    v_mul_f32 v133, v133, v13
    v_mul_f32 v134, v134, v13
    v_mul_f32 v135, v135, v13
    v_mul_f32 v136, v136, v13
    v_mfma_f32_32x32x16_bf16 v[16:31], a[40:43], v[212:215], v[16:31]
    v_mul_f32 v137, v137, v13
    v_mul_f32 v138, v138, v13
    v_mul_f32 v139, v139, v13
    v_mul_f32 v140, v140, v13
    v_mul_f32 v141, v141, v13
    v_mul_f32 v142, v142, v13
    v_mul_f32 v143, v143, v13
    v_cvt_pk_bf16_f32 v216, v128, v129
    v_cvt_pk_bf16_f32 v217, v130, v131
    v_mfma_f32_32x32x16_bf16 v[48:63], a[44:47], v[212:215], v[48:63]
    v_cvt_pk_bf16_f32 v218, v132, v133
    v_cvt_pk_bf16_f32 v219, v134, v135
    v_cvt_pk_bf16_f32 v220, v136, v137
    v_cvt_pk_bf16_f32 v221, v138, v139
    v_cvt_pk_bf16_f32 v222, v140, v141
    v_cvt_pk_bf16_f32 v223, v142, v143
    v_cndmask_b32 v222, v222, 0, s[84:85]
    v_cndmask_b32 v223, v223, 0, s[84:85]
    v_mfma_f32_32x32x16_bf16 v[32:47], a[32:35], v[216:219], v[32:47]
    v_mov_b32 v12, v172
    v_mov_b32 v13, v172
    s_nop 1
    v_permlane32_swap_b32 v12, v13
    v_add_f32 v13, s89, v13
    v_rcp_f32 v13, v13
    s_nop 0
    v_mul_f32 v13, v13, v6
    v_mfma_f32_32x32x16_bf16 v[64:79], a[36:39], v[216:219], v[64:79]
    v_mul_f32 v160, v160, v13
    v_mul_f32 v161, v161, v13
    v_mul_f32 v162, v162, v13
    v_mul_f32 v163, v163, v13
    v_mul_f32 v164, v164, v13
    v_mul_f32 v165, v165, v13
    v_mul_f32 v166, v166, v13
    v_mul_f32 v167, v167, v13
    v_mul_f32 v168, v168, v13
    v_mfma_f32_32x32x16_bf16 v[32:47], a[40:43], v[220:223], v[32:47]
    v_mul_f32 v169, v169, v13
    v_mul_f32 v170, v170, v13
    v_mul_f32 v171, v171, v13
    v_mul_f32 v172, v172, v13
    v_mul_f32 v173, v173, v13
    v_mul_f32 v174, v174, v13
    v_mul_f32 v175, v175, v13
    v_cvt_pk_bf16_f32 v224, v160, v161
    v_cvt_pk_bf16_f32 v225, v162, v163
    v_mfma_f32_32x32x16_bf16 v[64:79], a[44:47], v[220:223], v[64:79]
    v_cvt_pk_bf16_f32 v226, v164, v165
    v_cvt_pk_bf16_f32 v227, v166, v167
    v_cvt_pk_bf16_f32 v228, v168, v169
    v_cvt_pk_bf16_f32 v229, v170, v171
    v_cvt_pk_bf16_f32 v230, v172, v173
    v_cvt_pk_bf16_f32 v231, v174, v175
    v_cndmask_b32 v230, v230, 0, s[84:85]
    v_cndmask_b32 v231, v231, 0, s[84:85]
    s_waitcnt lgkmcnt(0)
    v_mfma_f32_32x32x16_bf16 v[16:31], a[48:51], v[224:227], v[16:31]
    v_mov_b32 v12, v156
    v_mov_b32 v13, v156
    s_nop 1
    v_permlane32_swap_b32 v12, v13
    v_add_f32 v13, s89, v13
    v_rcp_f32 v13, v13
    s_nop 0
    v_mul_f32 v13, v13, v7
    v_mfma_f32_32x32x16_bf16 v[48:63], a[52:55], v[224:227], v[48:63]
    v_mul_f32 v144, v144, v13
    v_mul_f32 v145, v145, v13
    v_mul_f32 v146, v146, v13
    v_mul_f32 v147, v147, v13
    v_mul_f32 v148, v148, v13
    v_mul_f32 v149, v149, v13
    v_mul_f32 v150, v150, v13
    v_mul_f32 v151, v151, v13
    v_mul_f32 v152, v152, v13
    v_mfma_f32_32x32x16_bf16 v[16:31], a[56:59], v[228:231], v[16:31]
    v_mul_f32 v153, v153, v13
    v_mul_f32 v154, v154, v13
    v_mul_f32 v155, v155, v13
    v_mul_f32 v156, v156, v13
    v_mul_f32 v157, v157, v13
    v_mul_f32 v158, v158, v13
    v_mul_f32 v159, v159, v13
    v_cvt_pk_bf16_f32 v232, v144, v145
    v_cvt_pk_bf16_f32 v233, v146, v147
    v_mfma_f32_32x32x16_bf16 v[48:63], a[60:63], v[228:231], v[48:63]
    v_cvt_pk_bf16_f32 v234, v148, v149
    v_cvt_pk_bf16_f32 v235, v150, v151
    v_cvt_pk_bf16_f32 v236, v152, v153
    v_cvt_pk_bf16_f32 v237, v154, v155
    v_cvt_pk_bf16_f32 v238, v156, v157
    v_cvt_pk_bf16_f32 v239, v158, v159
    v_cndmask_b32 v238, v238, 0, s[84:85]
    v_cndmask_b32 v239, v239, 0, s[84:85]
    v_mfma_f32_32x32x16_bf16 v[32:47], a[48:51], v[232:235], v[32:47]
    v_mfma_f32_32x32x16_bf16 v[64:79], a[52:55], v[232:235], v[64:79]
    v_mfma_f32_32x32x16_bf16 v[32:47], a[56:59], v[236:239], v[32:47]
    v_mfma_f32_32x32x16_bf16 v[64:79], a[60:63], v[236:239], v[64:79]
    s_xor_b32 s67, s64, 1
    s_mul_i32 s67, s67, 12288
    s_add_u32 s67, s67, 0
    v_add_u32 v145, s67, v9
    s_xor_b32 s67, s64, 2
    s_mul_i32 s67, s67, 12288
    s_add_u32 s67, s67, 4096
    v_add_u32 v146, s67, v9
    s_xor_b32 s67, s64, 3
    s_mul_i32 s67, s67, 12288
    s_add_u32 s67, s67, 8192
    v_add_u32 v147, s67, v9
    ds_write_b128 v145, v[48:51] offset:0
    ds_write_b128 v145, v[52:55] offset:1024
    ds_write_b128 v145, v[56:59] offset:2048
    ds_write_b128 v145, v[60:63] offset:3072
    ds_write_b128 v146, v[32:35] offset:0
    ds_write_b128 v146, v[36:39] offset:1024
    ds_write_b128 v146, v[40:43] offset:2048
    ds_write_b128 v146, v[44:47] offset:3072
    ds_write_b128 v147, v[64:67] offset:0
    ds_write_b128 v147, v[68:71] offset:1024
    ds_write_b128 v147, v[72:75] offset:2048
    ds_write_b128 v147, v[76:79] offset:3072
    s_mul_i32 s67, s64, 12288
    v_add_u32 v144, s67, v9
    v_and_b32 v148, 31, v1
    v_mul_u32_u24 v148, 896, v148
    v_lshrrev_b32 v149, 5, v1
    v_lshl_add_u32 v148, v149, 4, v148
    s_lshl_b32 s67, s86, 1
    s_add_u32 s67, s67, s71
    s_mul_i32 s67, s67, 28672
    s_lshl_b32 s68, s87, 7
    s_add_u32 s67, s67, s68
    s_and_b32 s68, s64, 1
    s_lshl_b32 s68, s68, 6
    s_add_u32 s67, s67, s68
    s_waitcnt lgkmcnt(0)
    s_barrier
    ds_read_b128 v[80:83], v144 offset:0
    ds_read_b128 v[84:87], v144 offset:1024
    ds_read_b128 v[88:91], v144 offset:2048
    ds_read_b128 v[92:95], v144 offset:3072
    ds_read_b128 v[96:99], v144 offset:4096
    ds_read_b128 v[100:103], v144 offset:5120
    ds_read_b128 v[104:107], v144 offset:6144
    ds_read_b128 v[108:111], v144 offset:7168
    ds_read_b128 v[112:115], v144 offset:8192
    ds_read_b128 v[116:119], v144 offset:9216
    ds_read_b128 v[120:123], v144 offset:10240
    ds_read_b128 v[124:127], v144 offset:11264
    s_waitcnt lgkmcnt(8)
    v_add_f32 v16, v16, v80
    v_add_f32 v17, v17, v81
    v_add_f32 v18, v18, v82
    v_add_f32 v19, v19, v83
    v_add_f32 v20, v20, v84
    v_add_f32 v21, v21, v85
    v_add_f32 v22, v22, v86
    v_add_f32 v23, v23, v87
    v_add_f32 v24, v24, v88
    v_add_f32 v25, v25, v89
    v_add_f32 v26, v26, v90
    v_add_f32 v27, v27, v91
    v_add_f32 v28, v28, v92
    v_add_f32 v29, v29, v93
    v_add_f32 v30, v30, v94
    v_add_f32 v31, v31, v95
    s_waitcnt lgkmcnt(4)
    v_add_f32 v16, v16, v96
    v_add_f32 v17, v17, v97
    v_add_f32 v18, v18, v98
    v_add_f32 v19, v19, v99
    v_add_f32 v20, v20, v100
    v_add_f32 v21, v21, v101
    v_add_f32 v22, v22, v102
    v_add_f32 v23, v23, v103
    v_add_f32 v24, v24, v104
    v_add_f32 v25, v25, v105
    v_add_f32 v26, v26, v106
    v_add_f32 v27, v27, v107
    v_add_f32 v28, v28, v108
    v_add_f32 v29, v29, v109
    v_add_f32 v30, v30, v110
    v_add_f32 v31, v31, v111
    s_waitcnt lgkmcnt(0)
    v_add_f32 v16, v16, v112
    v_add_f32 v17, v17, v113
    v_add_f32 v18, v18, v114
    v_add_f32 v19, v19, v115
    v_add_f32 v20, v20, v116
    v_add_f32 v21, v21, v117
    v_add_f32 v22, v22, v118
    v_add_f32 v23, v23, v119
    v_add_f32 v24, v24, v120
    v_add_f32 v25, v25, v121
    v_add_f32 v26, v26, v122
    v_add_f32 v27, v27, v123
    v_add_f32 v28, v28, v124
    v_add_f32 v29, v29, v125
    v_add_f32 v30, v30, v126
    v_add_f32 v31, v31, v127
    v_cvt_pk_bf16_f32 v128, v16, v17
    v_cvt_pk_bf16_f32 v129, v18, v19
    v_cvt_pk_bf16_f32 v130, v20, v21
    v_cvt_pk_bf16_f32 v131, v22, v23
    v_cvt_pk_bf16_f32 v132, v24, v25
    v_cvt_pk_bf16_f32 v133, v26, v27
    v_cvt_pk_bf16_f32 v134, v28, v29
    v_cvt_pk_bf16_f32 v135, v30, v31
    v_permlane32_swap_b32 v128, v130
    v_permlane32_swap_b32 v129, v131
    buffer_store_dwordx4 v[128:131], v148, s[44:47], s67 offen offset:0
    v_permlane32_swap_b32 v132, v134
    v_permlane32_swap_b32 v133, v135
    buffer_store_dwordx4 v[132:135], v148, s[44:47], s67 offen offset:32
L_end:
L_exit:
    s_endpgm

.section .rodata,"a"
.p2align 6
.amdhsa_kernel gated_mix__linear_attn_block__dense_activation_squared_relu__prompt_kernel
  .amdhsa_next_free_vgpr 512
  .amdhsa_next_free_sgpr 102
  .amdhsa_accum_offset 256
  .amdhsa_group_segment_fixed_size 0
  .amdhsa_kernarg_size 96
  .amdhsa_user_sgpr_count 2
  .amdhsa_user_sgpr_kernarg_segment_ptr 1
  .amdhsa_system_sgpr_workgroup_id_x 1
.end_amdhsa_kernel
```
